```python
import torch

def _softmax(x, axis=-1):
    return torch.softmax(x, dim=axis)
def _gelu(x):
    return torch.nn.functional.gelu(x, approximate="tanh")
def _silu(x):
    return torch.nn.functional.silu(x)
def _sigmoid(x):
    return torch.sigmoid(x)
def _layernorm(x, axis=-1, eps=1e-5):
    m = x.mean(dim=axis, keepdim=True)
    v = x.var(dim=axis, keepdim=True, unbiased=False)
    return (x - m) / torch.sqrt(v + eps)
def _scatter_add(tgt, idx, src, axis=0):
    return tgt.clone().index_add_(axis, idx, src)
def _segment_sum(src, seg, n):
    out = torch.zeros((n,) + src.shape[1:], dtype=src.dtype)
    return out.index_add_(0, seg, src)
def _pad(x, pw):
    flat = tuple(v for pair in reversed(pw) for v in pair)
    return torch.nn.functional.pad(x, flat)

kernel_name = 'sequential_preLN__ssm_conv_s4__swiglu_ffn__prompt'

def setup_inputs():

    _w = (lambda a: (lambda t: t.to(torch.bfloat16) if t.is_floating_point() else t)(torch.as_tensor(a)))
    def _A_setup():
        B, L, D, N = 1, 2048, 1024, 128
        A_re = -(lambda _x: torch.exp(torch.as_tensor(_x)))((lambda *s: torch.randn(*s, dtype=torch.bfloat16) * 6.4)(D, N))
        A_im = torch.pi * (lambda *s: torch.randn(*s, dtype=torch.bfloat16) * 0.05)(D, N)
        B_re = (lambda *s: torch.randn(*s, dtype=torch.bfloat16) * 0.05)(D, N)
        B_im = (lambda *s: torch.randn(*s, dtype=torch.bfloat16) * 0.05)(D, N)
        C_re = (lambda *s: torch.randn(*s, dtype=torch.bfloat16) * 0.05)(D, N)
        C_im = (lambda *s: torch.randn(*s, dtype=torch.bfloat16) * 0.05)(D, N)
        log_dt = (lambda *s: torch.randn(*s, dtype=torch.bfloat16) * 0.05)(D) * 0.5 - 4.0
        Dskip = (lambda *s: torch.randn(*s, dtype=torch.bfloat16) * 0.05)(D)
        return {
            "u": _w((lambda *s: torch.randn(*s, dtype=torch.bfloat16) * 0.05)(B, L, D)),
            "A_re": _w(A_re),
            "A_im": _w(A_im),
            "B_re": _w(B_re),
            "B_im": _w(B_im),
            "C_re": _w(C_re),
            "C_im": _w(C_im),
            "log_dt": _w(log_dt),
            "Dskip": _w(Dskip),
        }
    _A_in = _A_setup()

    def _B_setup():
        B, S, D, F = 1, 2048, 1024, 3584
        return {
            "x": _w((lambda *s: torch.randn(*s, dtype=torch.bfloat16) * 0.05)(B, S, D)),
            "w_gate": _w((lambda *s: torch.randn(*s, dtype=torch.bfloat16) * 0.05)(D, F)),
            "w_up": _w((lambda *s: torch.randn(*s, dtype=torch.bfloat16) * 0.05)(D, F)),
            "w_down": _w((lambda *s: torch.randn(*s, dtype=torch.bfloat16) * 0.05)(F, D)),
        }
    _B_in = _B_setup()

    return {
        "A_u": _A_in["u"],
        "A_A_re": _A_in["A_re"],
        "A_A_im": _A_in["A_im"],
        "A_B_re": _A_in["B_re"],
        "A_B_im": _A_in["B_im"],
        "A_C_re": _A_in["C_re"],
        "A_C_im": _A_in["C_im"],
        "A_log_dt": _A_in["log_dt"],
        "A_Dskip": _A_in["Dskip"],
        "B_x": _B_in["x"],
        "B_w_gate": _B_in["w_gate"],
        "B_w_up": _B_in["w_up"],
        "B_w_down": _B_in["w_down"],
    }

def reference(A_u, A_A_re, A_A_im, A_B_re, A_B_im, A_C_re, A_C_im, A_log_dt, A_Dskip, B_x, B_w_gate, B_w_up, B_w_down):
    def _A_ref(u, A_re, A_im, B_re, B_im, C_re, C_im, log_dt, Dskip):
        Bsz, L, D = u.shape
        dt = torch.exp(log_dt)[:, None]
        A = A_re + 1j * A_im
        Bc = B_re + 1j * B_im
        Cc = C_re + 1j * C_im
        logdA = dt * A
        dB = dt * Bc
        l = (lambda x, dt: x.to(dt))(torch.arange(L), A_re.dtype)
        P = torch.exp(logdA[:, :, None] * l[None, None, :])
        K = torch.einsum("dn,dnl,dn->dl", Cc, P, dB).real
        L2 = 2 * L
        Kp = _pad(K, ((0, 0), (0, L)))
        up = (lambda x, *d: x.permute(*d))(u, 0, 2, 1)
        up = _pad(up, ((0, 0), (0, 0), (0, L)))
        Kf = (lambda x, axes=(-2,-1): torch.fft.rfft2(x.float(), dim=axes))(Kp[:, None, :], axes=(-2, -1))
        Uf = (lambda x, axes=(-2,-1): torch.fft.rfft2(x.float(), dim=axes))(up[:, :, None, :], axes=(-2, -1))
        Yf = Uf * Kf[None, :, :, :]
        y = (lambda x, s, axes=(-2,-1): torch.fft.irfft2(x, s=s, dim=axes).to(torch.bfloat16))(Yf, (1, L2), axes=(-2, -1))[:, :, 0, :L]
        y = (lambda x, *d: x.permute(*d))(y, 0, 2, 1) + u * Dskip[None, None, :]
        return y

    def _B_ref(x, w_gate, w_up, w_down):
        g = _silu(x @ w_gate)
        u = x @ w_up
        return (g * u) @ w_down

    x = A_u
    h = x + _A_ref(_layernorm(x, axis=-1), A_A_re, A_A_im, A_B_re, A_B_im, A_C_re, A_C_im, A_log_dt, A_Dskip)
    h2 = h + _B_ref(_layernorm(h, axis=-1), B_w_gate, B_w_up, B_w_down)
    return h2
```

```asm
; @launch kernel=a_kernel grid=(256,1,1) block=(512,1,1) lds=154752
; @launch kernel=b_kernel grid=(256,1,1) block=(256,1,1) lds=132352
.amdgcn_target "amdgcn-amd-amdhsa--gfx950"
.text
.globl a_kernel
.p2align 8
.type a_kernel,@function
a_kernel:
  s_cmp_ge_u32 s2, 256
  s_cbranch_scc1 L_a_kernel_end
  s_load_dwordx16 s[52:67], s[0:1], 0
  s_load_dwordx2 s[68:69], s[0:1], 64
  s_load_dwordx4 s[72:75], s[0:1], 80
  s_load_dwordx2 s[24:25], s[0:1], 120
  v_lshrrev_b32 v1, 6, v0
  v_and_b32 v2, 63, v0
  s_and_b32 s3, s2, 7
  v_readfirstlane_b32 s28, v1
  s_lshl_b32 s3, s3, 5
  s_lshr_b32 s26, s2, 3
  s_add_u32 s26, s26, s3
  s_cmp_ge_u32 s28, 4
  s_cbranch_scc1 L_a_kernel_helper
  s_getpc_b64 s[76:77]
  v_lshlrev_b32 v3, 6, v0
  global_load_dword v127, v3, s[76:77]
  s_lshl_b32 s27, s26, 2
  s_add_u32 s27, s27, s28
  s_lshl_b32 s29, s27, 8
  v_lshl_add_u32 v3, v2, 2, s29
  s_lshr_b32 s29, s27, 1
  s_lshl_b32 s29, s29, 2
  s_mul_i32 s19, s28, 33792
  s_add_u32 s19, s19, 19456
  v_lshl_add_u32 v7, v2, 3, s19
  s_lshr_b32 s20, s2, 2
  s_lshl_b32 s20, s20, 5
  s_and_b32 s21, s2, 3
  s_add_u32 s20, s20, s21
  s_lshl_b32 s21, s28, 3
  s_add_u32 s20, s20, s21
  s_lshl_b32 s20, s20, 11
  s_add_u32 s21, s20, 8192
  v_lshlrev_b32 v14, 4, v2
  s_mov_b32 s6, 4194304
  s_mov_b32 s7, 0x20000
  s_mov_b32 s22, 25198592
  s_waitcnt lgkmcnt(0)
  s_mov_b32 s4, s52
  s_mov_b32 s5, s53
  s_load_dword s70, s[24:25], s22
  buffer_load_dwordx4 v[64:67], v14, s[4:7], s20 offen
  buffer_load_dwordx4 v[68:71], v14, s[4:7], s20 offen offset:1024
  buffer_load_dwordx4 v[72:75], v14, s[4:7], s21 offen
  buffer_load_dwordx4 v[76:79], v14, s[4:7], s21 offen offset:1024
  s_load_dword s16, s[66:67], s29
  s_load_dword s17, s[68:69], s29
  global_load_dword v8, v3, s[54:55]
  global_load_dword v9, v3, s[56:57]
  global_load_dword v10, v3, s[58:59]
  global_load_dword v11, v3, s[60:61]
  global_load_dword v12, v3, s[62:63]
  global_load_dword v13, v3, s[64:65]
  s_barrier
  s_setprio 1
  v_and_b32 v24, 31, v2
  v_lshlrev_b32 v5, 4, v24
  v_lshlrev_b32 v14, 2, v24
  v_mul_u32_u24 v24, 528, v24
  v_lshrrev_b32 v15, 5, v2
  v_lshl_add_u32 v24, v15, 4, v24
  v_add_u32 v24, s19, v24
  v_add_u32 v5, s19, v5
  v_lshl_add_u32 v4, v15, 3, v5
  v_lshl_add_u32 v5, v15, 10, v5
  s_add_u32 s20, s19, 4224
  v_lshl_add_u32 v26, v15, 12, v14
  v_add_u32 v26, s20, v26
  v_lshlrev_b32 v16, 10, v15
  v_sub_u32 v27, v14, v16
  s_add_u32 s20, s19, 13456
  v_add_u32 v27, s20, v27
  v_cmp_eq_u32 s[78:79], 1, v15
  v_bfe_u32 v16, v2, 4, 1
  v_and_b32 v17, 1, v2
  v_cmp_eq_u32 s[80:81], 1, v17
  v_lshlrev_b32 v17, 4, v17
  v_lshl_add_u32 v17, v16, 3, v17
  v_and_b32 v16, 2, v2
  v_lshl_add_u32 v17, v16, 1, v17
  v_lshlrev_b32 v16, 5, v15
  v_sub_u32 v17, v17, v16
  v_bfe_u32 v16, v2, 2, 2
  v_lshlrev_b32 v16, 2, v16
  v_sub_u32 v17, v17, v16
  v_add_u32 v17, 48, v17
  v_lshl_add_u32 v6, v17, 1, s19
  v_bfe_u32 v16, v2, 2, 3
  v_add_u32 v16, v16, v15
  v_and_b32 v17, 3, v2
  v_mul_u32_u24 v18, 1216, v17
  v_lshl_add_u32 v16, v16, 4, v18
  s_mul_i32 s20, s28, 4864
  v_add_u32 v25, s20, v16
  v_cmp_le_u32 vcc, 1, v17
  s_nop 1
  v_cndmask_b32 v28, 0, 1.0, vcc
  v_cndmask_b32 v31, 1.0, 0, vcc
  v_cmp_le_u32 vcc, 2, v17
  s_nop 1
  v_cndmask_b32 v29, 0, 1.0, vcc
  v_cndmask_b32 v62, 1.0, 0, vcc
  v_cmp_le_u32 vcc, 3, v17
  s_nop 1
  v_cndmask_b32 v30, 0, 1.0, vcc
  v_cndmask_b32 v63, 1.0, 0, vcc
  s_waitcnt lgkmcnt(0)
  s_and_b32 s29, s28, 1
  s_lshl_b32 s29, s29, 4
  s_lshr_b32 s16, s16, s29
  s_lshl_b32 s16, s16, 16
  s_lshr_b32 s17, s17, s29
  s_lshl_b32 s17, s17, 16
  v_mov_b32 v14, 0x3fb8aa3b
  v_mul_f32 v14, s16, v14
  v_exp_f32 v14, v14
  v_cmp_eq_u32 vcc, 0, v2
  v_mov_b32 v3, s17
  v_cvt_pk_bf16_f32 v14, v14, v14
  v_cndmask_b32 v3, 0, v3, vcc
  v_lshlrev_b32 v14, 16, v14
  v_mul_f32 v15, 0x3fb8aa3b, v14
  v_mul_f32 v16, 0.15915494, v14

  v_lshrrev_b32 v60, 1, v2
  v_mul_u32_u24 v60, 7168, v60
  v_and_b32 v61, 1, v2
  v_lshl_add_u32 v60, v61, 7, v60
  s_add_u32 s8, s24, 25165824
  s_addc_u32 s9, s25, 0
  s_mov_b32 s10, 16384
  s_mov_b32 s11, 0x20000
  v_mov_b32 v32, 0
  v_mov_b32 v33, 0
  v_mov_b32 v34, 0
  v_mov_b32 v35, 0
  s_mov_b32 s22, 0x3f803f80
  s_add_u32 s70, s70, 1
  s_waitcnt vmcnt(8)
  v_dot2c_f32_bf16 v32, s22, v64
  v_dot2c_f32_bf16 v34, v64, v64
  v_dot2c_f32_bf16 v32, s22, v65
  v_dot2c_f32_bf16 v34, v65, v65
  v_dot2c_f32_bf16 v32, s22, v66
  v_dot2c_f32_bf16 v34, v66, v66
  v_dot2c_f32_bf16 v32, s22, v67
  v_dot2c_f32_bf16 v34, v67, v67
  v_dot2c_f32_bf16 v32, s22, v68
  v_dot2c_f32_bf16 v34, v68, v68
  v_dot2c_f32_bf16 v32, s22, v69
  v_dot2c_f32_bf16 v34, v69, v69
  v_dot2c_f32_bf16 v32, s22, v70
  v_dot2c_f32_bf16 v34, v70, v70
  v_dot2c_f32_bf16 v32, s22, v71
  v_dot2c_f32_bf16 v34, v71, v71
  s_waitcnt vmcnt(6)
  v_dot2c_f32_bf16 v33, s22, v72
  v_dot2c_f32_bf16 v35, v72, v72
  v_dot2c_f32_bf16 v33, s22, v73
  v_dot2c_f32_bf16 v35, v73, v73
  v_dot2c_f32_bf16 v33, s22, v74
  v_dot2c_f32_bf16 v35, v74, v74
  v_dot2c_f32_bf16 v33, s22, v75
  v_dot2c_f32_bf16 v35, v75, v75
  v_dot2c_f32_bf16 v33, s22, v76
  v_dot2c_f32_bf16 v35, v76, v76
  v_dot2c_f32_bf16 v33, s22, v77
  v_dot2c_f32_bf16 v35, v77, v77
  v_dot2c_f32_bf16 v33, s22, v78
  v_dot2c_f32_bf16 v35, v78, v78
  v_dot2c_f32_bf16 v33, s22, v79
  v_dot2c_f32_bf16 v35, v79, v79
  s_nop 1

  v_add_f32_dpp v32, v32, v32 quad_perm:[1,0,3,2] row_mask:0xf bank_mask:0xf
  v_add_f32_dpp v33, v33, v33 quad_perm:[1,0,3,2] row_mask:0xf bank_mask:0xf
  v_add_f32_dpp v34, v34, v34 quad_perm:[1,0,3,2] row_mask:0xf bank_mask:0xf
  v_add_f32_dpp v35, v35, v35 quad_perm:[1,0,3,2] row_mask:0xf bank_mask:0xf

  v_add_f32_dpp v32, v32, v32 quad_perm:[2,3,0,1] row_mask:0xf bank_mask:0xf
  v_add_f32_dpp v33, v33, v33 quad_perm:[2,3,0,1] row_mask:0xf bank_mask:0xf
  v_add_f32_dpp v34, v34, v34 quad_perm:[2,3,0,1] row_mask:0xf bank_mask:0xf
  v_add_f32_dpp v35, v35, v35 quad_perm:[2,3,0,1] row_mask:0xf bank_mask:0xf

  v_add_f32_dpp v32, v32, v32 row_half_mirror row_mask:0xf bank_mask:0xf
  v_add_f32_dpp v33, v33, v33 row_half_mirror row_mask:0xf bank_mask:0xf
  v_add_f32_dpp v34, v34, v34 row_half_mirror row_mask:0xf bank_mask:0xf
  v_add_f32_dpp v35, v35, v35 row_half_mirror row_mask:0xf bank_mask:0xf

  v_add_f32_dpp v32, v32, v32 row_mirror row_mask:0xf bank_mask:0xf
  v_add_f32_dpp v33, v33, v33 row_mirror row_mask:0xf bank_mask:0xf
  v_add_f32_dpp v34, v34, v34 row_mirror row_mask:0xf bank_mask:0xf
  v_add_f32_dpp v35, v35, v35 row_mirror row_mask:0xf bank_mask:0xf
  v_mov_b32 v36, v32
  v_mov_b32 v37, v33
  v_mov_b32 v38, v34
  v_mov_b32 v39, v35
  s_nop 1
  v_permlane16_swap_b32 v36, v32
  v_permlane16_swap_b32 v37, v33
  v_permlane16_swap_b32 v38, v34
  v_permlane16_swap_b32 v39, v35
  v_add_f32 v32, v32, v36
  v_add_f32 v33, v33, v37
  v_add_f32 v34, v34, v38
  v_add_f32 v35, v35, v39
  v_mov_b32 v36, v32
  v_mov_b32 v37, v33
  v_mov_b32 v38, v34
  v_mov_b32 v39, v35
  s_nop 1
  v_permlane32_swap_b32 v36, v32
  v_permlane32_swap_b32 v37, v33
  v_permlane32_swap_b32 v38, v34
  v_permlane32_swap_b32 v39, v35
  v_add_f32 v32, v32, v36
  v_add_f32 v33, v33, v37
  v_add_f32 v34, v34, v38
  v_add_f32 v35, v35, v39
  v_mul_f32 v32, 0x3a800000, v32
  v_mul_f32 v34, 0x3a800000, v34
  v_fma_f32 v34, -v32, v32, v34
  v_max_f32 v34, 0, v34
  v_cvt_pk_bf16_f32 v40, v34, v34
  v_lshlrev_b32 v40, 16, v40
  v_add_f32 v40, 0x3727c5ac, v40
  v_cvt_pk_bf16_f32 v40, v40, v40
  v_lshlrev_b32 v40, 16, v40
  v_sqrt_f32 v40, v40
  s_nop 0
  v_cvt_pk_bf16_f32 v36, v32, v40
  v_mul_f32 v33, 0x3a800000, v33
  v_mul_f32 v35, 0x3a800000, v35
  v_fma_f32 v35, -v33, v33, v35
  v_max_f32 v35, 0, v35
  v_cvt_pk_bf16_f32 v40, v35, v35
  v_lshlrev_b32 v40, 16, v40
  v_add_f32 v40, 0x3727c5ac, v40
  v_cvt_pk_bf16_f32 v40, v40, v40
  v_lshlrev_b32 v40, 16, v40
  v_sqrt_f32 v40, v40
  s_nop 0
  v_cvt_pk_bf16_f32 v38, v33, v40
  v_mov_b32 v37, s70
  v_mov_b32 v39, s70
  s_lshl_b32 s21, s28, 4
  s_add_u32 s21, s21, 154624
  v_mov_b32 v32, s21
  v_mov_b32 v33, 154688
  v_mov_b32 v34, 1
  s_mov_b64 exec, 1
  ds_write_b128 v32, v[36:39]
  ds_add_rtn_u32 v34, v33, v34
  s_waitcnt lgkmcnt(0)
  v_cmp_eq_u32 vcc, 3, v34
  s_mov_b64 exec, -1
  s_cbranch_vccz L_a_kernel_nopub
  v_and_b32 v32, 3, v2
  v_lshlrev_b32 v32, 4, v32
  v_add_u32 v33, 154624, v32
  ds_read_b128 v[36:39], v33
  s_lshl_b32 s20, s2, 6
  s_mov_b64 exec, 15
  s_waitcnt lgkmcnt(0)
  buffer_store_dwordx4 v[36:39], v32, s[8:11], s20 offen sc1
  s_mov_b64 exec, -1
  s_waitcnt vmcnt(1)
  s_branch L_a_kernel_pub
L_a_kernel_nopub:
  s_waitcnt vmcnt(0)
L_a_kernel_pub:
  v_lshlrev_b32 v32, 16, v8
  v_lshlrev_b32 v34, 16, v9
  v_lshlrev_b32 v36, 16, v10
  v_lshlrev_b32 v37, 16, v11
  v_lshlrev_b32 v40, 16, v12
  v_lshlrev_b32 v41, 16, v13
  v_and_b32 v33, 0xffff0000, v8
  v_and_b32 v35, 0xffff0000, v9
  v_and_b32 v38, 0xffff0000, v10
  v_and_b32 v39, 0xffff0000, v11
  v_and_b32 v42, 0xffff0000, v12
  v_and_b32 v43, 0xffff0000, v13
  v_mul_f32 v32, v32, v15
  v_mul_f32 v33, v33, v15
  v_mul_f32 v34, v34, v16
  v_mul_f32 v35, v35, v16
  v_pk_mul_f32 v[36:37], v[36:37], v[14:15] op_sel:[0,0] op_sel_hi:[1,0]
  v_pk_mul_f32 v[38:39], v[38:39], v[14:15] op_sel:[0,0] op_sel_hi:[1,0]
  v_pk_mul_f32 v[16:17], v[36:37], v[40:41] op_sel:[0,0] op_sel_hi:[1,0]
  v_pk_mul_f32 v[18:19], v[38:39], v[42:43] op_sel:[0,0] op_sel_hi:[1,0]
  v_pk_fma_f32 v[36:37], v[36:37], v[40:41], v[16:17] op_sel:[1,1,0] op_sel_hi:[0,1,1] neg_lo:[1,0,0]
  v_pk_fma_f32 v[38:39], v[38:39], v[42:43], v[18:19] op_sel:[1,1,0] op_sel_hi:[0,1,1] neg_lo:[1,0,0]
  v_mul_f32 v16, 1.0, v32
  v_mul_f32 v18, 1.0, v34
  v_mul_f32 v17, 1.0, v33
  v_mul_f32 v19, 1.0, v35
  v_exp_f32 v16, v16
  v_fract_f32 v18, v18
  v_exp_f32 v17, v17
  v_fract_f32 v19, v19
  v_cos_f32 v44, v18
  v_sin_f32 v45, v18
  v_cos_f32 v46, v19
  v_sin_f32 v47, v19
  s_nop 0
  v_pk_mul_f32 v[44:45], v[44:45], v[16:17] op_sel:[0,0] op_sel_hi:[1,0]
  v_pk_mul_f32 v[46:47], v[46:47], v[16:17] op_sel:[0,1] op_sel_hi:[1,1]
  v_mul_f32 v16, 0x41000000, v32
  v_mul_f32 v18, 0x41000000, v34
  v_mul_f32 v17, 0x41000000, v33
  v_mul_f32 v19, 0x41000000, v35
  v_exp_f32 v16, v16
  v_fract_f32 v18, v18
  v_exp_f32 v17, v17
  v_fract_f32 v19, v19
  v_cos_f32 v48, v18
  v_sin_f32 v49, v18
  v_cos_f32 v50, v19
  v_sin_f32 v51, v19
  s_nop 0
  v_pk_mul_f32 v[48:49], v[48:49], v[16:17] op_sel:[0,0] op_sel_hi:[1,0]
  v_pk_mul_f32 v[50:51], v[50:51], v[16:17] op_sel:[0,1] op_sel_hi:[1,1]
  v_mul_f32 v16, 0x43800000, v32
  v_mul_f32 v18, 0x43800000, v34
  v_mul_f32 v17, 0x43800000, v33
  v_mul_f32 v19, 0x43800000, v35
  v_exp_f32 v16, v16
  v_fract_f32 v18, v18
  v_exp_f32 v17, v17
  v_fract_f32 v19, v19
  v_cos_f32 v52, v18
  v_sin_f32 v53, v18
  v_cos_f32 v54, v19
  v_sin_f32 v55, v19
  s_nop 0
  v_pk_mul_f32 v[52:53], v[52:53], v[16:17] op_sel:[0,0] op_sel_hi:[1,0]
  v_pk_mul_f32 v[54:55], v[54:55], v[16:17] op_sel:[0,1] op_sel_hi:[1,1]
  v_cvt_pk_bf16_f32 v20, v36, -v37
  v_cvt_pk_bf16_f32 v21, v38, -v39
  ds_write_b64 v7, v[20:21] offset:0
  v_pk_mul_f32 v[16:17], v[36:37], v[44:45] op_sel:[0,0] op_sel_hi:[1,0]
  v_pk_mul_f32 v[18:19], v[38:39], v[46:47] op_sel:[0,0] op_sel_hi:[1,0]
  v_pk_fma_f32 v[8:9], v[36:37], v[44:45], v[16:17] op_sel:[1,1,0] op_sel_hi:[0,1,1] neg_lo:[1,0,0]
  v_pk_fma_f32 v[10:11], v[38:39], v[46:47], v[18:19] op_sel:[1,1,0] op_sel_hi:[0,1,1] neg_lo:[1,0,0]
  v_cvt_pk_bf16_f32 v22, v8, -v9
  v_cvt_pk_bf16_f32 v23, v10, -v11
  ds_write_b64 v7, v[22:23] offset:528
  v_pk_mul_f32 v[16:17], v[8:9], v[44:45] op_sel:[0,0] op_sel_hi:[1,0]
  v_pk_mul_f32 v[18:19], v[10:11], v[46:47] op_sel:[0,0] op_sel_hi:[1,0]
  v_pk_fma_f32 v[8:9], v[8:9], v[44:45], v[16:17] op_sel:[1,1,0] op_sel_hi:[0,1,1] neg_lo:[1,0,0]
  v_pk_fma_f32 v[10:11], v[10:11], v[46:47], v[18:19] op_sel:[1,1,0] op_sel_hi:[0,1,1] neg_lo:[1,0,0]
  v_cvt_pk_bf16_f32 v20, v8, -v9
  v_cvt_pk_bf16_f32 v21, v10, -v11
  ds_write_b64 v7, v[20:21] offset:1056
  v_pk_mul_f32 v[16:17], v[8:9], v[44:45] op_sel:[0,0] op_sel_hi:[1,0]
  v_pk_mul_f32 v[18:19], v[10:11], v[46:47] op_sel:[0,0] op_sel_hi:[1,0]
  v_pk_fma_f32 v[8:9], v[8:9], v[44:45], v[16:17] op_sel:[1,1,0] op_sel_hi:[0,1,1] neg_lo:[1,0,0]
  v_pk_fma_f32 v[10:11], v[10:11], v[46:47], v[18:19] op_sel:[1,1,0] op_sel_hi:[0,1,1] neg_lo:[1,0,0]
  v_cvt_pk_bf16_f32 v22, v8, -v9
  v_cvt_pk_bf16_f32 v23, v10, -v11
  ds_write_b64 v7, v[22:23] offset:1584
  v_pk_mul_f32 v[16:17], v[8:9], v[44:45] op_sel:[0,0] op_sel_hi:[1,0]
  v_pk_mul_f32 v[18:19], v[10:11], v[46:47] op_sel:[0,0] op_sel_hi:[1,0]
  v_pk_fma_f32 v[8:9], v[8:9], v[44:45], v[16:17] op_sel:[1,1,0] op_sel_hi:[0,1,1] neg_lo:[1,0,0]
  v_pk_fma_f32 v[10:11], v[10:11], v[46:47], v[18:19] op_sel:[1,1,0] op_sel_hi:[0,1,1] neg_lo:[1,0,0]
  v_cvt_pk_bf16_f32 v20, v8, -v9
  v_cvt_pk_bf16_f32 v21, v10, -v11
  ds_write_b64 v7, v[20:21] offset:2112
  v_pk_mul_f32 v[16:17], v[8:9], v[44:45] op_sel:[0,0] op_sel_hi:[1,0]
  v_pk_mul_f32 v[18:19], v[10:11], v[46:47] op_sel:[0,0] op_sel_hi:[1,0]
  v_pk_fma_f32 v[8:9], v[8:9], v[44:45], v[16:17] op_sel:[1,1,0] op_sel_hi:[0,1,1] neg_lo:[1,0,0]
  v_pk_fma_f32 v[10:11], v[10:11], v[46:47], v[18:19] op_sel:[1,1,0] op_sel_hi:[0,1,1] neg_lo:[1,0,0]
  v_cvt_pk_bf16_f32 v22, v8, -v9
  v_cvt_pk_bf16_f32 v23, v10, -v11
  ds_write_b64 v7, v[22:23] offset:2640
  v_pk_mul_f32 v[16:17], v[8:9], v[44:45] op_sel:[0,0] op_sel_hi:[1,0]
  v_pk_mul_f32 v[18:19], v[10:11], v[46:47] op_sel:[0,0] op_sel_hi:[1,0]
  v_pk_fma_f32 v[8:9], v[8:9], v[44:45], v[16:17] op_sel:[1,1,0] op_sel_hi:[0,1,1] neg_lo:[1,0,0]
  v_pk_fma_f32 v[10:11], v[10:11], v[46:47], v[18:19] op_sel:[1,1,0] op_sel_hi:[0,1,1] neg_lo:[1,0,0]
  v_cvt_pk_bf16_f32 v20, v8, -v9
  v_cvt_pk_bf16_f32 v21, v10, -v11
  ds_write_b64 v7, v[20:21] offset:3168
  v_pk_mul_f32 v[16:17], v[8:9], v[44:45] op_sel:[0,0] op_sel_hi:[1,0]
  v_pk_mul_f32 v[18:19], v[10:11], v[46:47] op_sel:[0,0] op_sel_hi:[1,0]
  v_pk_fma_f32 v[8:9], v[8:9], v[44:45], v[16:17] op_sel:[1,1,0] op_sel_hi:[0,1,1] neg_lo:[1,0,0]
  v_pk_fma_f32 v[10:11], v[10:11], v[46:47], v[18:19] op_sel:[1,1,0] op_sel_hi:[0,1,1] neg_lo:[1,0,0]
  v_cvt_pk_bf16_f32 v22, v8, -v9
  v_cvt_pk_bf16_f32 v23, v10, -v11
  ds_write_b64 v7, v[22:23] offset:3696
  v_pk_mul_f32 v[16:17], v[44:45], v[44:45] op_sel:[0,0] op_sel_hi:[1,0]
  v_pk_mul_f32 v[18:19], v[46:47], v[46:47] op_sel:[0,0] op_sel_hi:[1,0]
  v_pk_fma_f32 v[40:41], v[44:45], v[44:45], v[16:17] op_sel:[1,1,0] op_sel_hi:[0,1,1] neg_lo:[1,0,0]
  v_pk_fma_f32 v[42:43], v[46:47], v[46:47], v[18:19] op_sel:[1,1,0] op_sel_hi:[0,1,1] neg_lo:[1,0,0]
  v_pk_mul_f32 v[16:17], v[40:41], v[40:41] op_sel:[0,0] op_sel_hi:[1,0]
  v_pk_mul_f32 v[18:19], v[42:43], v[42:43] op_sel:[0,0] op_sel_hi:[1,0]
  v_pk_fma_f32 v[44:45], v[40:41], v[40:41], v[16:17] op_sel:[1,1,0] op_sel_hi:[0,1,1] neg_lo:[1,0,0]
  v_pk_fma_f32 v[46:47], v[42:43], v[42:43], v[18:19] op_sel:[1,1,0] op_sel_hi:[0,1,1] neg_lo:[1,0,0]
  v_pk_mul_f32 v[16:17], v[36:37], v[52:53] op_sel:[0,0] op_sel_hi:[1,0]
  v_pk_mul_f32 v[18:19], v[38:39], v[54:55] op_sel:[0,0] op_sel_hi:[1,0]
  v_pk_fma_f32 v[56:57], v[36:37], v[52:53], v[16:17] op_sel:[1,1,0] op_sel_hi:[0,1,1] neg_lo:[1,0,0]
  v_pk_fma_f32 v[58:59], v[38:39], v[54:55], v[18:19] op_sel:[1,1,0] op_sel_hi:[0,1,1] neg_lo:[1,0,0]
  v_cvt_pk_bf16_f32 v20, v56, -v57
  v_cvt_pk_bf16_f32 v21, v58, -v59
  ds_write_b64 v7, v[20:21] offset:4224
  v_pk_mul_f32 v[16:17], v[56:57], v[40:41] op_sel:[0,0] op_sel_hi:[1,0]
  v_pk_mul_f32 v[18:19], v[58:59], v[42:43] op_sel:[0,0] op_sel_hi:[1,0]
  v_pk_fma_f32 v[8:9], v[56:57], v[40:41], v[16:17] op_sel:[1,1,0] op_sel_hi:[0,1,1] neg_lo:[1,0,0]
  v_pk_fma_f32 v[10:11], v[58:59], v[42:43], v[18:19] op_sel:[1,1,0] op_sel_hi:[0,1,1] neg_lo:[1,0,0]
  v_cvt_pk_bf16_f32 v22, v8, -v9
  v_cvt_pk_bf16_f32 v23, v10, -v11
  ds_write_b64 v7, v[22:23] offset:4752
  v_pk_mul_f32 v[16:17], v[8:9], v[40:41] op_sel:[0,0] op_sel_hi:[1,0]
  v_pk_mul_f32 v[18:19], v[10:11], v[42:43] op_sel:[0,0] op_sel_hi:[1,0]
  v_pk_fma_f32 v[8:9], v[8:9], v[40:41], v[16:17] op_sel:[1,1,0] op_sel_hi:[0,1,1] neg_lo:[1,0,0]
  v_pk_fma_f32 v[10:11], v[10:11], v[42:43], v[18:19] op_sel:[1,1,0] op_sel_hi:[0,1,1] neg_lo:[1,0,0]
  v_cvt_pk_bf16_f32 v20, v8, -v9
  v_cvt_pk_bf16_f32 v21, v10, -v11
  ds_write_b64 v7, v[20:21] offset:5280
  ds_write_b64 v7, v[20:21] offset:6336
  v_pk_mul_f32 v[16:17], v[8:9], v[40:41] op_sel:[0,0] op_sel_hi:[1,0]
  v_pk_mul_f32 v[18:19], v[10:11], v[42:43] op_sel:[0,0] op_sel_hi:[1,0]
  v_pk_fma_f32 v[8:9], v[8:9], v[40:41], v[16:17] op_sel:[1,1,0] op_sel_hi:[0,1,1] neg_lo:[1,0,0]
  v_pk_fma_f32 v[10:11], v[10:11], v[42:43], v[18:19] op_sel:[1,1,0] op_sel_hi:[0,1,1] neg_lo:[1,0,0]
  v_cvt_pk_bf16_f32 v22, v8, -v9
  v_cvt_pk_bf16_f32 v23, v10, -v11
  ds_write_b64 v7, v[22:23] offset:6864
  v_pk_mul_f32 v[16:17], v[8:9], v[40:41] op_sel:[0,0] op_sel_hi:[1,0]
  v_pk_mul_f32 v[18:19], v[10:11], v[42:43] op_sel:[0,0] op_sel_hi:[1,0]
  v_pk_fma_f32 v[8:9], v[8:9], v[40:41], v[16:17] op_sel:[1,1,0] op_sel_hi:[0,1,1] neg_lo:[1,0,0]
  v_pk_fma_f32 v[10:11], v[10:11], v[42:43], v[18:19] op_sel:[1,1,0] op_sel_hi:[0,1,1] neg_lo:[1,0,0]
  v_cvt_pk_bf16_f32 v20, v8, -v9
  v_cvt_pk_bf16_f32 v21, v10, -v11
  ds_write_b64 v7, v[20:21] offset:7392
  v_pk_mul_f32 v[16:17], v[56:57], v[52:53] op_sel:[0,0] op_sel_hi:[1,0]
  v_pk_mul_f32 v[18:19], v[58:59], v[54:55] op_sel:[0,0] op_sel_hi:[1,0]
  v_pk_fma_f32 v[56:57], v[56:57], v[52:53], v[16:17] op_sel:[1,1,0] op_sel_hi:[0,1,1] neg_lo:[1,0,0]
  v_pk_fma_f32 v[58:59], v[58:59], v[54:55], v[18:19] op_sel:[1,1,0] op_sel_hi:[0,1,1] neg_lo:[1,0,0]
  v_cvt_pk_bf16_f32 v22, v56, -v57
  v_cvt_pk_bf16_f32 v23, v58, -v59
  ds_write_b64 v7, v[22:23] offset:8448
  v_pk_mul_f32 v[16:17], v[56:57], v[44:45] op_sel:[0,0] op_sel_hi:[1,0]
  v_pk_mul_f32 v[18:19], v[58:59], v[46:47] op_sel:[0,0] op_sel_hi:[1,0]
  v_pk_fma_f32 v[8:9], v[56:57], v[44:45], v[16:17] op_sel:[1,1,0] op_sel_hi:[0,1,1] neg_lo:[1,0,0]
  v_pk_fma_f32 v[10:11], v[58:59], v[46:47], v[18:19] op_sel:[1,1,0] op_sel_hi:[0,1,1] neg_lo:[1,0,0]
  v_cvt_pk_bf16_f32 v20, v8, -v9
  v_cvt_pk_bf16_f32 v21, v10, -v11
  ds_write_b64 v7, v[20:21] offset:8976
  ds_write_b64 v7, v[20:21] offset:10560
  v_pk_mul_f32 v[16:17], v[8:9], v[44:45] op_sel:[0,0] op_sel_hi:[1,0]
  v_pk_mul_f32 v[18:19], v[10:11], v[46:47] op_sel:[0,0] op_sel_hi:[1,0]
  v_pk_fma_f32 v[8:9], v[8:9], v[44:45], v[16:17] op_sel:[1,1,0] op_sel_hi:[0,1,1] neg_lo:[1,0,0]
  v_pk_fma_f32 v[10:11], v[10:11], v[46:47], v[18:19] op_sel:[1,1,0] op_sel_hi:[0,1,1] neg_lo:[1,0,0]
  v_cvt_pk_bf16_f32 v22, v8, -v9
  v_cvt_pk_bf16_f32 v23, v10, -v11
  ds_write_b64 v7, v[22:23] offset:11088
  v_pk_mul_f32 v[16:17], v[56:57], v[52:53] op_sel:[0,0] op_sel_hi:[1,0]
  v_pk_mul_f32 v[18:19], v[58:59], v[54:55] op_sel:[0,0] op_sel_hi:[1,0]
  v_pk_fma_f32 v[56:57], v[56:57], v[52:53], v[16:17] op_sel:[1,1,0] op_sel_hi:[0,1,1] neg_lo:[1,0,0]
  v_pk_fma_f32 v[58:59], v[58:59], v[54:55], v[18:19] op_sel:[1,1,0] op_sel_hi:[0,1,1] neg_lo:[1,0,0]
  v_cvt_pk_bf16_f32 v20, v56, -v57
  v_cvt_pk_bf16_f32 v21, v58, -v59
  ds_write_b64 v7, v[20:21] offset:9504
  v_pk_mul_f32 v[16:17], v[56:57], v[44:45] op_sel:[0,0] op_sel_hi:[1,0]
  v_pk_mul_f32 v[18:19], v[58:59], v[46:47] op_sel:[0,0] op_sel_hi:[1,0]
  v_pk_fma_f32 v[8:9], v[56:57], v[44:45], v[16:17] op_sel:[1,1,0] op_sel_hi:[0,1,1] neg_lo:[1,0,0]
  v_pk_fma_f32 v[10:11], v[58:59], v[46:47], v[18:19] op_sel:[1,1,0] op_sel_hi:[0,1,1] neg_lo:[1,0,0]
  v_cvt_pk_bf16_f32 v22, v8, -v9
  v_cvt_pk_bf16_f32 v23, v10, -v11
  ds_write_b64 v7, v[22:23] offset:10032
  ds_write_b64 v7, v[22:23] offset:11616
  v_pk_mul_f32 v[16:17], v[8:9], v[44:45] op_sel:[0,0] op_sel_hi:[1,0]
  v_pk_mul_f32 v[18:19], v[10:11], v[46:47] op_sel:[0,0] op_sel_hi:[1,0]
  v_pk_fma_f32 v[8:9], v[8:9], v[44:45], v[16:17] op_sel:[1,1,0] op_sel_hi:[0,1,1] neg_lo:[1,0,0]
  v_pk_fma_f32 v[10:11], v[10:11], v[46:47], v[18:19] op_sel:[1,1,0] op_sel_hi:[0,1,1] neg_lo:[1,0,0]
  v_cvt_pk_bf16_f32 v20, v8, -v9
  v_cvt_pk_bf16_f32 v21, v10, -v11
  ds_write_b64 v7, v[20:21] offset:12144
  v_pk_mul_f32 v[16:17], v[56:57], v[52:53] op_sel:[0,0] op_sel_hi:[1,0]
  v_pk_mul_f32 v[18:19], v[58:59], v[54:55] op_sel:[0,0] op_sel_hi:[1,0]
  v_pk_fma_f32 v[56:57], v[56:57], v[52:53], v[16:17] op_sel:[1,1,0] op_sel_hi:[0,1,1] neg_lo:[1,0,0]
  v_pk_fma_f32 v[58:59], v[58:59], v[54:55], v[18:19] op_sel:[1,1,0] op_sel_hi:[0,1,1] neg_lo:[1,0,0]
  v_cvt_pk_bf16_f32 v22, v56, -v57
  v_cvt_pk_bf16_f32 v23, v58, -v59
  ds_write_b64 v7, v[22:23] offset:12672
  v_pk_mul_f32 v[16:17], v[56:57], v[48:49] op_sel:[0,0] op_sel_hi:[1,0]
  v_pk_mul_f32 v[18:19], v[58:59], v[50:51] op_sel:[0,0] op_sel_hi:[1,0]
  v_pk_fma_f32 v[8:9], v[56:57], v[48:49], v[16:17] op_sel:[1,1,0] op_sel_hi:[0,1,1] neg_lo:[1,0,0]
  v_pk_fma_f32 v[10:11], v[58:59], v[50:51], v[18:19] op_sel:[1,1,0] op_sel_hi:[0,1,1] neg_lo:[1,0,0]
  v_cvt_pk_bf16_f32 v20, v8, -v9
  v_cvt_pk_bf16_f32 v21, v10, -v11
  ds_write_b64 v7, v[20:21] offset:13200
  v_pk_mul_f32 v[16:17], v[56:57], v[52:53] op_sel:[0,0] op_sel_hi:[1,0]
  v_pk_mul_f32 v[18:19], v[58:59], v[54:55] op_sel:[0,0] op_sel_hi:[1,0]
  v_pk_fma_f32 v[56:57], v[56:57], v[52:53], v[16:17] op_sel:[1,1,0] op_sel_hi:[0,1,1] neg_lo:[1,0,0]
  v_pk_fma_f32 v[58:59], v[58:59], v[54:55], v[18:19] op_sel:[1,1,0] op_sel_hi:[0,1,1] neg_lo:[1,0,0]
  v_cvt_pk_bf16_f32 v22, v56, -v57
  v_cvt_pk_bf16_f32 v23, v58, -v59
  ds_write_b64 v7, v[22:23] offset:13728
  v_pk_mul_f32 v[16:17], v[56:57], v[48:49] op_sel:[0,0] op_sel_hi:[1,0]
  v_pk_mul_f32 v[18:19], v[58:59], v[50:51] op_sel:[0,0] op_sel_hi:[1,0]
  v_pk_fma_f32 v[8:9], v[56:57], v[48:49], v[16:17] op_sel:[1,1,0] op_sel_hi:[0,1,1] neg_lo:[1,0,0]
  v_pk_fma_f32 v[10:11], v[58:59], v[50:51], v[18:19] op_sel:[1,1,0] op_sel_hi:[0,1,1] neg_lo:[1,0,0]
  v_cvt_pk_bf16_f32 v20, v8, -v9
  v_cvt_pk_bf16_f32 v21, v10, -v11
  ds_write_b64 v7, v[20:21] offset:14256
  v_pk_mul_f32 v[16:17], v[56:57], v[52:53] op_sel:[0,0] op_sel_hi:[1,0]
  v_pk_mul_f32 v[18:19], v[58:59], v[54:55] op_sel:[0,0] op_sel_hi:[1,0]
  v_pk_fma_f32 v[56:57], v[56:57], v[52:53], v[16:17] op_sel:[1,1,0] op_sel_hi:[0,1,1] neg_lo:[1,0,0]
  v_pk_fma_f32 v[58:59], v[58:59], v[54:55], v[18:19] op_sel:[1,1,0] op_sel_hi:[0,1,1] neg_lo:[1,0,0]
  v_cvt_pk_bf16_f32 v22, v56, -v57
  v_cvt_pk_bf16_f32 v23, v58, -v59
  ds_write_b64 v7, v[22:23] offset:14784
  v_pk_mul_f32 v[16:17], v[56:57], v[48:49] op_sel:[0,0] op_sel_hi:[1,0]
  v_pk_mul_f32 v[18:19], v[58:59], v[50:51] op_sel:[0,0] op_sel_hi:[1,0]
  v_pk_fma_f32 v[8:9], v[56:57], v[48:49], v[16:17] op_sel:[1,1,0] op_sel_hi:[0,1,1] neg_lo:[1,0,0]
  v_pk_fma_f32 v[10:11], v[58:59], v[50:51], v[18:19] op_sel:[1,1,0] op_sel_hi:[0,1,1] neg_lo:[1,0,0]
  v_cvt_pk_bf16_f32 v20, v8, -v9
  v_cvt_pk_bf16_f32 v21, v10, -v11
  ds_write_b64 v7, v[20:21] offset:15312
  v_pk_mul_f32 v[16:17], v[56:57], v[52:53] op_sel:[0,0] op_sel_hi:[1,0]
  v_pk_mul_f32 v[18:19], v[58:59], v[54:55] op_sel:[0,0] op_sel_hi:[1,0]
  v_pk_fma_f32 v[56:57], v[56:57], v[52:53], v[16:17] op_sel:[1,1,0] op_sel_hi:[0,1,1] neg_lo:[1,0,0]
  v_pk_fma_f32 v[58:59], v[58:59], v[54:55], v[18:19] op_sel:[1,1,0] op_sel_hi:[0,1,1] neg_lo:[1,0,0]
  v_cvt_pk_bf16_f32 v22, v56, -v57
  v_cvt_pk_bf16_f32 v23, v58, -v59
  ds_write_b64 v7, v[22:23] offset:15840
  v_pk_mul_f32 v[16:17], v[56:57], v[48:49] op_sel:[0,0] op_sel_hi:[1,0]
  v_pk_mul_f32 v[18:19], v[58:59], v[50:51] op_sel:[0,0] op_sel_hi:[1,0]
  v_pk_fma_f32 v[8:9], v[56:57], v[48:49], v[16:17] op_sel:[1,1,0] op_sel_hi:[0,1,1] neg_lo:[1,0,0]
  v_pk_fma_f32 v[10:11], v[58:59], v[50:51], v[18:19] op_sel:[1,1,0] op_sel_hi:[0,1,1] neg_lo:[1,0,0]
  v_cvt_pk_bf16_f32 v20, v8, -v9
  v_cvt_pk_bf16_f32 v21, v10, -v11
  ds_write_b64 v7, v[20:21] offset:16368
  v_mov_b32 v20, 0x3f80
  v_mov_b32 v21, 0x3f80
  ds_write_b64 v7, v[20:21] offset:16896
  v_cvt_pk_bf16_f32 v22, v48, v49
  v_cvt_pk_bf16_f32 v23, v50, v51
  ds_write_b64 v7, v[22:23] offset:17424
  v_pk_mul_f32 v[16:17], v[48:49], v[48:49] op_sel:[0,0] op_sel_hi:[1,0]
  v_pk_mul_f32 v[18:19], v[50:51], v[50:51] op_sel:[0,0] op_sel_hi:[1,0]
  v_pk_fma_f32 v[8:9], v[48:49], v[48:49], v[16:17] op_sel:[1,1,0] op_sel_hi:[0,1,1] neg_lo:[1,0,0]
  v_pk_fma_f32 v[10:11], v[50:51], v[50:51], v[18:19] op_sel:[1,1,0] op_sel_hi:[0,1,1] neg_lo:[1,0,0]
  v_cvt_pk_bf16_f32 v20, v8, v9
  v_cvt_pk_bf16_f32 v21, v10, v11
  ds_write_b64 v7, v[20:21] offset:17952
  v_pk_mul_f32 v[16:17], v[8:9], v[48:49] op_sel:[0,0] op_sel_hi:[1,0]
  v_pk_mul_f32 v[18:19], v[10:11], v[50:51] op_sel:[0,0] op_sel_hi:[1,0]
  v_pk_fma_f32 v[8:9], v[8:9], v[48:49], v[16:17] op_sel:[1,1,0] op_sel_hi:[0,1,1] neg_lo:[1,0,0]
  v_pk_fma_f32 v[10:11], v[10:11], v[50:51], v[18:19] op_sel:[1,1,0] op_sel_hi:[0,1,1] neg_lo:[1,0,0]
  v_cvt_pk_bf16_f32 v22, v8, v9
  v_cvt_pk_bf16_f32 v23, v10, v11
  ds_write_b64 v7, v[22:23] offset:18480
  v_pk_mul_f32 v[16:17], v[8:9], v[48:49] op_sel:[0,0] op_sel_hi:[1,0]
  v_pk_mul_f32 v[18:19], v[10:11], v[50:51] op_sel:[0,0] op_sel_hi:[1,0]
  v_pk_fma_f32 v[8:9], v[8:9], v[48:49], v[16:17] op_sel:[1,1,0] op_sel_hi:[0,1,1] neg_lo:[1,0,0]
  v_pk_fma_f32 v[10:11], v[10:11], v[50:51], v[18:19] op_sel:[1,1,0] op_sel_hi:[0,1,1] neg_lo:[1,0,0]
  v_cvt_pk_bf16_f32 v20, v8, v9
  v_cvt_pk_bf16_f32 v21, v10, v11
  ds_write_b64 v7, v[20:21] offset:19008
  v_pk_mul_f32 v[16:17], v[8:9], v[48:49] op_sel:[0,0] op_sel_hi:[1,0]
  v_pk_mul_f32 v[18:19], v[10:11], v[50:51] op_sel:[0,0] op_sel_hi:[1,0]
  v_pk_fma_f32 v[8:9], v[8:9], v[48:49], v[16:17] op_sel:[1,1,0] op_sel_hi:[0,1,1] neg_lo:[1,0,0]
  v_pk_fma_f32 v[10:11], v[10:11], v[50:51], v[18:19] op_sel:[1,1,0] op_sel_hi:[0,1,1] neg_lo:[1,0,0]
  v_cvt_pk_bf16_f32 v22, v8, v9
  v_cvt_pk_bf16_f32 v23, v10, v11
  ds_write_b64 v7, v[22:23] offset:19536
  v_pk_mul_f32 v[16:17], v[8:9], v[48:49] op_sel:[0,0] op_sel_hi:[1,0]
  v_pk_mul_f32 v[18:19], v[10:11], v[50:51] op_sel:[0,0] op_sel_hi:[1,0]
  v_pk_fma_f32 v[8:9], v[8:9], v[48:49], v[16:17] op_sel:[1,1,0] op_sel_hi:[0,1,1] neg_lo:[1,0,0]
  v_pk_fma_f32 v[10:11], v[10:11], v[50:51], v[18:19] op_sel:[1,1,0] op_sel_hi:[0,1,1] neg_lo:[1,0,0]
  v_cvt_pk_bf16_f32 v20, v8, v9
  v_cvt_pk_bf16_f32 v21, v10, v11
  ds_write_b64 v7, v[20:21] offset:20064
  v_pk_mul_f32 v[16:17], v[8:9], v[48:49] op_sel:[0,0] op_sel_hi:[1,0]
  v_pk_mul_f32 v[18:19], v[10:11], v[50:51] op_sel:[0,0] op_sel_hi:[1,0]
  v_pk_fma_f32 v[8:9], v[8:9], v[48:49], v[16:17] op_sel:[1,1,0] op_sel_hi:[0,1,1] neg_lo:[1,0,0]
  v_pk_fma_f32 v[10:11], v[10:11], v[50:51], v[18:19] op_sel:[1,1,0] op_sel_hi:[0,1,1] neg_lo:[1,0,0]
  v_cvt_pk_bf16_f32 v22, v8, v9
  v_cvt_pk_bf16_f32 v23, v10, v11
  ds_write_b64 v7, v[22:23] offset:20592
  v_pk_mul_f32 v[16:17], v[8:9], v[48:49] op_sel:[0,0] op_sel_hi:[1,0]
  v_pk_mul_f32 v[18:19], v[10:11], v[50:51] op_sel:[0,0] op_sel_hi:[1,0]
  v_pk_fma_f32 v[8:9], v[8:9], v[48:49], v[16:17] op_sel:[1,1,0] op_sel_hi:[0,1,1] neg_lo:[1,0,0]
  v_pk_fma_f32 v[10:11], v[10:11], v[50:51], v[18:19] op_sel:[1,1,0] op_sel_hi:[0,1,1] neg_lo:[1,0,0]
  v_cvt_pk_bf16_f32 v20, v8, v9
  v_cvt_pk_bf16_f32 v21, v10, v11
  ds_write_b64 v7, v[20:21] offset:21120
  v_pk_mul_f32 v[16:17], v[8:9], v[48:49] op_sel:[0,0] op_sel_hi:[1,0]
  v_pk_mul_f32 v[18:19], v[10:11], v[50:51] op_sel:[0,0] op_sel_hi:[1,0]
  v_pk_fma_f32 v[8:9], v[8:9], v[48:49], v[16:17] op_sel:[1,1,0] op_sel_hi:[0,1,1] neg_lo:[1,0,0]
  v_pk_fma_f32 v[10:11], v[10:11], v[50:51], v[18:19] op_sel:[1,1,0] op_sel_hi:[0,1,1] neg_lo:[1,0,0]
  v_cvt_pk_bf16_f32 v22, v8, v9
  v_cvt_pk_bf16_f32 v23, v10, v11
  ds_write_b64 v7, v[22:23] offset:21648
  v_pk_mul_f32 v[16:17], v[8:9], v[48:49] op_sel:[0,0] op_sel_hi:[1,0]
  v_pk_mul_f32 v[18:19], v[10:11], v[50:51] op_sel:[0,0] op_sel_hi:[1,0]
  v_pk_fma_f32 v[8:9], v[8:9], v[48:49], v[16:17] op_sel:[1,1,0] op_sel_hi:[0,1,1] neg_lo:[1,0,0]
  v_pk_fma_f32 v[10:11], v[10:11], v[50:51], v[18:19] op_sel:[1,1,0] op_sel_hi:[0,1,1] neg_lo:[1,0,0]
  v_cvt_pk_bf16_f32 v20, v8, v9
  v_cvt_pk_bf16_f32 v21, v10, v11
  ds_write_b64 v7, v[20:21] offset:22176
  v_pk_mul_f32 v[16:17], v[8:9], v[48:49] op_sel:[0,0] op_sel_hi:[1,0]
  v_pk_mul_f32 v[18:19], v[10:11], v[50:51] op_sel:[0,0] op_sel_hi:[1,0]
  v_pk_fma_f32 v[8:9], v[8:9], v[48:49], v[16:17] op_sel:[1,1,0] op_sel_hi:[0,1,1] neg_lo:[1,0,0]
  v_pk_fma_f32 v[10:11], v[10:11], v[50:51], v[18:19] op_sel:[1,1,0] op_sel_hi:[0,1,1] neg_lo:[1,0,0]
  v_cvt_pk_bf16_f32 v22, v8, v9
  v_cvt_pk_bf16_f32 v23, v10, v11
  ds_write_b64 v7, v[22:23] offset:22704
  v_pk_mul_f32 v[16:17], v[8:9], v[48:49] op_sel:[0,0] op_sel_hi:[1,0]
  v_pk_mul_f32 v[18:19], v[10:11], v[50:51] op_sel:[0,0] op_sel_hi:[1,0]
  v_pk_fma_f32 v[8:9], v[8:9], v[48:49], v[16:17] op_sel:[1,1,0] op_sel_hi:[0,1,1] neg_lo:[1,0,0]
  v_pk_fma_f32 v[10:11], v[10:11], v[50:51], v[18:19] op_sel:[1,1,0] op_sel_hi:[0,1,1] neg_lo:[1,0,0]
  v_cvt_pk_bf16_f32 v20, v8, v9
  v_cvt_pk_bf16_f32 v21, v10, v11
  ds_write_b64 v7, v[20:21] offset:23232
  v_pk_mul_f32 v[16:17], v[8:9], v[48:49] op_sel:[0,0] op_sel_hi:[1,0]
  v_pk_mul_f32 v[18:19], v[10:11], v[50:51] op_sel:[0,0] op_sel_hi:[1,0]
  v_pk_fma_f32 v[8:9], v[8:9], v[48:49], v[16:17] op_sel:[1,1,0] op_sel_hi:[0,1,1] neg_lo:[1,0,0]
  v_pk_fma_f32 v[10:11], v[10:11], v[50:51], v[18:19] op_sel:[1,1,0] op_sel_hi:[0,1,1] neg_lo:[1,0,0]
  v_cvt_pk_bf16_f32 v22, v8, v9
  v_cvt_pk_bf16_f32 v23, v10, v11
  ds_write_b64 v7, v[22:23] offset:23760
  v_pk_mul_f32 v[16:17], v[8:9], v[48:49] op_sel:[0,0] op_sel_hi:[1,0]
  v_pk_mul_f32 v[18:19], v[10:11], v[50:51] op_sel:[0,0] op_sel_hi:[1,0]
  v_pk_fma_f32 v[8:9], v[8:9], v[48:49], v[16:17] op_sel:[1,1,0] op_sel_hi:[0,1,1] neg_lo:[1,0,0]
  v_pk_fma_f32 v[10:11], v[10:11], v[50:51], v[18:19] op_sel:[1,1,0] op_sel_hi:[0,1,1] neg_lo:[1,0,0]
  v_cvt_pk_bf16_f32 v20, v8, v9
  v_cvt_pk_bf16_f32 v21, v10, v11
  ds_write_b64 v7, v[20:21] offset:24288
  v_pk_mul_f32 v[16:17], v[8:9], v[48:49] op_sel:[0,0] op_sel_hi:[1,0]
  v_pk_mul_f32 v[18:19], v[10:11], v[50:51] op_sel:[0,0] op_sel_hi:[1,0]
  v_pk_fma_f32 v[8:9], v[8:9], v[48:49], v[16:17] op_sel:[1,1,0] op_sel_hi:[0,1,1] neg_lo:[1,0,0]
  v_pk_fma_f32 v[10:11], v[10:11], v[50:51], v[18:19] op_sel:[1,1,0] op_sel_hi:[0,1,1] neg_lo:[1,0,0]
  v_cvt_pk_bf16_f32 v22, v8, v9
  v_cvt_pk_bf16_f32 v23, v10, v11
  ds_write_b64 v7, v[22:23] offset:24816
  v_pk_mul_f32 v[16:17], v[8:9], v[48:49] op_sel:[0,0] op_sel_hi:[1,0]
  v_pk_mul_f32 v[18:19], v[10:11], v[50:51] op_sel:[0,0] op_sel_hi:[1,0]
  v_pk_fma_f32 v[8:9], v[8:9], v[48:49], v[16:17] op_sel:[1,1,0] op_sel_hi:[0,1,1] neg_lo:[1,0,0]
  v_pk_fma_f32 v[10:11], v[10:11], v[50:51], v[18:19] op_sel:[1,1,0] op_sel_hi:[0,1,1] neg_lo:[1,0,0]
  v_cvt_pk_bf16_f32 v20, v8, v9
  v_cvt_pk_bf16_f32 v21, v10, v11
  ds_write_b64 v7, v[20:21] offset:25344
  v_pk_mul_f32 v[16:17], v[8:9], v[48:49] op_sel:[0,0] op_sel_hi:[1,0]
  v_pk_mul_f32 v[18:19], v[10:11], v[50:51] op_sel:[0,0] op_sel_hi:[1,0]
  v_pk_fma_f32 v[8:9], v[8:9], v[48:49], v[16:17] op_sel:[1,1,0] op_sel_hi:[0,1,1] neg_lo:[1,0,0]
  v_pk_fma_f32 v[10:11], v[10:11], v[50:51], v[18:19] op_sel:[1,1,0] op_sel_hi:[0,1,1] neg_lo:[1,0,0]
  v_cvt_pk_bf16_f32 v22, v8, v9
  v_cvt_pk_bf16_f32 v23, v10, v11
  ds_write_b64 v7, v[22:23] offset:25872
  v_pk_mul_f32 v[16:17], v[8:9], v[48:49] op_sel:[0,0] op_sel_hi:[1,0]
  v_pk_mul_f32 v[18:19], v[10:11], v[50:51] op_sel:[0,0] op_sel_hi:[1,0]
  v_pk_fma_f32 v[8:9], v[8:9], v[48:49], v[16:17] op_sel:[1,1,0] op_sel_hi:[0,1,1] neg_lo:[1,0,0]
  v_pk_fma_f32 v[10:11], v[10:11], v[50:51], v[18:19] op_sel:[1,1,0] op_sel_hi:[0,1,1] neg_lo:[1,0,0]
  v_cvt_pk_bf16_f32 v20, v8, v9
  v_cvt_pk_bf16_f32 v21, v10, v11
  ds_write_b64 v7, v[20:21] offset:26400
  v_pk_mul_f32 v[16:17], v[8:9], v[48:49] op_sel:[0,0] op_sel_hi:[1,0]
  v_pk_mul_f32 v[18:19], v[10:11], v[50:51] op_sel:[0,0] op_sel_hi:[1,0]
  v_pk_fma_f32 v[8:9], v[8:9], v[48:49], v[16:17] op_sel:[1,1,0] op_sel_hi:[0,1,1] neg_lo:[1,0,0]
  v_pk_fma_f32 v[10:11], v[10:11], v[50:51], v[18:19] op_sel:[1,1,0] op_sel_hi:[0,1,1] neg_lo:[1,0,0]
  v_cvt_pk_bf16_f32 v22, v8, v9
  v_cvt_pk_bf16_f32 v23, v10, v11
  ds_write_b64 v7, v[22:23] offset:26928
  v_pk_mul_f32 v[16:17], v[8:9], v[48:49] op_sel:[0,0] op_sel_hi:[1,0]
  v_pk_mul_f32 v[18:19], v[10:11], v[50:51] op_sel:[0,0] op_sel_hi:[1,0]
  v_pk_fma_f32 v[8:9], v[8:9], v[48:49], v[16:17] op_sel:[1,1,0] op_sel_hi:[0,1,1] neg_lo:[1,0,0]
  v_pk_fma_f32 v[10:11], v[10:11], v[50:51], v[18:19] op_sel:[1,1,0] op_sel_hi:[0,1,1] neg_lo:[1,0,0]
  v_cvt_pk_bf16_f32 v20, v8, v9
  v_cvt_pk_bf16_f32 v21, v10, v11
  ds_write_b64 v7, v[20:21] offset:27456
  v_pk_mul_f32 v[16:17], v[8:9], v[48:49] op_sel:[0,0] op_sel_hi:[1,0]
  v_pk_mul_f32 v[18:19], v[10:11], v[50:51] op_sel:[0,0] op_sel_hi:[1,0]
  v_pk_fma_f32 v[8:9], v[8:9], v[48:49], v[16:17] op_sel:[1,1,0] op_sel_hi:[0,1,1] neg_lo:[1,0,0]
  v_pk_fma_f32 v[10:11], v[10:11], v[50:51], v[18:19] op_sel:[1,1,0] op_sel_hi:[0,1,1] neg_lo:[1,0,0]
  v_cvt_pk_bf16_f32 v22, v8, v9
  v_cvt_pk_bf16_f32 v23, v10, v11
  ds_write_b64 v7, v[22:23] offset:27984
  v_pk_mul_f32 v[16:17], v[8:9], v[48:49] op_sel:[0,0] op_sel_hi:[1,0]
  v_pk_mul_f32 v[18:19], v[10:11], v[50:51] op_sel:[0,0] op_sel_hi:[1,0]
  v_pk_fma_f32 v[8:9], v[8:9], v[48:49], v[16:17] op_sel:[1,1,0] op_sel_hi:[0,1,1] neg_lo:[1,0,0]
  v_pk_fma_f32 v[10:11], v[10:11], v[50:51], v[18:19] op_sel:[1,1,0] op_sel_hi:[0,1,1] neg_lo:[1,0,0]
  v_cvt_pk_bf16_f32 v20, v8, v9
  v_cvt_pk_bf16_f32 v21, v10, v11
  ds_write_b64 v7, v[20:21] offset:28512
  v_pk_mul_f32 v[16:17], v[8:9], v[48:49] op_sel:[0,0] op_sel_hi:[1,0]
  v_pk_mul_f32 v[18:19], v[10:11], v[50:51] op_sel:[0,0] op_sel_hi:[1,0]
  v_pk_fma_f32 v[8:9], v[8:9], v[48:49], v[16:17] op_sel:[1,1,0] op_sel_hi:[0,1,1] neg_lo:[1,0,0]
  v_pk_fma_f32 v[10:11], v[10:11], v[50:51], v[18:19] op_sel:[1,1,0] op_sel_hi:[0,1,1] neg_lo:[1,0,0]
  v_cvt_pk_bf16_f32 v22, v8, v9
  v_cvt_pk_bf16_f32 v23, v10, v11
  ds_write_b64 v7, v[22:23] offset:29040
  v_pk_mul_f32 v[16:17], v[8:9], v[48:49] op_sel:[0,0] op_sel_hi:[1,0]
  v_pk_mul_f32 v[18:19], v[10:11], v[50:51] op_sel:[0,0] op_sel_hi:[1,0]
  v_pk_fma_f32 v[8:9], v[8:9], v[48:49], v[16:17] op_sel:[1,1,0] op_sel_hi:[0,1,1] neg_lo:[1,0,0]
  v_pk_fma_f32 v[10:11], v[10:11], v[50:51], v[18:19] op_sel:[1,1,0] op_sel_hi:[0,1,1] neg_lo:[1,0,0]
  v_cvt_pk_bf16_f32 v20, v8, v9
  v_cvt_pk_bf16_f32 v21, v10, v11
  ds_write_b64 v7, v[20:21] offset:29568
  v_pk_mul_f32 v[16:17], v[8:9], v[48:49] op_sel:[0,0] op_sel_hi:[1,0]
  v_pk_mul_f32 v[18:19], v[10:11], v[50:51] op_sel:[0,0] op_sel_hi:[1,0]
  v_pk_fma_f32 v[8:9], v[8:9], v[48:49], v[16:17] op_sel:[1,1,0] op_sel_hi:[0,1,1] neg_lo:[1,0,0]
  v_pk_fma_f32 v[10:11], v[10:11], v[50:51], v[18:19] op_sel:[1,1,0] op_sel_hi:[0,1,1] neg_lo:[1,0,0]
  v_cvt_pk_bf16_f32 v22, v8, v9
  v_cvt_pk_bf16_f32 v23, v10, v11
  ds_write_b64 v7, v[22:23] offset:30096
  v_pk_mul_f32 v[16:17], v[8:9], v[48:49] op_sel:[0,0] op_sel_hi:[1,0]
  v_pk_mul_f32 v[18:19], v[10:11], v[50:51] op_sel:[0,0] op_sel_hi:[1,0]
  v_pk_fma_f32 v[8:9], v[8:9], v[48:49], v[16:17] op_sel:[1,1,0] op_sel_hi:[0,1,1] neg_lo:[1,0,0]
  v_pk_fma_f32 v[10:11], v[10:11], v[50:51], v[18:19] op_sel:[1,1,0] op_sel_hi:[0,1,1] neg_lo:[1,0,0]
  v_cvt_pk_bf16_f32 v20, v8, v9
  v_cvt_pk_bf16_f32 v21, v10, v11
  ds_write_b64 v7, v[20:21] offset:30624
  v_pk_mul_f32 v[16:17], v[8:9], v[48:49] op_sel:[0,0] op_sel_hi:[1,0]
  v_pk_mul_f32 v[18:19], v[10:11], v[50:51] op_sel:[0,0] op_sel_hi:[1,0]
  v_pk_fma_f32 v[8:9], v[8:9], v[48:49], v[16:17] op_sel:[1,1,0] op_sel_hi:[0,1,1] neg_lo:[1,0,0]
  v_pk_fma_f32 v[10:11], v[10:11], v[50:51], v[18:19] op_sel:[1,1,0] op_sel_hi:[0,1,1] neg_lo:[1,0,0]
  v_cvt_pk_bf16_f32 v22, v8, v9
  v_cvt_pk_bf16_f32 v23, v10, v11
  ds_write_b64 v7, v[22:23] offset:31152
  v_pk_mul_f32 v[16:17], v[8:9], v[48:49] op_sel:[0,0] op_sel_hi:[1,0]
  v_pk_mul_f32 v[18:19], v[10:11], v[50:51] op_sel:[0,0] op_sel_hi:[1,0]
  v_pk_fma_f32 v[8:9], v[8:9], v[48:49], v[16:17] op_sel:[1,1,0] op_sel_hi:[0,1,1] neg_lo:[1,0,0]
  v_pk_fma_f32 v[10:11], v[10:11], v[50:51], v[18:19] op_sel:[1,1,0] op_sel_hi:[0,1,1] neg_lo:[1,0,0]
  v_cvt_pk_bf16_f32 v20, v8, v9
  v_cvt_pk_bf16_f32 v21, v10, v11
  ds_write_b64 v7, v[20:21] offset:31680
  v_pk_mul_f32 v[16:17], v[8:9], v[48:49] op_sel:[0,0] op_sel_hi:[1,0]
  v_pk_mul_f32 v[18:19], v[10:11], v[50:51] op_sel:[0,0] op_sel_hi:[1,0]
  v_pk_fma_f32 v[8:9], v[8:9], v[48:49], v[16:17] op_sel:[1,1,0] op_sel_hi:[0,1,1] neg_lo:[1,0,0]
  v_pk_fma_f32 v[10:11], v[10:11], v[50:51], v[18:19] op_sel:[1,1,0] op_sel_hi:[0,1,1] neg_lo:[1,0,0]
  v_cvt_pk_bf16_f32 v22, v8, v9
  v_cvt_pk_bf16_f32 v23, v10, v11
  ds_write_b64 v7, v[22:23] offset:32208
  v_pk_mul_f32 v[16:17], v[8:9], v[48:49] op_sel:[0,0] op_sel_hi:[1,0]
  v_pk_mul_f32 v[18:19], v[10:11], v[50:51] op_sel:[0,0] op_sel_hi:[1,0]
  v_pk_fma_f32 v[8:9], v[8:9], v[48:49], v[16:17] op_sel:[1,1,0] op_sel_hi:[0,1,1] neg_lo:[1,0,0]
  v_pk_fma_f32 v[10:11], v[10:11], v[50:51], v[18:19] op_sel:[1,1,0] op_sel_hi:[0,1,1] neg_lo:[1,0,0]
  v_cvt_pk_bf16_f32 v20, v8, v9
  v_cvt_pk_bf16_f32 v21, v10, v11
  ds_write_b64 v7, v[20:21] offset:32736
  v_pk_mul_f32 v[16:17], v[8:9], v[48:49] op_sel:[0,0] op_sel_hi:[1,0]
  v_pk_mul_f32 v[18:19], v[10:11], v[50:51] op_sel:[0,0] op_sel_hi:[1,0]
  v_pk_fma_f32 v[8:9], v[8:9], v[48:49], v[16:17] op_sel:[1,1,0] op_sel_hi:[0,1,1] neg_lo:[1,0,0]
  v_pk_fma_f32 v[10:11], v[10:11], v[50:51], v[18:19] op_sel:[1,1,0] op_sel_hi:[0,1,1] neg_lo:[1,0,0]
  v_cvt_pk_bf16_f32 v22, v8, v9
  v_cvt_pk_bf16_f32 v23, v10, v11
  ds_write_b64 v7, v[22:23] offset:33264
  ds_read_b128 a[0:3], v24 offset:0
  ds_read_b128 a[4:7], v24 offset:16896
  ds_read_b128 a[8:11], v24 offset:32
  ds_read_b128 a[12:15], v24 offset:16928
  ds_read_b128 a[16:19], v24 offset:64
  ds_read_b128 a[20:23], v24 offset:16960
  ds_read_b128 a[24:27], v24 offset:96
  ds_read_b128 a[28:31], v24 offset:16992
  ds_read_b128 a[32:35], v24 offset:128
  ds_read_b128 a[36:39], v24 offset:17024
  ds_read_b128 a[40:43], v24 offset:160
  ds_read_b128 a[44:47], v24 offset:17056
  ds_read_b128 a[48:51], v24 offset:192
  ds_read_b128 a[52:55], v24 offset:17088
  s_waitcnt lgkmcnt(12)
  v_mfma_f32_32x32x16_bf16 v[96:111], a[0:3], a[4:7], 0
  ds_read_b128 a[56:59], v24 offset:224
  ds_read_b128 a[60:63], v24 offset:17120
  s_waitcnt lgkmcnt(12)
  v_mfma_f32_32x32x16_bf16 v[96:111], a[8:11], a[12:15], v[96:111]
  ds_read_b128 a[64:67], v24 offset:256
  ds_read_b128 a[68:71], v24 offset:17152
  s_waitcnt lgkmcnt(12)
  v_mfma_f32_32x32x16_bf16 v[96:111], a[16:19], a[20:23], v[96:111]
  ds_read_b128 a[72:75], v24 offset:288
  ds_read_b128 a[76:79], v24 offset:17184
  s_waitcnt lgkmcnt(12)
  v_mfma_f32_32x32x16_bf16 v[96:111], a[24:27], a[28:31], v[96:111]
  ds_read_b128 a[80:83], v24 offset:320
  ds_read_b128 a[84:87], v24 offset:17216
  s_waitcnt lgkmcnt(12)
  v_mfma_f32_32x32x16_bf16 v[96:111], a[32:35], a[36:39], v[96:111]
  ds_read_b128 a[88:91], v24 offset:352
  ds_read_b128 a[92:95], v24 offset:17248
  s_waitcnt lgkmcnt(12)
  v_mfma_f32_32x32x16_bf16 v[96:111], a[40:43], a[44:47], v[96:111]
  ds_read_b128 a[96:99], v24 offset:384
  ds_read_b128 a[100:103], v24 offset:17280
  s_waitcnt lgkmcnt(12)
  v_mfma_f32_32x32x16_bf16 v[96:111], a[48:51], a[52:55], v[96:111]
  ds_read_b128 a[104:107], v24 offset:416
  ds_read_b128 a[108:111], v24 offset:17312
  s_waitcnt lgkmcnt(12)
  v_mfma_f32_32x32x16_bf16 v[96:111], a[56:59], a[60:63], v[96:111]
  ds_read_b128 a[112:115], v24 offset:448
  ds_read_b128 a[116:119], v24 offset:17344
  s_waitcnt lgkmcnt(12)
  v_mfma_f32_32x32x16_bf16 v[96:111], a[64:67], a[68:71], v[96:111]
  ds_read_b128 a[120:123], v24 offset:480
  ds_read_b128 a[124:127], v24 offset:17376
  s_waitcnt lgkmcnt(12)
  v_mfma_f32_32x32x16_bf16 v[96:111], a[72:75], a[76:79], v[96:111]
  s_waitcnt lgkmcnt(10)
  v_mfma_f32_32x32x16_bf16 v[96:111], a[80:83], a[84:87], v[96:111]
  s_waitcnt lgkmcnt(8)
  v_mfma_f32_32x32x16_bf16 v[96:111], a[88:91], a[92:95], v[96:111]
  s_waitcnt lgkmcnt(6)
  v_mfma_f32_32x32x16_bf16 v[96:111], a[96:99], a[100:103], v[96:111]
  s_waitcnt lgkmcnt(4)
  v_mfma_f32_32x32x16_bf16 v[96:111], a[104:107], a[108:111], v[96:111]
  s_waitcnt lgkmcnt(2)
  v_mfma_f32_32x32x16_bf16 v[96:111], a[112:115], a[116:119], v[96:111]
  s_waitcnt lgkmcnt(0)
  v_mfma_f32_32x32x16_bf16 v[96:111], a[120:123], a[124:127], v[96:111]
  v_mov_b32 v20, 0
  v_min_u32 v21, 15, v2
  v_lshl_add_u32 v21, v21, 2, s19
  ds_write_b32 v21, v20
  ds_write_b32 v21, v20 offset:12416
  s_nop 6
  v_add_f32 v96, v96, v3
  v_cvt_pk_bf16_f32 v8, v96, v97
  v_cvt_pk_bf16_f32 v9, v98, v99
  ds_write_b64 v4, v[8:9] offset:64
  v_cvt_pk_bf16_f32 v10, v100, v100
  v_cvt_pk_bf16_f32 v11, v101, v102
  ds_write_b64 v4, v[10:11] offset:576
  v_cndmask_b32 v12, v104, v105, s[78:79]
  v_cvt_pk_bf16_f32 v8, v104, v104
  v_cvt_pk_bf16_f32 v9, v12, v105
  ds_write_b64 v4, v[8:9] offset:1088
  v_cndmask_b32 v12, v106, v107, s[78:79]
  v_cvt_pk_bf16_f32 v10, v106, v106
  v_cvt_pk_bf16_f32 v11, v12, v107
  ds_write_b64 v4, v[10:11] offset:1600
  v_cndmask_b32 v12, v108, v109, s[80:81]
  v_cvt_pk_bf16_f32 v16, v108, v108
  v_cvt_pk_bf16_f32 v17, v108, v108
  v_cvt_pk_bf16_f32 v18, v12, v109
  v_cvt_pk_bf16_f32 v19, v109, v109
  ds_write_b128 v5, v[16:19] offset:2112
  v_cndmask_b32 v12, v110, v111, s[80:81]
  v_cvt_pk_bf16_f32 v20, v110, v110
  v_cvt_pk_bf16_f32 v21, v110, v110
  v_cvt_pk_bf16_f32 v22, v12, v111
  v_cvt_pk_bf16_f32 v23, v111, v111
  ds_write_b128 v5, v[20:23] offset:2624
  ds_read_b64_tr_b16 a[0:1], v6 offset:32
  ds_read_b64_tr_b16 a[2:3], v6 offset:0
  ds_read_b64_tr_b16 a[4:5], v6 offset:160
  ds_read_b64_tr_b16 a[6:7], v6 offset:128
  ds_read_b64_tr_b16 a[8:9], v6 offset:288
  ds_read_b64_tr_b16 a[10:11], v6 offset:256
  ds_read_b64_tr_b16 a[12:13], v6 offset:416
  ds_read_b64_tr_b16 a[14:15], v6 offset:384
  ds_read_b64_tr_b16 a[16:17], v6 offset:544
  ds_read_b64_tr_b16 a[18:19], v6 offset:512
  ds_read_b64_tr_b16 a[20:21], v6 offset:672
  ds_read_b64_tr_b16 a[22:23], v6 offset:640
  ds_read_b64_tr_b16 a[24:25], v6 offset:800
  ds_read_b64_tr_b16 a[26:27], v6 offset:768
  ds_read_b64_tr_b16 a[28:29], v6 offset:928
  ds_read_b64_tr_b16 a[30:31], v6 offset:896
  v_mov_b32 v4, 154688
  v_mov_b32 v5, 1
  s_waitcnt lgkmcnt(0)
  s_barrier
  ds_read_b128 v[64:67], v25 offset:112
  ds_read_b128 v[68:71], v25 offset:80
  ds_read_b128 v[72:75], v25 offset:48
  ds_read_b128 v[76:79], v25 offset:16
  ds_read_b128 v[80:83], v25 offset:240
  ds_read_b128 v[84:87], v25 offset:208
  ds_read_b128 v[88:91], v25 offset:176
  s_waitcnt lgkmcnt(6)
  v_mfma_f32_32x32x16_bf16 v[96:111], a[0:3], v[64:67], 0
  ds_read_b128 v[92:95], v25 offset:144
  s_waitcnt lgkmcnt(6)
  v_mfma_f32_32x32x16_bf16 v[96:111], a[4:7], v[68:71], v[96:111]
  ds_read_b128 v[64:67], v25 offset:112
  s_waitcnt lgkmcnt(6)
  v_mfma_f32_32x32x16_bf16 v[96:111], a[8:11], v[72:75], v[96:111]
  ds_read_b128 v[68:71], v25 offset:80
  s_waitcnt lgkmcnt(6)
  v_mfma_f32_32x32x16_bf16 v[96:111], a[12:15], v[76:79], v[96:111]
  ds_read_b128 v[72:75], v25 offset:48
  s_waitcnt lgkmcnt(6)
  v_mfma_f32_32x32x16_bf16 v[112:127], a[0:3], v[80:83], 0
  ds_read_b128 v[76:79], v25 offset:16
  ds_read_b64_tr_b16 a[32:33], v6 offset:1056
  ds_read_b64_tr_b16 a[34:35], v6 offset:1024
  s_waitcnt lgkmcnt(8)
  v_mfma_f32_32x32x16_bf16 v[112:127], a[4:7], v[84:87], v[112:127]
  ds_read_b128 v[80:83], v25 offset:368
  s_waitcnt lgkmcnt(8)
  v_mfma_f32_32x32x16_bf16 v[112:127], a[8:11], v[88:91], v[112:127]
  ds_read_b128 v[84:87], v25 offset:336
  ds_read_b64_tr_b16 a[36:37], v6 offset:1184
  ds_read_b64_tr_b16 a[38:39], v6 offset:1152
  s_waitcnt lgkmcnt(10)
  v_mfma_f32_32x32x16_bf16 v[112:127], a[12:15], v[92:95], v[112:127]
  ds_read_b128 v[88:91], v25 offset:304
  s_waitcnt lgkmcnt(10)
  v_mfma_f32_32x32x16_bf16 v[112:127], a[16:19], v[64:67], v[112:127]
  ds_read_b128 v[92:95], v25 offset:272
  ds_read_b64_tr_b16 a[40:41], v6 offset:1312
  ds_read_b64_tr_b16 a[42:43], v6 offset:1280
  s_waitcnt lgkmcnt(12)
  v_mfma_f32_32x32x16_bf16 v[112:127], a[20:23], v[68:71], v[112:127]
  ds_read_b128 v[64:67], v25 offset:240
  v_fmac_f32_dpp v96, v97, v28 quad_perm:[3,0,1,2] row_mask:0xf bank_mask:0xf
  s_waitcnt lgkmcnt(12)
  v_mfma_f32_32x32x16_bf16 v[112:127], a[24:27], v[72:75], v[112:127]
  ds_read_b128 v[68:71], v25 offset:208
  ds_read_b64_tr_b16 a[44:45], v6 offset:1440
  ds_read_b64_tr_b16 a[46:47], v6 offset:1408
  s_waitcnt lgkmcnt(14)
  v_mfma_f32_32x32x16_bf16 v[112:127], a[28:31], v[76:79], v[112:127]
  ds_read_b128 v[72:75], v25 offset:176
  v_fmac_f32_dpp v100, v97, v31 quad_perm:[3,0,1,2] row_mask:0xf bank_mask:0xf
  s_waitcnt lgkmcnt(11)
  v_mfma_f32_32x32x16_bf16 v[32:47], a[0:3], v[80:83], 0
  ds_read_b128 v[76:79], v25 offset:144
  ds_read_b64_tr_b16 a[48:49], v6 offset:1568
  ds_read_b64_tr_b16 a[50:51], v6 offset:1536
  ds_read_b64_tr_b16 a[52:53], v6 offset:1696
  v_mfma_f32_32x32x16_bf16 v[32:47], a[4:7], v[84:87], v[32:47]
  ds_read_b128 v[80:83], v25 offset:112
  v_fmac_f32_dpp v96, v98, v29 quad_perm:[2,3,0,1] row_mask:0xf bank_mask:0xf
  v_fmac_f32_dpp v100, v98, v62 quad_perm:[2,3,0,1] row_mask:0xf bank_mask:0xf
  v_fmac_f32_dpp v96, v99, v30 quad_perm:[1,2,3,0] row_mask:0xf bank_mask:0xf
  s_waitcnt lgkmcnt(12)
  v_mfma_f32_32x32x16_bf16 v[32:47], a[8:11], v[88:91], v[32:47]
  ds_read_b128 v[84:87], v25 offset:80
  ds_read_b64_tr_b16 a[54:55], v6 offset:1664
  ds_read_b64_tr_b16 a[56:57], v6 offset:1824
  ds_read_b64_tr_b16 a[58:59], v6 offset:1792
  v_mfma_f32_32x32x16_bf16 v[32:47], a[12:15], v[92:95], v[32:47]
  ds_read_b128 v[88:91], v25 offset:48
  v_fmac_f32_dpp v100, v99, v63 quad_perm:[1,2,3,0] row_mask:0xf bank_mask:0xf
  v_fmac_f32_dpp v100, v101, v28 quad_perm:[3,0,1,2] row_mask:0xf bank_mask:0xf
  v_fmac_f32_dpp v104, v101, v31 quad_perm:[3,0,1,2] row_mask:0xf bank_mask:0xf
  s_waitcnt lgkmcnt(13)
  v_mfma_f32_32x32x16_bf16 v[32:47], a[16:19], v[64:67], v[32:47]
  ds_read_b128 v[92:95], v25 offset:16
  ds_read_b64_tr_b16 a[60:61], v6 offset:1952
  ds_read_b64_tr_b16 a[62:63], v6 offset:1920
  v_fmac_f32_dpp v100, v102, v29 quad_perm:[2,3,0,1] row_mask:0xf bank_mask:0xf
  v_mfma_f32_32x32x16_bf16 v[32:47], a[20:23], v[68:71], v[32:47]
  ds_read_b128 v[64:67], v25 offset:496
  v_fmac_f32_dpp v104, v102, v62 quad_perm:[2,3,0,1] row_mask:0xf bank_mask:0xf
  v_fmac_f32_dpp v100, v103, v30 quad_perm:[1,2,3,0] row_mask:0xf bank_mask:0xf
  v_fmac_f32_dpp v104, v103, v63 quad_perm:[1,2,3,0] row_mask:0xf bank_mask:0xf
  s_waitcnt lgkmcnt(13)
  v_mfma_f32_32x32x16_bf16 v[32:47], a[24:27], v[72:75], v[32:47]
  ds_read_b128 v[68:71], v25 offset:464
  ds_write2st64_b32 v26, v96, v100 offset0:0 offset1:4
  v_fmac_f32_dpp v104, v105, v28 quad_perm:[3,0,1,2] row_mask:0xf bank_mask:0xf
  v_fmac_f32_dpp v108, v105, v31 quad_perm:[3,0,1,2] row_mask:0xf bank_mask:0xf
  v_mfma_f32_32x32x16_bf16 v[32:47], a[28:31], v[76:79], v[32:47]
  ds_read_b128 v[72:75], v25 offset:432
  v_fmac_f32_dpp v104, v106, v29 quad_perm:[2,3,0,1] row_mask:0xf bank_mask:0xf
  v_fmac_f32_dpp v108, v106, v62 quad_perm:[2,3,0,1] row_mask:0xf bank_mask:0xf
  v_fmac_f32_dpp v104, v107, v30 quad_perm:[1,2,3,0] row_mask:0xf bank_mask:0xf
  s_waitcnt lgkmcnt(11)
  v_mfma_f32_32x32x16_bf16 v[32:47], a[32:35], v[80:83], v[32:47]
  ds_read_b128 v[76:79], v25 offset:400
  v_fmac_f32_dpp v108, v107, v63 quad_perm:[1,2,3,0] row_mask:0xf bank_mask:0xf
  v_fmac_f32_dpp v108, v109, v28 quad_perm:[3,0,1,2] row_mask:0xf bank_mask:0xf
  v_mul_f32_dpp v21, v109, v31 quad_perm:[3,0,1,2] row_mask:0xf bank_mask:0xf
  v_mfma_f32_32x32x16_bf16 v[32:47], a[36:39], v[84:87], v[32:47]
  ds_read_b128 v[80:83], v25 offset:368
  v_fmac_f32_dpp v108, v110, v29 quad_perm:[2,3,0,1] row_mask:0xf bank_mask:0xf
  v_fmac_f32_dpp v21, v110, v62 quad_perm:[2,3,0,1] row_mask:0xf bank_mask:0xf
  v_fmac_f32_dpp v108, v111, v30 quad_perm:[1,2,3,0] row_mask:0xf bank_mask:0xf
  s_waitcnt lgkmcnt(8)
  v_mfma_f32_32x32x16_bf16 v[32:47], a[40:43], v[88:91], v[32:47]
  ds_read_b128 v[84:87], v25 offset:336
  v_fmac_f32_dpp v21, v111, v63 quad_perm:[1,2,3,0] row_mask:0xf bank_mask:0xf
  ds_write2st64_b32 v26, v104, v108 offset0:8 offset1:12
  v_mfma_f32_32x32x16_bf16 v[32:47], a[44:47], v[92:95], v[32:47]
  ds_read_b128 v[88:91], v25 offset:304
  ds_write_b32 v27, v21 offset:0
  v_add_u32 v26, 128, v26
  s_waitcnt lgkmcnt(8)
  v_mfma_f32_32x32x16_bf16 v[96:111], a[0:3], v[64:67], 0
  ds_read_b128 v[92:95], v25 offset:272
  ds_read_b64_tr_b16 a[64:65], v6 offset:2080
  ds_read_b64_tr_b16 a[66:67], v6 offset:2048
  ds_read_b64_tr_b16 a[68:69], v6 offset:2208
  v_mfma_f32_32x32x16_bf16 v[96:111], a[4:7], v[68:71], v[96:111]
  ds_read_b128 v[64:67], v25 offset:240
  v_fmac_f32_dpp v112, v113, v28 quad_perm:[3,0,1,2] row_mask:0xf bank_mask:0xf
  v_fmac_f32_dpp v116, v113, v31 quad_perm:[3,0,1,2] row_mask:0xf bank_mask:0xf
  v_fmac_f32_dpp v112, v114, v29 quad_perm:[2,3,0,1] row_mask:0xf bank_mask:0xf
  s_waitcnt lgkmcnt(10)
  v_mfma_f32_32x32x16_bf16 v[96:111], a[8:11], v[72:75], v[96:111]
  ds_read_b128 v[68:71], v25 offset:208
  ds_read_b64_tr_b16 a[70:71], v6 offset:2176
  ds_read_b64_tr_b16 a[72:73], v6 offset:2336
  ds_read_b64_tr_b16 a[74:75], v6 offset:2304
  v_mfma_f32_32x32x16_bf16 v[96:111], a[12:15], v[76:79], v[96:111]
  ds_read_b128 v[72:75], v25 offset:176
  v_fmac_f32_dpp v116, v114, v62 quad_perm:[2,3,0,1] row_mask:0xf bank_mask:0xf
  v_fmac_f32_dpp v112, v115, v30 quad_perm:[1,2,3,0] row_mask:0xf bank_mask:0xf
  v_fmac_f32_dpp v116, v115, v63 quad_perm:[1,2,3,0] row_mask:0xf bank_mask:0xf
  s_waitcnt lgkmcnt(13)
  v_mfma_f32_32x32x16_bf16 v[96:111], a[16:19], v[80:83], v[96:111]
  ds_read_b128 v[76:79], v25 offset:144
  ds_read_b64_tr_b16 a[76:77], v6 offset:2464
  ds_read_b64_tr_b16 a[78:79], v6 offset:2432
  v_mfma_f32_32x32x16_bf16 v[96:111], a[20:23], v[84:87], v[96:111]
  ds_read_b128 v[80:83], v25 offset:112
  v_fmac_f32_dpp v116, v117, v28 quad_perm:[3,0,1,2] row_mask:0xf bank_mask:0xf
  v_fmac_f32_dpp v120, v117, v31 quad_perm:[3,0,1,2] row_mask:0xf bank_mask:0xf
  s_waitcnt lgkmcnt(13)
  v_mfma_f32_32x32x16_bf16 v[96:111], a[24:27], v[88:91], v[96:111]
  ds_read_b128 v[84:87], v25 offset:80
  v_fmac_f32_dpp v116, v118, v29 quad_perm:[2,3,0,1] row_mask:0xf bank_mask:0xf
  v_fmac_f32_dpp v120, v118, v62 quad_perm:[2,3,0,1] row_mask:0xf bank_mask:0xf
  v_mfma_f32_32x32x16_bf16 v[96:111], a[28:31], v[92:95], v[96:111]
  ds_read_b128 v[88:91], v25 offset:48
  v_fmac_f32_dpp v116, v119, v30 quad_perm:[1,2,3,0] row_mask:0xf bank_mask:0xf
  v_fmac_f32_dpp v120, v119, v63 quad_perm:[1,2,3,0] row_mask:0xf bank_mask:0xf
  s_waitcnt lgkmcnt(10)
  v_mfma_f32_32x32x16_bf16 v[96:111], a[32:35], v[64:67], v[96:111]
  ds_read_b128 v[92:95], v25 offset:16
  ds_write2st64_b32 v26, v112, v116 offset0:0 offset1:4
  v_fmac_f32_dpp v120, v121, v28 quad_perm:[3,0,1,2] row_mask:0xf bank_mask:0xf
  v_mfma_f32_32x32x16_bf16 v[96:111], a[36:39], v[68:71], v[96:111]
  ds_read_b128 v[64:67], v25 offset:16
  v_fmac_f32_dpp v124, v121, v31 quad_perm:[3,0,1,2] row_mask:0xf bank_mask:0xf
  v_fmac_f32_dpp v120, v122, v29 quad_perm:[2,3,0,1] row_mask:0xf bank_mask:0xf
  s_waitcnt lgkmcnt(8)
  v_mfma_f32_32x32x16_bf16 v[96:111], a[40:43], v[72:75], v[96:111]
  ds_read_b128 v[68:71], v25 offset:48
  v_fmac_f32_dpp v124, v122, v62 quad_perm:[2,3,0,1] row_mask:0xf bank_mask:0xf
  v_fmac_f32_dpp v120, v123, v30 quad_perm:[1,2,3,0] row_mask:0xf bank_mask:0xf
  v_mfma_f32_32x32x16_bf16 v[96:111], a[44:47], v[76:79], v[96:111]
  ds_read_b128 v[72:75], v25 offset:80
  v_fmac_f32_dpp v124, v123, v63 quad_perm:[1,2,3,0] row_mask:0xf bank_mask:0xf
  v_fmac_f32_dpp v124, v125, v28 quad_perm:[3,0,1,2] row_mask:0xf bank_mask:0xf
  s_waitcnt lgkmcnt(6)
  v_mfma_f32_32x32x16_bf16 v[96:111], a[48:51], v[80:83], v[96:111]
  ds_read_b128 v[76:79], v25 offset:112
  v_mul_f32_dpp v22, v125, v31 quad_perm:[3,0,1,2] row_mask:0xf bank_mask:0xf
  v_fmac_f32_dpp v124, v126, v29 quad_perm:[2,3,0,1] row_mask:0xf bank_mask:0xf
  v_mfma_f32_32x32x16_bf16 v[96:111], a[52:55], v[84:87], v[96:111]
  ds_read_b128 v[80:83], v25 offset:144
  v_fmac_f32_dpp v22, v126, v62 quad_perm:[2,3,0,1] row_mask:0xf bank_mask:0xf
  v_fmac_f32_dpp v124, v127, v30 quad_perm:[1,2,3,0] row_mask:0xf bank_mask:0xf
  s_waitcnt lgkmcnt(6)
  v_mfma_f32_32x32x16_bf16 v[96:111], a[56:59], v[88:91], v[96:111]
  ds_read_b128 v[84:87], v25 offset:176
  v_fmac_f32_dpp v22, v127, v63 quad_perm:[1,2,3,0] row_mask:0xf bank_mask:0xf
  ds_write2st64_b32 v26, v120, v124 offset0:8 offset1:12
  v_mfma_f32_32x32x16_bf16 v[96:111], a[60:63], v[92:95], v[96:111]
  ds_read_b128 v[88:91], v25 offset:208
  ds_write_b32 v27, v22 offset:128
  v_add_u32 v26, 128, v26
  s_waitcnt lgkmcnt(7)
  v_mfma_f32_32x32x16_bf16 v[112:127], a[76:79], v[64:67], 0
  ds_read_b128 v[92:95], v25 offset:240
  ds_read_b64_tr_b16 a[80:81], v6 offset:2592
  ds_read_b64_tr_b16 a[82:83], v6 offset:2560
  v_mfma_f32_32x32x16_bf16 v[112:127], a[72:75], v[68:71], v[112:127]
  ds_read_b128 v[64:67], v25 offset:272
  v_fmac_f32_dpp v32, v33, v28 quad_perm:[3,0,1,2] row_mask:0xf bank_mask:0xf
  v_fmac_f32_dpp v36, v33, v31 quad_perm:[3,0,1,2] row_mask:0xf bank_mask:0xf
  s_waitcnt lgkmcnt(9)
  v_mfma_f32_32x32x16_bf16 v[112:127], a[68:71], v[72:75], v[112:127]
  ds_read_b128 v[68:71], v25 offset:304
  ds_read_b64_tr_b16 a[84:85], v6 offset:2720
  ds_read_b64_tr_b16 a[86:87], v6 offset:2688
  v_mfma_f32_32x32x16_bf16 v[112:127], a[64:67], v[76:79], v[112:127]
  ds_read_b128 v[72:75], v25 offset:336
  v_fmac_f32_dpp v32, v34, v29 quad_perm:[2,3,0,1] row_mask:0xf bank_mask:0xf
  v_fmac_f32_dpp v36, v34, v62 quad_perm:[2,3,0,1] row_mask:0xf bank_mask:0xf
  s_waitcnt lgkmcnt(11)
  v_mfma_f32_32x32x16_bf16 v[112:127], a[60:63], v[80:83], v[112:127]
  ds_read_b128 v[76:79], v25 offset:368
  ds_read_b64_tr_b16 a[88:89], v6 offset:2848
  ds_read_b64_tr_b16 a[90:91], v6 offset:2816
  v_mfma_f32_32x32x16_bf16 v[112:127], a[56:59], v[84:87], v[112:127]
  ds_read_b128 v[80:83], v25 offset:400
  v_fmac_f32_dpp v32, v35, v30 quad_perm:[1,2,3,0] row_mask:0xf bank_mask:0xf
  v_fmac_f32_dpp v36, v35, v63 quad_perm:[1,2,3,0] row_mask:0xf bank_mask:0xf
  s_waitcnt lgkmcnt(11)
  v_mfma_f32_32x32x16_bf16 v[112:127], a[52:55], v[88:91], v[112:127]
  ds_read_b32 v8, v4 offset:4
  ds_read_b128 v[84:87], v25 offset:432
  ds_read_b64_tr_b16 a[92:93], v6 offset:2976
  ds_read_b64_tr_b16 a[94:95], v6 offset:2944
  v_mfma_f32_32x32x16_bf16 v[112:127], a[48:51], v[92:95], v[112:127]
  ds_read_b128 v[88:91], v25 offset:464
  v_fmac_f32_dpp v36, v37, v28 quad_perm:[3,0,1,2] row_mask:0xf bank_mask:0xf
  v_fmac_f32_dpp v40, v37, v31 quad_perm:[3,0,1,2] row_mask:0xf bank_mask:0xf
  s_waitcnt lgkmcnt(12)
  v_mfma_f32_32x32x16_bf16 v[112:127], a[44:47], v[64:67], v[112:127]
  ds_read_b128 v[92:95], v25 offset:496
  v_fmac_f32_dpp v36, v38, v29 quad_perm:[2,3,0,1] row_mask:0xf bank_mask:0xf
  v_fmac_f32_dpp v40, v38, v62 quad_perm:[2,3,0,1] row_mask:0xf bank_mask:0xf
  v_mfma_f32_32x32x16_bf16 v[112:127], a[40:43], v[68:71], v[112:127]
  s_waitcnt lgkmcnt(5)
  v_readfirstlane_b32 s20, v8
  s_cmp_lt_u32 s20, 4
  s_cbranch_scc1 L_a_kernel_mspin
L_a_kernel_mret:
  ds_read_b128 v[64:67], v25 offset:528
  v_fmac_f32_dpp v36, v39, v30 quad_perm:[1,2,3,0] row_mask:0xf bank_mask:0xf
  v_fmac_f32_dpp v40, v39, v63 quad_perm:[1,2,3,0] row_mask:0xf bank_mask:0xf
  v_mfma_f32_32x32x16_bf16 v[112:127], a[36:39], v[72:75], v[112:127]
  ds_read_b128 v[68:71], v25 offset:560
  ds_write2st64_b32 v26, v32, v36 offset0:0 offset1:4
  v_fmac_f32_dpp v40, v41, v28 quad_perm:[3,0,1,2] row_mask:0xf bank_mask:0xf
  v_mfma_f32_32x32x16_bf16 v[112:127], a[32:35], v[76:79], v[112:127]
  ds_read_b128 v[72:75], v25 offset:592
  v_fmac_f32_dpp v44, v41, v31 quad_perm:[3,0,1,2] row_mask:0xf bank_mask:0xf
  v_fmac_f32_dpp v40, v42, v29 quad_perm:[2,3,0,1] row_mask:0xf bank_mask:0xf
  s_waitcnt lgkmcnt(8)
  v_mfma_f32_32x32x16_bf16 v[112:127], a[28:31], v[80:83], v[112:127]
  ds_read_b128 v[76:79], v25 offset:624
  v_fmac_f32_dpp v44, v42, v62 quad_perm:[2,3,0,1] row_mask:0xf bank_mask:0xf
  v_fmac_f32_dpp v40, v43, v30 quad_perm:[1,2,3,0] row_mask:0xf bank_mask:0xf
  v_mfma_f32_32x32x16_bf16 v[112:127], a[24:27], v[84:87], v[112:127]
  ds_read_b128 v[80:83], v25 offset:752
  v_fmac_f32_dpp v44, v43, v63 quad_perm:[1,2,3,0] row_mask:0xf bank_mask:0xf
  v_fmac_f32_dpp v44, v45, v28 quad_perm:[3,0,1,2] row_mask:0xf bank_mask:0xf
  s_waitcnt lgkmcnt(6)
  v_mfma_f32_32x32x16_bf16 v[112:127], a[20:23], v[88:91], v[112:127]
  ds_read_b128 v[84:87], v25 offset:720
  v_mul_f32_dpp v23, v45, v31 quad_perm:[3,0,1,2] row_mask:0xf bank_mask:0xf
  v_fmac_f32_dpp v44, v46, v29 quad_perm:[2,3,0,1] row_mask:0xf bank_mask:0xf
  v_mfma_f32_32x32x16_bf16 v[112:127], a[16:19], v[92:95], v[112:127]
  ds_read_b128 v[88:91], v25 offset:688
  v_fmac_f32_dpp v23, v46, v62 quad_perm:[2,3,0,1] row_mask:0xf bank_mask:0xf
  v_fmac_f32_dpp v44, v47, v30 quad_perm:[1,2,3,0] row_mask:0xf bank_mask:0xf
  s_waitcnt lgkmcnt(6)
  v_mfma_f32_32x32x16_bf16 v[112:127], a[12:15], v[64:67], v[112:127]
  ds_read_b128 v[92:95], v25 offset:656
  v_fmac_f32_dpp v23, v47, v63 quad_perm:[1,2,3,0] row_mask:0xf bank_mask:0xf
  ds_write2st64_b32 v26, v40, v44 offset0:8 offset1:12
  v_mfma_f32_32x32x16_bf16 v[112:127], a[8:11], v[68:71], v[112:127]
  ds_read_b128 v[64:67], v25 offset:624
  ds_write_b32 v27, v23 offset:256
  s_waitcnt lgkmcnt(7)
  v_mfma_f32_32x32x16_bf16 v[112:127], a[4:7], v[72:75], v[112:127]
  ds_read_b128 v[68:71], v25 offset:592
  v_add_u32 v26, 128, v26
  v_fmac_f32_dpp v96, v97, v28 quad_perm:[3,0,1,2] row_mask:0xf bank_mask:0xf
  v_mfma_f32_32x32x16_bf16 v[112:127], a[0:3], v[76:79], v[112:127]
  ds_read_b128 v[72:75], v25 offset:560
  v_fmac_f32_dpp v100, v97, v31 quad_perm:[3,0,1,2] row_mask:0xf bank_mask:0xf
  s_waitcnt lgkmcnt(7)
  v_mfma_f32_32x32x16_bf16 v[32:47], a[0:3], v[80:83], 0
  ds_read_b128 v[76:79], v25 offset:528
  ds_read_b64_tr_b16 a[96:97], v6 offset:3104
  ds_read_b64_tr_b16 a[98:99], v6 offset:3072
  v_mfma_f32_32x32x16_bf16 v[32:47], a[4:7], v[84:87], v[32:47]
  ds_read_b128 v[80:83], v25 offset:496
  v_fmac_f32_dpp v96, v98, v29 quad_perm:[2,3,0,1] row_mask:0xf bank_mask:0xf
  v_fmac_f32_dpp v100, v98, v62 quad_perm:[2,3,0,1] row_mask:0xf bank_mask:0xf
  s_waitcnt lgkmcnt(9)
  v_mfma_f32_32x32x16_bf16 v[32:47], a[8:11], v[88:91], v[32:47]
  ds_read_b128 v[84:87], v25 offset:464
  ds_read_b64_tr_b16 a[100:101], v6 offset:3232
  ds_read_b64_tr_b16 a[102:103], v6 offset:3200
  v_mfma_f32_32x32x16_bf16 v[32:47], a[12:15], v[92:95], v[32:47]
  ds_read_b128 v[88:91], v25 offset:432
  v_fmac_f32_dpp v96, v99, v30 quad_perm:[1,2,3,0] row_mask:0xf bank_mask:0xf
  v_fmac_f32_dpp v100, v99, v63 quad_perm:[1,2,3,0] row_mask:0xf bank_mask:0xf
  s_waitcnt lgkmcnt(9)
  v_mfma_f32_32x32x16_bf16 v[32:47], a[16:19], v[64:67], v[32:47]
  ds_read_b128 v[92:95], v25 offset:400
  ds_read_b64_tr_b16 a[104:105], v6 offset:3360
  ds_read_b64_tr_b16 a[106:107], v6 offset:3328
  v_mfma_f32_32x32x16_bf16 v[32:47], a[20:23], v[68:71], v[32:47]
  ds_read_b128 v[64:67], v25 offset:368
  v_fmac_f32_dpp v100, v101, v28 quad_perm:[3,0,1,2] row_mask:0xf bank_mask:0xf
  v_fmac_f32_dpp v104, v101, v31 quad_perm:[3,0,1,2] row_mask:0xf bank_mask:0xf
  s_waitcnt lgkmcnt(11)
  v_mfma_f32_32x32x16_bf16 v[32:47], a[24:27], v[72:75], v[32:47]
  ds_read_b128 v[68:71], v25 offset:336
  ds_read_b64_tr_b16 a[108:109], v6 offset:3488
  ds_read_b64_tr_b16 a[110:111], v6 offset:3456
  v_mfma_f32_32x32x16_bf16 v[32:47], a[28:31], v[76:79], v[32:47]
  ds_read_b128 v[72:75], v25 offset:304
  v_fmac_f32_dpp v100, v102, v29 quad_perm:[2,3,0,1] row_mask:0xf bank_mask:0xf
  v_fmac_f32_dpp v104, v102, v62 quad_perm:[2,3,0,1] row_mask:0xf bank_mask:0xf
  s_waitcnt lgkmcnt(11)
  v_mfma_f32_32x32x16_bf16 v[32:47], a[32:35], v[80:83], v[32:47]
  ds_read_b128 v[76:79], v25 offset:272
  v_fmac_f32_dpp v100, v103, v30 quad_perm:[1,2,3,0] row_mask:0xf bank_mask:0xf
  v_fmac_f32_dpp v104, v103, v63 quad_perm:[1,2,3,0] row_mask:0xf bank_mask:0xf
  v_mfma_f32_32x32x16_bf16 v[32:47], a[36:39], v[84:87], v[32:47]
  ds_read_b128 v[80:83], v25 offset:240
  ds_write2st64_b32 v26, v96, v100 offset0:0 offset1:4
  v_fmac_f32_dpp v104, v105, v28 quad_perm:[3,0,1,2] row_mask:0xf bank_mask:0xf
  s_waitcnt lgkmcnt(10)
  v_mfma_f32_32x32x16_bf16 v[32:47], a[40:43], v[88:91], v[32:47]
  ds_read_b128 v[84:87], v25 offset:208
  v_fmac_f32_dpp v108, v105, v31 quad_perm:[3,0,1,2] row_mask:0xf bank_mask:0xf
  v_fmac_f32_dpp v104, v106, v29 quad_perm:[2,3,0,1] row_mask:0xf bank_mask:0xf
  v_mfma_f32_32x32x16_bf16 v[32:47], a[44:47], v[92:95], v[32:47]
  ds_read_b128 v[88:91], v25 offset:176
  v_fmac_f32_dpp v108, v106, v62 quad_perm:[2,3,0,1] row_mask:0xf bank_mask:0xf
  s_waitcnt lgkmcnt(8)
  v_mfma_f32_32x32x16_bf16 v[32:47], a[48:51], v[64:67], v[32:47]
  ds_read_b128 v[92:95], v25 offset:144
  v_fmac_f32_dpp v104, v107, v30 quad_perm:[1,2,3,0] row_mask:0xf bank_mask:0xf
  v_fmac_f32_dpp v108, v107, v63 quad_perm:[1,2,3,0] row_mask:0xf bank_mask:0xf
  v_mfma_f32_32x32x16_bf16 v[32:47], a[52:55], v[68:71], v[32:47]
  ds_read_b128 v[64:67], v25 offset:112
  v_fmac_f32_dpp v108, v109, v28 quad_perm:[3,0,1,2] row_mask:0xf bank_mask:0xf
  s_waitcnt lgkmcnt(6)
  v_mfma_f32_32x32x16_bf16 v[32:47], a[56:59], v[72:75], v[32:47]
  ds_read_b128 v[68:71], v25 offset:80
  v_mul_f32_dpp v21, v109, v31 quad_perm:[3,0,1,2] row_mask:0xf bank_mask:0xf
  v_fmac_f32_dpp v108, v110, v29 quad_perm:[2,3,0,1] row_mask:0xf bank_mask:0xf
  v_mfma_f32_32x32x16_bf16 v[32:47], a[60:63], v[76:79], v[32:47]
  ds_read_b128 v[72:75], v25 offset:48
  v_fmac_f32_dpp v21, v110, v62 quad_perm:[2,3,0,1] row_mask:0xf bank_mask:0xf
  s_waitcnt lgkmcnt(5)
  v_mfma_f32_32x32x16_bf16 v[32:47], a[64:67], v[80:83], v[32:47]
  ds_read_b128 v[76:79], v25 offset:16
  v_fmac_f32_dpp v108, v111, v30 quad_perm:[1,2,3,0] row_mask:0xf bank_mask:0xf
  v_fmac_f32_dpp v21, v111, v63 quad_perm:[1,2,3,0] row_mask:0xf bank_mask:0xf
  v_mfma_f32_32x32x16_bf16 v[32:47], a[68:71], v[84:87], v[32:47]
  ds_read_b128 v[80:83], v25 offset:880
  ds_write2st64_b32 v26, v104, v108 offset0:8 offset1:12
  s_waitcnt lgkmcnt(6)
  v_mfma_f32_32x32x16_bf16 v[32:47], a[72:75], v[88:91], v[32:47]
  ds_read_b128 v[84:87], v25 offset:848
  ds_write_b32 v27, v21 offset:384
  v_add_u32 v26, 128, v26
  s_mov_b64 exec, 1
  ds_add_u32 v4, v5 offset:8
  s_mov_b64 exec, -1
  v_mfma_f32_32x32x16_bf16 v[32:47], a[76:79], v[92:95], v[32:47]
  ds_read_b128 v[88:91], v25 offset:816
  v_fmac_f32_dpp v112, v113, v28 quad_perm:[3,0,1,2] row_mask:0xf bank_mask:0xf
  s_waitcnt lgkmcnt(8)
  v_mfma_f32_32x32x16_bf16 v[32:47], a[80:83], v[64:67], v[32:47]
  ds_read_b128 v[92:95], v25 offset:784
  v_fmac_f32_dpp v116, v113, v31 quad_perm:[3,0,1,2] row_mask:0xf bank_mask:0xf
  v_fmac_f32_dpp v112, v114, v29 quad_perm:[2,3,0,1] row_mask:0xf bank_mask:0xf
  v_mfma_f32_32x32x16_bf16 v[32:47], a[84:87], v[68:71], v[32:47]
  ds_read_b128 v[64:67], v25 offset:752
  v_fmac_f32_dpp v116, v114, v62 quad_perm:[2,3,0,1] row_mask:0xf bank_mask:0xf
  s_waitcnt lgkmcnt(8)
  v_mfma_f32_32x32x16_bf16 v[32:47], a[88:91], v[72:75], v[32:47]
  ds_read_b128 v[68:71], v25 offset:720
  v_fmac_f32_dpp v112, v115, v30 quad_perm:[1,2,3,0] row_mask:0xf bank_mask:0xf
  v_fmac_f32_dpp v116, v115, v63 quad_perm:[1,2,3,0] row_mask:0xf bank_mask:0xf
  v_mfma_f32_32x32x16_bf16 v[32:47], a[92:95], v[76:79], v[32:47]
  ds_read_b128 v[72:75], v25 offset:688
  v_fmac_f32_dpp v116, v117, v28 quad_perm:[3,0,1,2] row_mask:0xf bank_mask:0xf
  s_waitcnt lgkmcnt(7)
  v_mfma_f32_32x32x16_bf16 v[96:111], a[0:3], v[80:83], 0
  ds_read_b128 v[76:79], v25 offset:656
  ds_read_b64_tr_b16 a[112:113], v6 offset:3616
  ds_read_b64_tr_b16 a[114:115], v6 offset:3584
  v_mfma_f32_32x32x16_bf16 v[96:111], a[4:7], v[84:87], v[96:111]
  ds_read_b128 v[80:83], v25 offset:624
  v_fmac_f32_dpp v120, v117, v31 quad_perm:[3,0,1,2] row_mask:0xf bank_mask:0xf
  s_waitcnt lgkmcnt(7)
  v_mfma_f32_32x32x16_bf16 v[96:111], a[8:11], v[88:91], v[96:111]
  ds_read_b128 v[84:87], v25 offset:592
  ds_read_b64_tr_b16 a[116:117], v6 offset:3744
  ds_read_b64_tr_b16 a[118:119], v6 offset:3712
  v_mfma_f32_32x32x16_bf16 v[96:111], a[12:15], v[92:95], v[96:111]
  ds_read_b128 v[88:91], v25 offset:560
  v_fmac_f32_dpp v116, v118, v29 quad_perm:[2,3,0,1] row_mask:0xf bank_mask:0xf
  s_waitcnt lgkmcnt(9)
  v_mfma_f32_32x32x16_bf16 v[96:111], a[16:19], v[64:67], v[96:111]
  ds_read_b128 v[92:95], v25 offset:528
  ds_read_b64_tr_b16 a[120:121], v6 offset:3872
  ds_read_b64_tr_b16 a[122:123], v6 offset:3840
  v_mfma_f32_32x32x16_bf16 v[96:111], a[20:23], v[68:71], v[96:111]
  ds_read_b128 v[64:67], v25 offset:496
  v_fmac_f32_dpp v120, v118, v62 quad_perm:[2,3,0,1] row_mask:0xf bank_mask:0xf
  s_waitcnt lgkmcnt(11)
  v_mfma_f32_32x32x16_bf16 v[96:111], a[24:27], v[72:75], v[96:111]
  ds_read_b128 v[68:71], v25 offset:464
  ds_read_b64_tr_b16 a[124:125], v6 offset:4000
  ds_read_b64_tr_b16 a[126:127], v6 offset:3968
  v_mfma_f32_32x32x16_bf16 v[96:111], a[28:31], v[76:79], v[96:111]
  ds_read_b128 v[72:75], v25 offset:432
  v_fmac_f32_dpp v116, v119, v30 quad_perm:[1,2,3,0] row_mask:0xf bank_mask:0xf
  s_waitcnt lgkmcnt(11)
  v_mfma_f32_32x32x16_bf16 v[96:111], a[32:35], v[80:83], v[96:111]
  ds_read_b128 v[76:79], v25 offset:400
  v_fmac_f32_dpp v120, v119, v63 quad_perm:[1,2,3,0] row_mask:0xf bank_mask:0xf
  ds_write2st64_b32 v26, v112, v116 offset0:0 offset1:4
  v_mfma_f32_32x32x16_bf16 v[96:111], a[36:39], v[84:87], v[96:111]
  ds_read_b128 v[80:83], v25 offset:368
  v_fmac_f32_dpp v120, v121, v28 quad_perm:[3,0,1,2] row_mask:0xf bank_mask:0xf
  s_waitcnt lgkmcnt(10)
  v_mfma_f32_32x32x16_bf16 v[96:111], a[40:43], v[88:91], v[96:111]
  ds_read_b128 v[84:87], v25 offset:336
  v_fmac_f32_dpp v124, v121, v31 quad_perm:[3,0,1,2] row_mask:0xf bank_mask:0xf
  v_fmac_f32_dpp v120, v122, v29 quad_perm:[2,3,0,1] row_mask:0xf bank_mask:0xf
  v_mfma_f32_32x32x16_bf16 v[96:111], a[44:47], v[92:95], v[96:111]
  ds_read_b128 v[88:91], v25 offset:304
  v_fmac_f32_dpp v124, v122, v62 quad_perm:[2,3,0,1] row_mask:0xf bank_mask:0xf
  s_waitcnt lgkmcnt(8)
  v_mfma_f32_32x32x16_bf16 v[96:111], a[48:51], v[64:67], v[96:111]
  ds_read_b128 v[92:95], v25 offset:272
  v_fmac_f32_dpp v120, v123, v30 quad_perm:[1,2,3,0] row_mask:0xf bank_mask:0xf
  v_fmac_f32_dpp v124, v123, v63 quad_perm:[1,2,3,0] row_mask:0xf bank_mask:0xf
  v_mfma_f32_32x32x16_bf16 v[96:111], a[52:55], v[68:71], v[96:111]
  ds_read_b128 v[64:67], v25 offset:240
  v_fmac_f32_dpp v124, v125, v28 quad_perm:[3,0,1,2] row_mask:0xf bank_mask:0xf
  s_waitcnt lgkmcnt(6)
  v_mfma_f32_32x32x16_bf16 v[96:111], a[56:59], v[72:75], v[96:111]
  ds_read_b128 v[68:71], v25 offset:208
  v_mul_f32_dpp v22, v125, v31 quad_perm:[3,0,1,2] row_mask:0xf bank_mask:0xf
  v_fmac_f32_dpp v124, v126, v29 quad_perm:[2,3,0,1] row_mask:0xf bank_mask:0xf
  v_mfma_f32_32x32x16_bf16 v[96:111], a[60:63], v[76:79], v[96:111]
  ds_read_b128 v[72:75], v25 offset:176
  v_fmac_f32_dpp v22, v126, v62 quad_perm:[2,3,0,1] row_mask:0xf bank_mask:0xf
  s_waitcnt lgkmcnt(5)
  v_mfma_f32_32x32x16_bf16 v[96:111], a[64:67], v[80:83], v[96:111]
  ds_read_b128 v[76:79], v25 offset:144
  v_fmac_f32_dpp v124, v127, v30 quad_perm:[1,2,3,0] row_mask:0xf bank_mask:0xf
  v_fmac_f32_dpp v22, v127, v63 quad_perm:[1,2,3,0] row_mask:0xf bank_mask:0xf
  v_mfma_f32_32x32x16_bf16 v[96:111], a[68:71], v[84:87], v[96:111]
  ds_read_b128 v[80:83], v25 offset:112
  ds_write2st64_b32 v26, v120, v124 offset0:8 offset1:12
  s_waitcnt lgkmcnt(6)
  v_mfma_f32_32x32x16_bf16 v[96:111], a[72:75], v[88:91], v[96:111]
  ds_read_b128 v[84:87], v25 offset:80
  ds_write_b32 v27, v22 offset:512
  v_add_u32 v26, 128, v26
  v_mfma_f32_32x32x16_bf16 v[96:111], a[76:79], v[92:95], v[96:111]
  ds_read_b128 v[88:91], v25 offset:48
  v_fmac_f32_dpp v32, v33, v28 quad_perm:[3,0,1,2] row_mask:0xf bank_mask:0xf
  s_waitcnt lgkmcnt(7)
  v_mfma_f32_32x32x16_bf16 v[96:111], a[80:83], v[64:67], v[96:111]
  ds_read_b128 v[92:95], v25 offset:16
  v_fmac_f32_dpp v36, v33, v31 quad_perm:[3,0,1,2] row_mask:0xf bank_mask:0xf
  v_fmac_f32_dpp v32, v34, v29 quad_perm:[2,3,0,1] row_mask:0xf bank_mask:0xf
  v_mfma_f32_32x32x16_bf16 v[96:111], a[84:87], v[68:71], v[96:111]
  ds_read_b128 v[64:67], v25 offset:1008
  v_fmac_f32_dpp v36, v34, v62 quad_perm:[2,3,0,1] row_mask:0xf bank_mask:0xf
  s_waitcnt lgkmcnt(7)
  v_mfma_f32_32x32x16_bf16 v[96:111], a[88:91], v[72:75], v[96:111]
  ds_read_b128 v[68:71], v25 offset:976
  v_fmac_f32_dpp v32, v35, v30 quad_perm:[1,2,3,0] row_mask:0xf bank_mask:0xf
  v_fmac_f32_dpp v36, v35, v63 quad_perm:[1,2,3,0] row_mask:0xf bank_mask:0xf
  v_mfma_f32_32x32x16_bf16 v[96:111], a[92:95], v[76:79], v[96:111]
  ds_read_b128 v[72:75], v25 offset:944
  v_fmac_f32_dpp v36, v37, v28 quad_perm:[3,0,1,2] row_mask:0xf bank_mask:0xf
  s_waitcnt lgkmcnt(6)
  v_mfma_f32_32x32x16_bf16 v[96:111], a[96:99], v[80:83], v[96:111]
  ds_read_b128 v[76:79], v25 offset:912
  v_fmac_f32_dpp v40, v37, v31 quad_perm:[3,0,1,2] row_mask:0xf bank_mask:0xf
  v_fmac_f32_dpp v36, v38, v29 quad_perm:[2,3,0,1] row_mask:0xf bank_mask:0xf
  v_mfma_f32_32x32x16_bf16 v[96:111], a[100:103], v[84:87], v[96:111]
  ds_read_b128 v[80:83], v25 offset:880
  v_fmac_f32_dpp v40, v38, v62 quad_perm:[2,3,0,1] row_mask:0xf bank_mask:0xf
  s_waitcnt lgkmcnt(5)
  v_mfma_f32_32x32x16_bf16 v[96:111], a[104:107], v[88:91], v[96:111]
  ds_read_b128 v[84:87], v25 offset:848
  v_fmac_f32_dpp v36, v39, v30 quad_perm:[1,2,3,0] row_mask:0xf bank_mask:0xf
  v_fmac_f32_dpp v40, v39, v63 quad_perm:[1,2,3,0] row_mask:0xf bank_mask:0xf
  v_mfma_f32_32x32x16_bf16 v[96:111], a[108:111], v[92:95], v[96:111]
  ds_read_b128 v[88:91], v25 offset:816
  ds_write2st64_b32 v26, v32, v36 offset0:0 offset1:4
  s_waitcnt lgkmcnt(6)
  v_mfma_f32_32x32x16_bf16 v[112:127], a[0:3], v[64:67], 0
  ds_read_b128 v[92:95], v25 offset:784
  v_fmac_f32_dpp v40, v41, v28 quad_perm:[3,0,1,2] row_mask:0xf bank_mask:0xf
  v_fmac_f32_dpp v44, v41, v31 quad_perm:[3,0,1,2] row_mask:0xf bank_mask:0xf
  v_mfma_f32_32x32x16_bf16 v[112:127], a[4:7], v[68:71], v[112:127]
  ds_read_b128 v[64:67], v25 offset:752
  v_fmac_f32_dpp v40, v42, v29 quad_perm:[2,3,0,1] row_mask:0xf bank_mask:0xf
  s_waitcnt lgkmcnt(6)
  v_mfma_f32_32x32x16_bf16 v[112:127], a[8:11], v[72:75], v[112:127]
  ds_read_b128 v[68:71], v25 offset:720
  v_fmac_f32_dpp v44, v42, v62 quad_perm:[2,3,0,1] row_mask:0xf bank_mask:0xf
  v_fmac_f32_dpp v40, v43, v30 quad_perm:[1,2,3,0] row_mask:0xf bank_mask:0xf
  v_mfma_f32_32x32x16_bf16 v[112:127], a[12:15], v[76:79], v[112:127]
  ds_read_b128 v[72:75], v25 offset:688
  v_fmac_f32_dpp v44, v43, v63 quad_perm:[1,2,3,0] row_mask:0xf bank_mask:0xf
  s_waitcnt lgkmcnt(6)
  v_mfma_f32_32x32x16_bf16 v[112:127], a[16:19], v[80:83], v[112:127]
  ds_read_b128 v[76:79], v25 offset:656
  v_fmac_f32_dpp v44, v45, v28 quad_perm:[3,0,1,2] row_mask:0xf bank_mask:0xf
  v_mul_f32_dpp v23, v45, v31 quad_perm:[3,0,1,2] row_mask:0xf bank_mask:0xf
  v_mfma_f32_32x32x16_bf16 v[112:127], a[20:23], v[84:87], v[112:127]
  ds_read_b128 v[80:83], v25 offset:624
  v_fmac_f32_dpp v44, v46, v29 quad_perm:[2,3,0,1] row_mask:0xf bank_mask:0xf
  s_waitcnt lgkmcnt(5)
  v_mfma_f32_32x32x16_bf16 v[112:127], a[24:27], v[88:91], v[112:127]
  ds_read_b128 v[84:87], v25 offset:592
  v_fmac_f32_dpp v23, v46, v62 quad_perm:[2,3,0,1] row_mask:0xf bank_mask:0xf
  v_fmac_f32_dpp v44, v47, v30 quad_perm:[1,2,3,0] row_mask:0xf bank_mask:0xf
  v_mfma_f32_32x32x16_bf16 v[112:127], a[28:31], v[92:95], v[112:127]
  ds_read_b128 v[88:91], v25 offset:560
  v_fmac_f32_dpp v23, v47, v63 quad_perm:[1,2,3,0] row_mask:0xf bank_mask:0xf
  s_waitcnt lgkmcnt(5)
  v_mfma_f32_32x32x16_bf16 v[112:127], a[32:35], v[64:67], v[112:127]
  ds_read_b128 v[92:95], v25 offset:528
  ds_write2st64_b32 v26, v40, v44 offset0:8 offset1:12
  ds_write_b32 v27, v23 offset:640
  v_mfma_f32_32x32x16_bf16 v[112:127], a[36:39], v[68:71], v[112:127]
  ds_read_b128 v[64:67], v25 offset:496
  v_add_u32 v26, 128, v26
  s_waitcnt lgkmcnt(7)
  v_mfma_f32_32x32x16_bf16 v[112:127], a[40:43], v[72:75], v[112:127]
  ds_read_b128 v[68:71], v25 offset:464
  v_fmac_f32_dpp v96, v97, v28 quad_perm:[3,0,1,2] row_mask:0xf bank_mask:0xf
  v_fmac_f32_dpp v100, v97, v31 quad_perm:[3,0,1,2] row_mask:0xf bank_mask:0xf
  v_mfma_f32_32x32x16_bf16 v[112:127], a[44:47], v[76:79], v[112:127]
  ds_read_b128 v[72:75], v25 offset:432
  v_fmac_f32_dpp v96, v98, v29 quad_perm:[2,3,0,1] row_mask:0xf bank_mask:0xf
  s_waitcnt lgkmcnt(7)
  v_mfma_f32_32x32x16_bf16 v[112:127], a[48:51], v[80:83], v[112:127]
  ds_read_b128 v[76:79], v25 offset:400
  v_fmac_f32_dpp v100, v98, v62 quad_perm:[2,3,0,1] row_mask:0xf bank_mask:0xf
  v_fmac_f32_dpp v96, v99, v30 quad_perm:[1,2,3,0] row_mask:0xf bank_mask:0xf
  v_mfma_f32_32x32x16_bf16 v[112:127], a[52:55], v[84:87], v[112:127]
  ds_read_b128 v[80:83], v25 offset:368
  v_fmac_f32_dpp v100, v99, v63 quad_perm:[1,2,3,0] row_mask:0xf bank_mask:0xf
  s_waitcnt lgkmcnt(7)
  v_mfma_f32_32x32x16_bf16 v[112:127], a[56:59], v[88:91], v[112:127]
  ds_read_b128 v[84:87], v25 offset:336
  v_fmac_f32_dpp v100, v101, v28 quad_perm:[3,0,1,2] row_mask:0xf bank_mask:0xf
  v_fmac_f32_dpp v104, v101, v31 quad_perm:[3,0,1,2] row_mask:0xf bank_mask:0xf
  v_mfma_f32_32x32x16_bf16 v[112:127], a[60:63], v[92:95], v[112:127]
  ds_read_b128 v[88:91], v25 offset:304
  v_fmac_f32_dpp v100, v102, v29 quad_perm:[2,3,0,1] row_mask:0xf bank_mask:0xf
  s_waitcnt lgkmcnt(5)
  v_mfma_f32_32x32x16_bf16 v[112:127], a[64:67], v[64:67], v[112:127]
  ds_read_b128 v[92:95], v25 offset:272
  v_fmac_f32_dpp v104, v102, v62 quad_perm:[2,3,0,1] row_mask:0xf bank_mask:0xf
  v_fmac_f32_dpp v100, v103, v30 quad_perm:[1,2,3,0] row_mask:0xf bank_mask:0xf
  v_mfma_f32_32x32x16_bf16 v[112:127], a[68:71], v[68:71], v[112:127]
  ds_read_b128 v[64:67], v25 offset:240
  v_fmac_f32_dpp v104, v103, v63 quad_perm:[1,2,3,0] row_mask:0xf bank_mask:0xf
  s_waitcnt lgkmcnt(5)
  v_mfma_f32_32x32x16_bf16 v[112:127], a[72:75], v[72:75], v[112:127]
  ds_read_b128 v[68:71], v25 offset:208
  ds_write2st64_b32 v26, v96, v100 offset0:0 offset1:4
  v_fmac_f32_dpp v104, v105, v28 quad_perm:[3,0,1,2] row_mask:0xf bank_mask:0xf
  v_mfma_f32_32x32x16_bf16 v[112:127], a[76:79], v[76:79], v[112:127]
  ds_read_b128 v[72:75], v25 offset:176
  v_fmac_f32_dpp v108, v105, v31 quad_perm:[3,0,1,2] row_mask:0xf bank_mask:0xf
  s_waitcnt lgkmcnt(6)
  v_mfma_f32_32x32x16_bf16 v[112:127], a[80:83], v[80:83], v[112:127]
  ds_read_b128 v[76:79], v25 offset:144
  v_fmac_f32_dpp v104, v106, v29 quad_perm:[2,3,0,1] row_mask:0xf bank_mask:0xf
  v_fmac_f32_dpp v108, v106, v62 quad_perm:[2,3,0,1] row_mask:0xf bank_mask:0xf
  v_mfma_f32_32x32x16_bf16 v[112:127], a[84:87], v[84:87], v[112:127]
  ds_read_b128 v[80:83], v25 offset:112
  v_fmac_f32_dpp v104, v107, v30 quad_perm:[1,2,3,0] row_mask:0xf bank_mask:0xf
  s_waitcnt lgkmcnt(6)
  v_mfma_f32_32x32x16_bf16 v[112:127], a[88:91], v[88:91], v[112:127]
  ds_read_b128 v[84:87], v25 offset:80
  v_fmac_f32_dpp v108, v107, v63 quad_perm:[1,2,3,0] row_mask:0xf bank_mask:0xf
  v_fmac_f32_dpp v108, v109, v28 quad_perm:[3,0,1,2] row_mask:0xf bank_mask:0xf
  v_mfma_f32_32x32x16_bf16 v[112:127], a[92:95], v[92:95], v[112:127]
  ds_read_b128 v[88:91], v25 offset:48
  v_mul_f32_dpp v21, v109, v31 quad_perm:[3,0,1,2] row_mask:0xf bank_mask:0xf
  s_waitcnt lgkmcnt(6)
  v_mfma_f32_32x32x16_bf16 v[112:127], a[96:99], v[64:67], v[112:127]
  ds_read_b128 v[92:95], v25 offset:16
  v_fmac_f32_dpp v108, v110, v29 quad_perm:[2,3,0,1] row_mask:0xf bank_mask:0xf
  v_fmac_f32_dpp v21, v110, v62 quad_perm:[2,3,0,1] row_mask:0xf bank_mask:0xf
  v_mfma_f32_32x32x16_bf16 v[112:127], a[100:103], v[68:71], v[112:127]
  v_fmac_f32_dpp v108, v111, v30 quad_perm:[1,2,3,0] row_mask:0xf bank_mask:0xf
  s_waitcnt lgkmcnt(4)
  v_mfma_f32_32x32x16_bf16 v[112:127], a[104:107], v[72:75], v[112:127]
  v_fmac_f32_dpp v21, v111, v63 quad_perm:[1,2,3,0] row_mask:0xf bank_mask:0xf
  ds_write2st64_b32 v26, v104, v108 offset0:8 offset1:12
  v_mfma_f32_32x32x16_bf16 v[112:127], a[108:111], v[76:79], v[112:127]
  ds_write_b32 v27, v21 offset:768
  s_waitcnt lgkmcnt(4)
  v_mfma_f32_32x32x16_bf16 v[112:127], a[112:115], v[80:83], v[112:127]
  v_add_u32 v26, 128, v26
  v_mfma_f32_32x32x16_bf16 v[112:127], a[116:119], v[84:87], v[112:127]
  s_waitcnt lgkmcnt(2)
  v_mfma_f32_32x32x16_bf16 v[112:127], a[120:123], v[88:91], v[112:127]
  v_mfma_f32_32x32x16_bf16 v[112:127], a[124:127], v[92:95], v[112:127]
  s_nop 11
  v_fmac_f32_dpp v112, v113, v28 quad_perm:[3,0,1,2] row_mask:0xf bank_mask:0xf
  v_fmac_f32_dpp v116, v113, v31 quad_perm:[3,0,1,2] row_mask:0xf bank_mask:0xf
  v_fmac_f32_dpp v112, v114, v29 quad_perm:[2,3,0,1] row_mask:0xf bank_mask:0xf
  v_fmac_f32_dpp v116, v114, v62 quad_perm:[2,3,0,1] row_mask:0xf bank_mask:0xf
  v_fmac_f32_dpp v112, v115, v30 quad_perm:[1,2,3,0] row_mask:0xf bank_mask:0xf
  v_fmac_f32_dpp v116, v115, v63 quad_perm:[1,2,3,0] row_mask:0xf bank_mask:0xf
  v_fmac_f32_dpp v116, v117, v28 quad_perm:[3,0,1,2] row_mask:0xf bank_mask:0xf
  v_fmac_f32_dpp v120, v117, v31 quad_perm:[3,0,1,2] row_mask:0xf bank_mask:0xf
  v_fmac_f32_dpp v116, v118, v29 quad_perm:[2,3,0,1] row_mask:0xf bank_mask:0xf
  v_fmac_f32_dpp v120, v118, v62 quad_perm:[2,3,0,1] row_mask:0xf bank_mask:0xf
  v_fmac_f32_dpp v116, v119, v30 quad_perm:[1,2,3,0] row_mask:0xf bank_mask:0xf
  v_fmac_f32_dpp v120, v119, v63 quad_perm:[1,2,3,0] row_mask:0xf bank_mask:0xf
  ds_write2st64_b32 v26, v112, v116 offset0:0 offset1:4
  v_fmac_f32_dpp v120, v121, v28 quad_perm:[3,0,1,2] row_mask:0xf bank_mask:0xf
  v_fmac_f32_dpp v124, v121, v31 quad_perm:[3,0,1,2] row_mask:0xf bank_mask:0xf
  v_fmac_f32_dpp v120, v122, v29 quad_perm:[2,3,0,1] row_mask:0xf bank_mask:0xf
  v_fmac_f32_dpp v124, v122, v62 quad_perm:[2,3,0,1] row_mask:0xf bank_mask:0xf
  v_fmac_f32_dpp v120, v123, v30 quad_perm:[1,2,3,0] row_mask:0xf bank_mask:0xf
  v_fmac_f32_dpp v124, v123, v63 quad_perm:[1,2,3,0] row_mask:0xf bank_mask:0xf
  v_fmac_f32_dpp v124, v125, v28 quad_perm:[3,0,1,2] row_mask:0xf bank_mask:0xf
  v_mul_f32_dpp v22, v125, v31 quad_perm:[3,0,1,2] row_mask:0xf bank_mask:0xf
  v_fmac_f32_dpp v124, v126, v29 quad_perm:[2,3,0,1] row_mask:0xf bank_mask:0xf
  v_fmac_f32_dpp v22, v126, v62 quad_perm:[2,3,0,1] row_mask:0xf bank_mask:0xf
  v_fmac_f32_dpp v124, v127, v30 quad_perm:[1,2,3,0] row_mask:0xf bank_mask:0xf
  v_fmac_f32_dpp v22, v127, v63 quad_perm:[1,2,3,0] row_mask:0xf bank_mask:0xf
  ds_write2st64_b32 v26, v120, v124 offset0:8 offset1:12
  ds_write_b32 v27, v22 offset:896
  v_add_u32 v26, 128, v26
  s_waitcnt lgkmcnt(0)
  s_barrier
  s_endpgm
L_a_kernel_mspin:
  ds_read_b32 v8, v4 offset:4
  s_waitcnt lgkmcnt(0)
  v_readfirstlane_b32 s20, v8
  s_cmp_lt_u32 s20, 4
  s_cbranch_scc1 L_a_kernel_mspin
  s_branch L_a_kernel_mret
L_a_kernel_helper:
  v_and_b32 v0, 255, v0
  v_mov_b32 v12, 0
  v_mov_b32 v13, 154688
  ds_write_b32 v13, v12
  ds_write_b32 v13, v12 offset:4
  ds_write_b32 v13, v12 offset:8
  s_sub_u32 s28, s28, 4
  v_bfe_u32 v4, v2, 2, 3
  v_lshl_add_u32 v4, s28, 3, v4
  v_and_b32 v5, 3, v0
  v_lshrrev_b32 v111, 5, v2
  v_lshl_add_u32 v6, v4, 1, v111
  v_lshl_add_u32 v6, v6, 4, v5
  v_lshlrev_b32 v6, 11, v6
  s_lshl_b32 s18, s26, 3
  s_mov_b32 s6, 4194304
  s_mov_b32 s7, 0x20000
  s_mov_b32 s22, 25198592
  v_mov_b32 v112, 0
  v_mov_b32 v113, 0
  v_mov_b32 v114, 0
  v_mov_b32 v115, 0
  v_bfe_u32 v14, v0, 3, 4
  v_mul_u32_u24 v14, 1216, v14
  v_and_b32 v15, 7, v0
  v_lshl_add_u32 v14, v15, 4, v14
  ds_write_b128 v14, v[112:115]
  s_waitcnt lgkmcnt(0)
  s_mov_b32 s4, s52
  s_mov_b32 s5, s53
  s_load_dword s70, s[24:25], s22
  s_barrier
  s_add_u32 s8, s24, 25165824
  s_addc_u32 s9, s25, 0
  s_mov_b32 s10, 16384
  s_mov_b32 s11, 0x20000
  s_lshl_b32 s20, s28, 11
  v_lshl_add_u32 v3, v2, 4, s20
  s_movk_i32 s71, 8192
  buffer_load_dwordx2 v[16:17], v6, s[4:7], s18 offen
  s_add_u32 s18, s18, 8192
  s_add_u32 s84, s24, 25231360
  s_addc_u32 s85, s25, 0
  s_mov_b32 s86, 81920
  s_mov_b32 s87, 0x20000
  s_add_u32 s12, s24, 0
  s_addc_u32 s13, s25, 0
  s_mov_b32 s14, 4194304
  s_mov_b32 s15, 0x20000
  v_mul_u32_u24 v7, 1216, v5
  v_lshl_add_u32 v7, v4, 4, v7
  v_lshl_add_u32 v7, v111, 3, v7
  s_mul_i32 s20, s2, 1171
  s_lshr_b32 s20, s20, 16
  s_mul_i32 s21, s20, 56
  s_sub_u32 s21, s2, s21
  s_cmp_ge_u32 s21, 28
  s_cselect_b32 s44, s74, s72
  s_cselect_b32 s45, s75, s73
  s_cselect_b32 s22, 28, 0
  s_sub_u32 s22, s21, s22
  s_cmp_lt_u32 s2, 224
  s_cselect_b32 s46, 7340032, 0
  s_mov_b32 s47, 0x20000
  s_lshl_b32 s23, s20, 2
  s_add_u32 s23, s23, s28
  s_mul_i32 s23, s23, 458752
  s_lshl_b32 s22, s22, 8
  s_add_u32 s92, s23, s22
  s_mul_i32 s20, s20, 28672
  s_lshl_b32 s21, s21, 9
  s_add_u32 s93, s20, s21
  s_lshl_b32 s20, s28, 7
  s_add_u32 s20, s20, 128
  v_lshrrev_b32 v12, 3, v2
  v_and_b32 v13, 7, v2
  v_mul_u32_u24 v108, 1216, v12
  v_lshl_add_u32 v108, v13, 4, v108
  v_add_u32 v108, s20, v108
  v_lshrrev_b32 v12, 4, v2
  v_and_b32 v13, 15, v2
  v_mul_u32_u24 v12, 7168, v12
  v_lshl_add_u32 v110, v13, 4, v12
  v_bfe_u32 v12, v2, 1, 4
  v_mul_u32_u24 v109, 1216, v12
  v_and_b32 v13, 1, v2
  v_lshl_add_u32 v13, v13, 1, v111
  v_lshl_add_u32 v109, v13, 5, v109
  v_add_u32 v109, s20, v109
  s_waitcnt lgkmcnt(0)
  s_add_u32 s70, s70, 1
  buffer_load_dwordx4 a[0:3], v110, s[44:47], s92 offen
  s_add_u32 s92, s92, 28672
  buffer_load_dwordx4 a[4:7], v110, s[44:47], s92 offen
  s_add_u32 s92, s92, 28672
  v_mov_b32 v12, 154688
L_a_kernel_pause:
  ds_read_b32 v13, v12
  s_waitcnt lgkmcnt(0)
  v_readfirstlane_b32 s20, v13
  s_cmp_lt_u32 s20, 4
  s_cbranch_scc1 L_a_kernel_pause
  buffer_load_dwordx2 v[18:19], v6, s[4:7], s18 offen
  s_add_u32 s18, s18, 8192
  s_waitcnt vmcnt(3)
  v_lshlrev_b32 v48, 16, v16
  v_and_b32 v56, 0xffff0000, v16
  v_lshlrev_b32 v64, 16, v17
  v_and_b32 v72, 0xffff0000, v17
  buffer_load_dwordx2 v[20:21], v6, s[4:7], s18 offen
  s_add_u32 s18, s18, 8192
  s_waitcnt vmcnt(1)
  v_lshlrev_b32 v49, 16, v18
  v_and_b32 v57, 0xffff0000, v18
  v_lshlrev_b32 v65, 16, v19
  v_and_b32 v73, 0xffff0000, v19
  buffer_load_dwordx2 v[22:23], v6, s[4:7], s18 offen
  s_add_u32 s18, s18, 2072576
  s_waitcnt vmcnt(1)
  v_lshlrev_b32 v50, 16, v20
  v_and_b32 v58, 0xffff0000, v20
  v_lshlrev_b32 v66, 16, v21
  v_and_b32 v74, 0xffff0000, v21
  buffer_load_dwordx2 v[24:25], v6, s[4:7], s18 offen
  s_add_u32 s18, s18, 8192
  buffer_load_dwordx4 v[32:35], v3, s[8:11], 0 offen offset:0 sc1
  buffer_load_dwordx4 v[36:39], v3, s[8:11], 0 offen offset:1024 sc1
  buffer_load_dwordx4 v[40:43], v3, s[8:11], s71 offen offset:0 sc1
  buffer_load_dwordx4 v[44:47], v3, s[8:11], s71 offen offset:1024 sc1
  s_waitcnt vmcnt(5)
  v_lshlrev_b32 v51, 16, v22
  v_and_b32 v59, 0xffff0000, v22
  v_lshlrev_b32 v67, 16, v23
  v_and_b32 v75, 0xffff0000, v23
  buffer_load_dwordx2 v[26:27], v6, s[4:7], s18 offen
  s_add_u32 s18, s18, 8192
  s_waitcnt vmcnt(5)
  s_waitcnt vmcnt(1)
  buffer_load_dwordx2 v[28:29], v6, s[4:7], s18 offen
  s_add_u32 s18, s18, 8192
  s_mov_b32 s20, 0
L_a_kernel_poll:
  v_cmp_ne_u32 vcc, s70, v33
  v_cmp_ne_u32 s[22:23], s70, v35
  s_or_b64 vcc, vcc, s[22:23]
  v_cmp_ne_u32 s[22:23], s70, v37
  s_or_b64 vcc, vcc, s[22:23]
  v_cmp_ne_u32 s[22:23], s70, v39
  s_or_b64 vcc, vcc, s[22:23]
  v_cmp_ne_u32 s[22:23], s70, v41
  s_or_b64 vcc, vcc, s[22:23]
  v_cmp_ne_u32 s[22:23], s70, v43
  s_or_b64 vcc, vcc, s[22:23]
  v_cmp_ne_u32 s[22:23], s70, v45
  s_or_b64 vcc, vcc, s[22:23]
  v_cmp_ne_u32 s[22:23], s70, v47
  s_or_b64 vcc, vcc, s[22:23]
  s_cbranch_vccz L_a_kernel_go
  s_add_u32 s20, s20, 1
  s_cmp_gt_u32 s20, 0x100000
  s_cbranch_scc1 L_a_kernel_go
  s_sleep 4
  buffer_load_dwordx4 v[32:35], v3, s[8:11], 0 offen offset:0 sc1
  buffer_load_dwordx4 v[36:39], v3, s[8:11], 0 offen offset:1024 sc1
  buffer_load_dwordx4 v[40:43], v3, s[8:11], s71 offen offset:0 sc1
  buffer_load_dwordx4 v[44:47], v3, s[8:11], s71 offen offset:1024 sc1
  s_waitcnt vmcnt(0)
  s_branch L_a_kernel_poll
L_a_kernel_go:
  v_and_b32 v8, 0xffff0000, v32
  v_and_b32 v9, 0xffff0000, v34
  v_lshlrev_b32 v10, 16, v32
  v_lshlrev_b32 v11, 16, v34
  v_rcp_f32 v32, v8
  v_rcp_f32 v33, v9
  s_nop 0
  v_mul_f32 v34, -v10, v32
  v_mul_f32 v35, -v11, v33
  ds_write_b128 v108, v[32:35] offset:0
  v_and_b32 v8, 0xffff0000, v36
  v_and_b32 v9, 0xffff0000, v38
  v_lshlrev_b32 v10, 16, v36
  v_lshlrev_b32 v11, 16, v38
  v_rcp_f32 v36, v8
  v_rcp_f32 v37, v9
  s_nop 0
  v_mul_f32 v38, -v10, v36
  v_mul_f32 v39, -v11, v37
  ds_write_b128 v108, v[36:39] offset:9728
  ds_read_b128 v[32:35], v109 offset:0
  ds_read_b128 v[36:39], v109 offset:16
  s_waitcnt lgkmcnt(0)
  v_fma_f32 v8, v48, v32, v34
  v_fma_f32 v9, v49, v33, v35
  v_cvt_pk_bf16_f32 v80, v8, v9
  v_fma_f32 v10, v50, v36, v38
  v_fma_f32 v11, v51, v37, v39
  v_cvt_pk_bf16_f32 v81, v10, v11
  ds_write_b64 v7, v[80:81] offset:128
  v_fma_f32 v8, v56, v32, v34
  v_fma_f32 v9, v57, v33, v35
  v_cvt_pk_bf16_f32 v82, v8, v9
  v_fma_f32 v10, v58, v36, v38
  v_fma_f32 v11, v59, v37, v39
  v_cvt_pk_bf16_f32 v83, v10, v11
  ds_write_b64 v7, v[82:83] offset:4992
  v_fma_f32 v8, v64, v32, v34
  v_fma_f32 v9, v65, v33, v35
  v_cvt_pk_bf16_f32 v84, v8, v9
  v_fma_f32 v10, v66, v36, v38
  v_fma_f32 v11, v67, v37, v39
  v_cvt_pk_bf16_f32 v85, v10, v11
  ds_write_b64 v7, v[84:85] offset:9856
  v_fma_f32 v8, v72, v32, v34
  v_fma_f32 v9, v73, v33, v35
  v_cvt_pk_bf16_f32 v86, v8, v9
  v_fma_f32 v10, v74, v36, v38
  v_fma_f32 v11, v75, v37, v39
  v_cvt_pk_bf16_f32 v87, v10, v11
  ds_write_b64 v7, v[86:87] offset:14720
  buffer_load_dwordx2 v[30:31], v6, s[4:7], s18 offen
  s_waitcnt lgkmcnt(0)
  s_barrier
  v_and_b32 v8, 0xffff0000, v40
  v_and_b32 v9, 0xffff0000, v42
  v_lshlrev_b32 v10, 16, v40
  v_lshlrev_b32 v11, 16, v42
  v_rcp_f32 v40, v8
  v_rcp_f32 v41, v9
  s_nop 0
  v_mul_f32 v42, -v10, v40
  v_mul_f32 v43, -v11, v41
  ds_write_b128 v108, v[40:43] offset:512
  v_and_b32 v8, 0xffff0000, v44
  v_and_b32 v9, 0xffff0000, v46
  v_lshlrev_b32 v10, 16, v44
  v_lshlrev_b32 v11, 16, v46
  v_rcp_f32 v44, v8
  v_rcp_f32 v45, v9
  s_nop 0
  v_mul_f32 v46, -v10, v44
  v_mul_f32 v47, -v11, v45
  ds_write_b128 v108, v[44:47] offset:10240
  ds_read_b128 v[40:43], v109 offset:512
  ds_read_b128 v[44:47], v109 offset:528
  s_waitcnt vmcnt(3)
  v_lshlrev_b32 v52, 16, v24
  v_and_b32 v60, 0xffff0000, v24
  v_lshlrev_b32 v68, 16, v25
  v_and_b32 v76, 0xffff0000, v25
  s_waitcnt vmcnt(2)
  v_lshlrev_b32 v53, 16, v26
  v_and_b32 v61, 0xffff0000, v26
  v_lshlrev_b32 v69, 16, v27
  v_and_b32 v77, 0xffff0000, v27
  s_waitcnt vmcnt(1)
  v_lshlrev_b32 v54, 16, v28
  v_and_b32 v62, 0xffff0000, v28
  v_lshlrev_b32 v70, 16, v29
  v_and_b32 v78, 0xffff0000, v29
  s_waitcnt vmcnt(0)
  v_lshlrev_b32 v55, 16, v30
  v_and_b32 v63, 0xffff0000, v30
  v_lshlrev_b32 v71, 16, v31
  v_and_b32 v79, 0xffff0000, v31
  s_waitcnt lgkmcnt(0)
  v_fma_f32 v8, v52, v40, v42
  v_fma_f32 v9, v53, v41, v43
  v_cvt_pk_bf16_f32 v80, v8, v9
  v_fma_f32 v10, v54, v44, v46
  v_fma_f32 v11, v55, v45, v47
  v_cvt_pk_bf16_f32 v81, v10, v11
  ds_write_b64 v7, v[80:81] offset:640
  v_fma_f32 v8, v60, v40, v42
  v_fma_f32 v9, v61, v41, v43
  v_cvt_pk_bf16_f32 v82, v8, v9
  v_fma_f32 v10, v62, v44, v46
  v_fma_f32 v11, v63, v45, v47
  v_cvt_pk_bf16_f32 v83, v10, v11
  ds_write_b64 v7, v[82:83] offset:5504
  v_fma_f32 v8, v68, v40, v42
  v_fma_f32 v9, v69, v41, v43
  v_cvt_pk_bf16_f32 v84, v8, v9
  v_fma_f32 v10, v70, v44, v46
  v_fma_f32 v11, v71, v45, v47
  v_cvt_pk_bf16_f32 v85, v10, v11
  ds_write_b64 v7, v[84:85] offset:10368
  v_fma_f32 v8, v76, v40, v42
  v_fma_f32 v9, v77, v41, v43
  v_cvt_pk_bf16_f32 v86, v8, v9
  v_fma_f32 v10, v78, v44, v46
  v_fma_f32 v11, v79, v45, v47
  v_cvt_pk_bf16_f32 v87, v10, v11
  ds_write_b64 v7, v[86:87] offset:15232
  v_mov_b32 v34, 154688
  v_mov_b32 v35, 1
  s_mov_b64 exec, 1
  ds_add_u32 v34, v35 offset:4
  s_mov_b64 exec, -1
  s_mul_i32 s20, s2, 320
  v_min_u32 v14, 79, v0
  v_lshlrev_b32 v14, 2, v14
  buffer_store_dword v112, v14, s[84:87], s20 offen sc1
  s_cmp_lg_u32 s2, 0
  s_cbranch_scc1 L_a_kernel_noep
  v_mov_b32 v8, 25198592
  v_mov_b32 v9, s70
  global_store_dword v8, v9, s[24:25]
L_a_kernel_noep:
  v_and_b32 v7, 31, v2
  v_lshl_add_u32 v7, s28, 5, v7
  v_lshlrev_b32 v7, 2, v7
  v_lshl_add_u32 v7, v111, 12, v7
  v_add_u32 v7, 23680, v7
  v_add_u32 v8, 33792, v7
  v_add_u32 v9, 67584, v7
  v_add_u32 v10, 101376, v7
  v_mul_u32_u24 v12, 3056, v111
  v_sub_u32 v32, v7, v12
  v_add_u32 v33, 67584, v32
  s_lshl_b32 s20, s28, 13
  v_lshl_add_u32 v11, v2, 4, s20
  s_and_b32 s20, s26, 1
  s_lshl_b32 s20, s20, 3
  v_add_u32 v11, s20, v11
  s_lshr_b32 s20, s26, 1
  s_lshl_b32 s20, s20, 15
  s_add_u32 s21, s20, 4096
  v_and_b32 v12, 15, v2
  v_and_b32 v13, 1, v2
  v_lshlrev_b32 v13, 4, v13
  v_mov_b32 v14, 0x3f80
  v_lshlrev_b32 v13, v13, v14
  v_lshrrev_b32 v14, 1, v12
  v_cmp_eq_u32 vcc, 0, v14
  s_nop 1
  v_cndmask_b32 v116, 0, v13, vcc
  v_cmp_eq_u32 vcc, 1, v14
  s_nop 1
  v_cndmask_b32 v117, 0, v13, vcc
  v_cmp_eq_u32 vcc, 2, v14
  s_nop 1
  v_cndmask_b32 v118, 0, v13, vcc
  v_cmp_eq_u32 vcc, 3, v14
  s_nop 1
  v_cndmask_b32 v119, 0, v13, vcc
  v_lshlrev_b32 v12, 5, v12
  v_lshrrev_b32 v13, 4, v2
  v_and_b32 v14, 1, v13
  v_lshl_add_u32 v12, v14, 4, v12
  v_lshrrev_b32 v13, 1, v13
  v_lshl_add_u32 v12, v13, 9, v12
  s_mul_i32 s19, s28, 33792
  s_add_u32 s19, s19, 33984
  v_add_u32 v124, s19, v12
  s_add_u32 s84, s24, 25427968
  s_addc_u32 s85, s25, 0
  s_cmp_lt_u32 s2, 224
  s_cselect_b32 s86, 114688, 0
  s_mov_b32 s87, 0x20000
  v_and_b32 v125, 127, v0
  v_lshlrev_b32 v125, 2, v125
  v_add_u32 v126, 33984, v125
  v_add_u32 v3, 67584, v126
  buffer_load_dwordx4 a[8:11], v110, s[44:47], s92 offen
  s_add_u32 s92, s92, 28672
  buffer_load_dwordx4 a[12:15], v110, s[44:47], s92 offen
  s_add_u32 s92, s92, 28672
  buffer_load_dwordx4 a[16:19], v110, s[44:47], s92 offen
  s_add_u32 s92, s92, 28672
  buffer_load_dwordx4 a[20:23], v110, s[44:47], s92 offen
  s_add_u32 s92, s92, 28672
  buffer_load_dwordx4 a[24:27], v110, s[44:47], s92 offen
  s_add_u32 s92, s92, 28672
  buffer_load_dwordx4 a[28:31], v110, s[44:47], s92 offen
  s_add_u32 s92, s92, 28672
  buffer_load_dwordx4 a[32:35], v110, s[44:47], s92 offen
  s_add_u32 s92, s92, 28672
  buffer_load_dwordx4 a[36:39], v110, s[44:47], s92 offen
  s_add_u32 s92, s92, 28672
  buffer_load_dwordx4 a[40:43], v110, s[44:47], s92 offen
  s_add_u32 s92, s92, 28672
  buffer_load_dwordx4 a[44:47], v110, s[44:47], s92 offen
  s_add_u32 s92, s92, 28672
  buffer_load_dwordx4 a[48:51], v110, s[44:47], s92 offen
  s_add_u32 s92, s92, 28672
  buffer_load_dwordx4 a[52:55], v110, s[44:47], s92 offen
  s_add_u32 s92, s92, 28672
  buffer_load_dwordx4 a[56:59], v110, s[44:47], s92 offen
  s_add_u32 s92, s92, 28672
  buffer_load_dwordx4 a[60:63], v110, s[44:47], s92 offen
  s_cmp_ge_u32 s28, 2
  s_cselect_b32 s76, s74, s72
  s_cselect_b32 s77, s75, s73
  s_lshr_b32 s22, s2, 3
  s_lshl_b32 s22, s22, 1
  s_and_b32 s23, s28, 1
  s_add_u32 s22, s22, s23
  s_mul_i32 s22, s22, 2
  s_and_b32 s23, s2, 0
  s_lshl_b32 s23, s23, 7
  s_add_u32 s22, s22, s23
  s_bfe_u32 s23, s2, 0x20001
  s_mul_i32 s23, s23, 1792
  v_min_u32 v12, 27, v2
  v_mul_u32_u24 v13, 4682, v12
  v_lshrrev_b32 v13, 16, v13
  v_mul_u32_u24 v14, 14, v13
  v_sub_u32 v12, v12, v14
  v_add_u32 v13, s22, v13
  v_and_b32 v13, 1023, v13
  v_mul_u32_u24 v13, 7168, v13
  v_lshl_add_u32 v12, v12, 7, v13
  v_add_u32 v12, s23, v12
  global_load_dword v127, v12, s[76:77]
  v_lshlrev_b32 v12, 6, v0
  s_getpc_b64 s[76:77]
L_a_kernel_pc_b_kernel:
  s_add_u32 s76, s76, b_kernel-L_a_kernel_pc_b_kernel
  s_addc_u32 s77, s77, 0
  global_load_dword v127, v12, s[76:77]
  s_getpc_b64 s[76:77]
L_a_kernel_pc_L_b_kernel_go:
  s_add_u32 s76, s76, L_b_kernel_go-L_a_kernel_pc_L_b_kernel_go
  s_addc_u32 s77, s77, 0
  global_load_dword v127, v12, s[76:77]
L_a_kernel_hspin:
  ds_read_b32 v35, v34 offset:8
  s_waitcnt lgkmcnt(0)
  v_readfirstlane_b32 s22, v35
  s_cmp_ge_u32 s22, 4
  s_cbranch_scc1 L_a_kernel_hgo
  s_sleep 2
  s_branch L_a_kernel_hspin
L_a_kernel_hgo:
  ds_read_b32 v16, v32 offset:8192
  ds_read_b32 v17, v32 offset:41984
  ds_read_b32 v18, v33 offset:8192
  ds_read_b32 v19, v33 offset:41984
  ds_read2st64_b32 v[80:81], v7 offset0:0 offset1:4
  ds_read2st64_b32 v[84:85], v8 offset0:0 offset1:4
  ds_read2st64_b32 v[88:89], v9 offset0:0 offset1:4
  ds_read2st64_b32 v[92:93], v10 offset0:0 offset1:4
  ds_read2st64_b32 v[82:83], v7 offset0:8 offset1:12
  ds_read2st64_b32 v[86:87], v8 offset0:8 offset1:12
  ds_read2st64_b32 v[90:91], v9 offset0:8 offset1:12
  ds_read2st64_b32 v[94:95], v10 offset0:8 offset1:12
  s_waitcnt lgkmcnt(8)
  v_add_f32 v48, v48, v16
  v_add_f32 v56, v56, v17
  v_add_f32 v64, v64, v18
  v_add_f32 v72, v72, v19
  s_waitcnt lgkmcnt(4)
  v_add_f32 v80, v80, v48
  v_add_f32 v84, v84, v56
  v_add_f32 v88, v88, v64
  v_add_f32 v92, v92, v72
  v_cvt_pk_bf16_f32 v24, v80, v84
  v_cvt_pk_bf16_f32 v25, v88, v92
  buffer_store_dwordx2 v[24:25], v11, s[12:15], s20 offen offset:0
  v_add_f32 v81, v81, v49
  v_add_f32 v85, v85, v57
  v_add_f32 v89, v89, v65
  v_add_f32 v93, v93, v73
  v_cvt_pk_bf16_f32 v26, v81, v85
  v_cvt_pk_bf16_f32 v27, v89, v93
  buffer_store_dwordx2 v[26:27], v11, s[12:15], s20 offen offset:1024
  s_waitcnt lgkmcnt(0)
  v_add_f32 v82, v82, v50
  v_add_f32 v86, v86, v58
  v_add_f32 v90, v90, v66
  v_add_f32 v94, v94, v74
  v_cvt_pk_bf16_f32 v28, v82, v86
  v_cvt_pk_bf16_f32 v29, v90, v94
  buffer_store_dwordx2 v[28:29], v11, s[12:15], s20 offen offset:2048
  v_add_f32 v83, v83, v51
  v_add_f32 v87, v87, v59
  v_add_f32 v91, v91, v67
  v_add_f32 v95, v95, v75
  v_cvt_pk_bf16_f32 v30, v83, v87
  v_cvt_pk_bf16_f32 v31, v91, v95
  buffer_store_dwordx2 v[30:31], v11, s[12:15], s20 offen offset:3072
  s_barrier
  ds_read_b32 v16, v32 offset:8704
  ds_read_b32 v17, v32 offset:42496
  ds_read_b32 v18, v33 offset:8704
  ds_read_b32 v19, v33 offset:42496
  ds_read2st64_b32 v[80:81], v7 offset0:2 offset1:6
  ds_read2st64_b32 v[84:85], v8 offset0:2 offset1:6
  ds_read2st64_b32 v[88:89], v9 offset0:2 offset1:6
  ds_read2st64_b32 v[92:93], v10 offset0:2 offset1:6
  ds_read2st64_b32 v[82:83], v7 offset0:10 offset1:14
  ds_read2st64_b32 v[86:87], v8 offset0:10 offset1:14
  ds_read2st64_b32 v[90:91], v9 offset0:10 offset1:14
  ds_read2st64_b32 v[94:95], v10 offset0:10 offset1:14
  s_waitcnt lgkmcnt(8)
  v_add_f32 v52, v52, v16
  v_add_f32 v60, v60, v17
  v_add_f32 v68, v68, v18
  v_add_f32 v76, v76, v19
  s_waitcnt lgkmcnt(4)
  v_add_f32 v80, v80, v52
  v_add_f32 v84, v84, v60
  v_add_f32 v88, v88, v68
  v_add_f32 v92, v92, v76
  v_cvt_pk_bf16_f32 v24, v80, v84
  v_cvt_pk_bf16_f32 v25, v88, v92
  buffer_store_dwordx2 v[24:25], v11, s[12:15], s21 offen offset:0
  v_add_f32 v81, v81, v53
  v_add_f32 v85, v85, v61
  v_add_f32 v89, v89, v69
  v_add_f32 v93, v93, v77
  v_cvt_pk_bf16_f32 v26, v81, v85
  v_cvt_pk_bf16_f32 v27, v89, v93
  buffer_store_dwordx2 v[26:27], v11, s[12:15], s21 offen offset:1024
  s_waitcnt lgkmcnt(0)
  v_add_f32 v82, v82, v54
  v_add_f32 v86, v86, v62
  v_add_f32 v90, v90, v70
  v_add_f32 v94, v94, v78
  v_cvt_pk_bf16_f32 v28, v82, v86
  v_cvt_pk_bf16_f32 v29, v90, v94
  buffer_store_dwordx2 v[28:29], v11, s[12:15], s21 offen offset:2048
  v_add_f32 v83, v83, v55
  v_add_f32 v87, v87, v63
  v_add_f32 v91, v91, v71
  v_add_f32 v95, v95, v79
  v_cvt_pk_bf16_f32 v30, v83, v87
  v_cvt_pk_bf16_f32 v31, v91, v95
  buffer_store_dwordx2 v[30:31], v11, s[12:15], s21 offen offset:3072
  s_waitcnt vmcnt(11)
  v_mfma_f32_16x16x32_bf16 v[120:123], v[116:119], a[0:3], 0
  v_mfma_f32_16x16x32_bf16 v[120:123], v[116:119], a[4:7], v[120:123]
  v_mfma_f32_16x16x32_bf16 v[120:123], v[116:119], a[8:11], v[120:123]
  v_mfma_f32_16x16x32_bf16 v[120:123], v[116:119], a[12:15], v[120:123]
  v_mfma_f32_16x16x32_bf16 v[120:123], v[116:119], a[16:19], v[120:123]
  v_mfma_f32_16x16x32_bf16 v[120:123], v[116:119], a[20:23], v[120:123]
  v_mfma_f32_16x16x32_bf16 v[120:123], v[116:119], a[24:27], v[120:123]
  v_mfma_f32_16x16x32_bf16 v[120:123], v[116:119], a[28:31], v[120:123]
  v_mfma_f32_16x16x32_bf16 v[120:123], v[116:119], a[32:35], v[120:123]
  v_mfma_f32_16x16x32_bf16 v[120:123], v[116:119], a[36:39], v[120:123]
  v_mfma_f32_16x16x32_bf16 v[120:123], v[116:119], a[40:43], v[120:123]
  v_mfma_f32_16x16x32_bf16 v[120:123], v[116:119], a[44:47], v[120:123]
  v_mfma_f32_16x16x32_bf16 v[120:123], v[116:119], a[48:51], v[120:123]
  v_mfma_f32_16x16x32_bf16 v[120:123], v[116:119], a[52:55], v[120:123]
  v_mfma_f32_16x16x32_bf16 v[120:123], v[116:119], a[56:59], v[120:123]
  v_mfma_f32_16x16x32_bf16 v[120:123], v[116:119], a[60:63], v[120:123]
  s_nop 7
  ds_write_b128 v124, v[120:123]
  s_waitcnt lgkmcnt(0)
  s_barrier
  ds_read_b32 v14, v126
  ds_read_b32 v15, v126 offset:33792
  ds_read_b32 v16, v3
  ds_read_b32 v17, v3 offset:33792
  s_waitcnt lgkmcnt(0)
  v_add_f32 v14, v14, v15
  v_add_f32 v16, v16, v17
  v_add_f32 v14, v14, v16
  buffer_store_dword v14, v125, s[84:87], s93 offen
L_a_kernel_end:
  s_endpgm

.text
.globl b_kernel
.p2align 8
.type b_kernel,@function
b_kernel:
  s_cmp_ge_u32 s2, 256
  s_cbranch_scc1 L_b_kernel_end
  s_load_dwordx8 s[88:95], s[0:1], 80
  s_load_dwordx2 s[24:25], s[0:1], 120
  v_lshrrev_b32 v10, 6, v0
  v_and_b32 v11, 63, v0
  s_and_b32 s26, s2, 7
  s_lshr_b32 s27, s2, 3
  v_readfirstlane_b32 s28, v10
  s_and_b32 s3, s26, 1
  s_lshl_b32 s3, s3, 2
  s_and_b32 s29, s27, 3
  s_add_u32 s3, s3, s29
  s_lshr_b32 s26, s26, 1
  s_lshl_b32 s26, s26, 3
  s_lshr_b32 s27, s27, 2
  s_add_u32 s26, s26, s27
  s_lshl_b32 s52, s3, 1
  s_lshr_b32 s29, s26, 4
  s_add_u32 s52, s52, s29
  s_lshl_b32 s52, s52, 7
  s_lshl_b32 s3, s3, 8
  s_lshl_b32 s54, s26, 3
  s_add_u32 s54, s54, s3
  s_lshl_b32 s29, s28, 6
  s_add_u32 s3, s3, s29
  s_and_b32 s29, s28, 1
  s_lshl_b32 s29, s29, 5
  s_movk_i32 s19, 4682
  s_movk_i32 s20, 7168
  v_add_u32 v22, 0, v11
  v_mul_u32_u24 v23, s19, v22
  v_lshrrev_b32 v23, 16, v23
  v_mul_u32_u24 v14, 14, v23
  v_sub_u32 v22, v22, v14
  v_and_b32 v14, 4, v23
  v_and_b32 v15, 8, v23
  v_and_b32 v23, 0x13, v23
  v_lshl_or_b32 v23, v14, 1, v23
  v_lshrrev_b32 v15, 1, v15
  v_or3_b32 v23, v23, v15, s29
  v_mul_u32_u24 v23, s20, v23
  v_lshl_add_u32 v1, v22, 4, v23
  v_add_u32 v22, 64, v11
  v_mul_u32_u24 v23, s19, v22
  v_lshrrev_b32 v23, 16, v23
  v_mul_u32_u24 v14, 14, v23
  v_sub_u32 v22, v22, v14
  v_and_b32 v14, 4, v23
  v_and_b32 v15, 8, v23
  v_and_b32 v23, 0x13, v23
  v_lshl_or_b32 v23, v14, 1, v23
  v_lshrrev_b32 v15, 1, v15
  v_or3_b32 v23, v23, v15, s29
  v_mul_u32_u24 v23, s20, v23
  v_lshl_add_u32 v2, v22, 4, v23
  v_add_u32 v22, 128, v11
  v_mul_u32_u24 v23, s19, v22
  v_lshrrev_b32 v23, 16, v23
  v_mul_u32_u24 v14, 14, v23
  v_sub_u32 v22, v22, v14
  v_and_b32 v14, 4, v23
  v_and_b32 v15, 8, v23
  v_and_b32 v23, 0x13, v23
  v_lshl_or_b32 v23, v14, 1, v23
  v_lshrrev_b32 v15, 1, v15
  v_or3_b32 v23, v23, v15, s29
  v_mul_u32_u24 v23, s20, v23
  v_lshl_add_u32 v3, v22, 4, v23
  v_add_u32 v22, 192, v11
  v_mul_u32_u24 v23, s19, v22
  v_lshrrev_b32 v23, 16, v23
  v_mul_u32_u24 v14, 14, v23
  v_sub_u32 v22, v22, v14
  v_and_b32 v14, 4, v23
  v_and_b32 v15, 8, v23
  v_and_b32 v23, 0x13, v23
  v_lshl_or_b32 v23, v14, 1, v23
  v_lshrrev_b32 v15, 1, v15
  v_or3_b32 v23, v23, v15, s29
  v_mul_u32_u24 v23, s20, v23
  v_lshl_add_u32 v4, v22, 4, v23
  v_add_u32 v22, 256, v11
  v_mul_u32_u24 v23, s19, v22
  v_lshrrev_b32 v23, 16, v23
  v_mul_u32_u24 v14, 14, v23
  v_sub_u32 v22, v22, v14
  v_and_b32 v14, 4, v23
  v_and_b32 v15, 8, v23
  v_and_b32 v23, 0x13, v23
  v_lshl_or_b32 v23, v14, 1, v23
  v_lshrrev_b32 v15, 1, v15
  v_or3_b32 v23, v23, v15, s29
  v_mul_u32_u24 v23, s20, v23
  v_lshl_add_u32 v5, v22, 4, v23
  v_add_u32 v22, 320, v11
  v_mul_u32_u24 v23, s19, v22
  v_lshrrev_b32 v23, 16, v23
  v_mul_u32_u24 v14, 14, v23
  v_sub_u32 v22, v22, v14
  v_and_b32 v14, 4, v23
  v_and_b32 v15, 8, v23
  v_and_b32 v23, 0x13, v23
  v_lshl_or_b32 v23, v14, 1, v23
  v_lshrrev_b32 v15, 1, v15
  v_or3_b32 v23, v23, v15, s29
  v_mul_u32_u24 v23, s20, v23
  v_lshl_add_u32 v6, v22, 4, v23
  v_add_u32 v22, 384, v11
  v_mul_u32_u24 v23, s19, v22
  v_lshrrev_b32 v23, 16, v23
  v_mul_u32_u24 v14, 14, v23
  v_sub_u32 v22, v22, v14
  v_and_b32 v14, 4, v23
  v_and_b32 v15, 8, v23
  v_and_b32 v23, 0x13, v23
  v_lshl_or_b32 v23, v14, 1, v23
  v_lshrrev_b32 v15, 1, v15
  v_or3_b32 v23, v23, v15, s29
  v_mul_u32_u24 v23, s20, v23
  v_lshl_add_u32 v7, v22, 4, v23
  v_lshrrev_b32 v12, 4, v11
  v_and_b32 v13, 15, v11
  v_add_u32 v13, s3, v13
  v_lshlrev_b32 v14, 11, v12
  v_add_lshl_u32 v8, v14, v13, 4
  s_mul_i32 s18, s28, 7168
  s_add_u32 s18, s18, 57344
  s_and_b32 s17, s2, 0
  s_mul_i32 s16, s17, 917504
  s_lshl_b32 s17, s17, 19
  s_mov_b32 s7, 0x20000
  s_mov_b32 s10, 4194304
  s_mov_b32 s11, 0x20000
  s_mul_i32 s27, s26, 224
  s_sub_u32 s6, 7340032, s27
  s_cmp_ge_u32 s28, 2
  s_waitcnt lgkmcnt(0)
  s_cselect_b32 s4, s90, s88
  s_cselect_b32 s5, s91, s89
  s_add_u32 s4, s4, s27
  s_addc_u32 s5, s5, 0
  s_add_u32 s8, s24, 0
  s_addc_u32 s9, s25, 0
  s_add_u32 m0, s18, 0
  s_nop 0
  buffer_load_dwordx4 v1, s[4:7], s16 offen  lds
  s_add_u32 m0, s18, 1024
  s_nop 0
  buffer_load_dwordx4 v2, s[4:7], s16 offen  lds
  s_add_u32 m0, s18, 2048
  s_nop 0
  buffer_load_dwordx4 v3, s[4:7], s16 offen  lds
  s_add_u32 m0, s18, 3072
  s_nop 0
  buffer_load_dwordx4 v4, s[4:7], s16 offen  lds
  s_add_u32 m0, s18, 4096
  s_nop 0
  buffer_load_dwordx4 v5, s[4:7], s16 offen  lds
  s_add_u32 m0, s18, 5120
  s_nop 0
  buffer_load_dwordx4 v6, s[4:7], s16 offen  lds
  s_add_u32 m0, s18, 6144
  s_nop 0
  buffer_load_dwordx4 v7, s[4:7], s16 offen  lds
  s_add_u32 s16, s16, 458752
  buffer_load_dwordx4 a[16:19], v8, s[8:11], s17 offen offset:0 sc1
  buffer_load_dwordx4 a[20:23], v8, s[8:11], s17 offen offset:256 sc1
  buffer_load_dwordx4 a[24:27], v8, s[8:11], s17 offen offset:512 sc1
  buffer_load_dwordx4 a[28:31], v8, s[8:11], s17 offen offset:768 sc1
  s_add_u32 s17, s17, 131072
  buffer_load_dwordx4 a[32:35], v8, s[8:11], s17 offen offset:0 sc1
  buffer_load_dwordx4 a[36:39], v8, s[8:11], s17 offen offset:256 sc1
  buffer_load_dwordx4 a[40:43], v8, s[8:11], s17 offen offset:512 sc1
  buffer_load_dwordx4 a[44:47], v8, s[8:11], s17 offen offset:768 sc1
  s_add_u32 s17, s17, 131072
  s_mov_b32 s21, -57344
  s_mov_b32 s22, -57344
  v_lshrrev_b32 v14, 1, v12
  v_and_b32 v15, 1, v12
  v_lshlrev_b32 v16, 11, v14
  v_lshl_add_u32 v16, v15, 4, v16
  v_add_lshl_u32 v10, v16, v13, 4
  v_lshlrev_b32 v14, 4, v14
  v_lshl_add_u32 v14, v15, 2, v14
  v_bfe_u32 v15, v11, 2, 2
  v_add_u32 v14, v14, v15
  v_mul_u32_u24 v14, 224, v14
  v_and_b32 v15, 3, v11
  v_lshl_add_u32 v9, v15, 3, v14
  v_add_u32 v9, 57344, v9
  v_lshlrev_b32 v26, 2, v13
  v_lshlrev_b32 v27, 4, v12
  v_add_u32 v27, 131072, v27
  v_lshrrev_b32 v16, 3, v0
  v_and_b32 v17, 7, v0
  v_lshlrev_b32 v16, 15, v16
  v_lshl_add_u32 v16, v17, 4, v16
  v_add_lshl_u32 v21, v17, s54, 2
  v_lshlrev_b32 v17, 3, v17
  v_add_u32 v17, 132096, v17
  s_lshl_b32 s29, s28, 6
  v_add_u32 v20, s29, v17
  s_lshl_b32 s55, s54, 4
  v_min_u32 v18, 223, v0
  v_cmp_le_u32 vcc, 112, v18
  v_lshlrev_b32 v18, 2, v18
  v_add_u32 v19, 13888, v18
  s_mul_i32 s59, s26, 448
  v_cndmask_b32 v19, v18, v19, vcc
  v_add_u32 v18, 131072, v18
  v_and_b32 v11, 7, v11
  s_mul_i32 s29, s28, 8
  v_add_lshl_u32 v11, v11, s29, 7
  s_mul_i32 s72, s2, 4096
  s_add_u32 s60, s24, 25427968
  s_addc_u32 s61, s25, 0
  s_mov_b32 s62, 114688
  s_mov_b32 s63, 0x20000
  s_add_u32 s12, s24, 8388608
  s_addc_u32 s13, s25, 0
  s_mov_b32 s14, 14680064
  s_mov_b32 s15, 0x20000
  s_add_u32 s64, s24, 25231360
  s_addc_u32 s65, s25, 0
  s_mov_b32 s66, 81920
  s_mov_b32 s67, 0x20000
  s_mov_b32 s68, s92
  s_mov_b32 s69, s93
  s_mov_b32 s70, 7340032
  s_mov_b32 s71, 0x20000
  s_getpc_b64 s[56:57]
L_b_kernel_pc:
  s_add_u32 s56, s56, L_b_kernel_go-L_b_kernel_pc
  s_addc_u32 s57, s57, 0
  v_and_b32 v22, 31, v0
  v_lshlrev_b32 v22, 7, v22
  s_lshl_b32 s29, s28, 12
  v_add_u32 v14, s29, v22
  v_mov_b32 v22, 0
  v_mov_b32 v23, 0
  s_mov_b32 s23, 0x3f803f80
  s_mov_b32 s19, 1
  s_waitcnt vmcnt(8)
  s_barrier
  ds_read_b64_tr_b16 a[0:1], v9 offset:0
  ds_read_b64_tr_b16 a[2:3], v9 offset:1792
  ds_read_b64_tr_b16 a[4:5], v9 offset:14336
  ds_read_b64_tr_b16 a[6:7], v9 offset:16128
  ds_read_b64_tr_b16 a[8:9], v9 offset:32
  ds_read_b64_tr_b16 a[10:11], v9 offset:1824
  s_waitcnt vmcnt(4) lgkmcnt(4)
  v_mfma_f32_16x16x32_bf16 v[32:35], a[0:3], a[16:19], 0
  ds_read_b64_tr_b16 a[12:13], v9 offset:14368
  ds_read_b64_tr_b16 a[14:15], v9 offset:16160
  v_mfma_f32_16x16x32_bf16 v[36:39], a[0:3], a[20:23], 0
  s_add_u32 m0, s18, 28672
  v_mfma_f32_16x16x32_bf16 v[40:43], a[0:3], a[24:27], 0
  buffer_load_dwordx4 v1, s[4:7], s16 offen  lds
  v_mfma_f32_16x16x32_bf16 v[44:47], a[0:3], a[28:31], 0
  s_waitcnt lgkmcnt(4)
  v_mfma_f32_16x16x32_bf16 v[60:63], a[4:7], a[28:31], 0
  ds_read_b64_tr_b16 a[0:1], v9 offset:64
  ds_read_b64_tr_b16 a[2:3], v9 offset:1856
  v_mfma_f32_16x16x32_bf16 v[56:59], a[4:7], a[24:27], 0
  s_add_u32 m0, s18, 29696
  v_mfma_f32_16x16x32_bf16 v[52:55], a[4:7], a[20:23], 0
  buffer_load_dwordx4 v2, s[4:7], s16 offen  lds
  v_mfma_f32_16x16x32_bf16 v[48:51], a[4:7], a[16:19], 0
  s_waitcnt lgkmcnt(4)
  v_mfma_f32_16x16x32_bf16 v[64:67], a[8:11], a[16:19], 0
  ds_read_b64_tr_b16 a[4:5], v9 offset:14400
  ds_read_b64_tr_b16 a[6:7], v9 offset:16192
  v_mfma_f32_16x16x32_bf16 v[68:71], a[8:11], a[20:23], 0
  s_add_u32 m0, s18, 30720
  v_mfma_f32_16x16x32_bf16 v[72:75], a[8:11], a[24:27], 0
  buffer_load_dwordx4 v3, s[4:7], s16 offen  lds
  v_mfma_f32_16x16x32_bf16 v[76:79], a[8:11], a[28:31], 0
  s_waitcnt lgkmcnt(4)
  v_mfma_f32_16x16x32_bf16 v[92:95], a[12:15], a[28:31], 0
  ds_read_b64_tr_b16 a[8:9], v9 offset:96
  ds_read_b64_tr_b16 a[10:11], v9 offset:1888
  v_mfma_f32_16x16x32_bf16 v[88:91], a[12:15], a[24:27], 0
  s_add_u32 m0, s18, 31744
  v_mfma_f32_16x16x32_bf16 v[84:87], a[12:15], a[20:23], 0
  buffer_load_dwordx4 v4, s[4:7], s16 offen  lds
  v_mfma_f32_16x16x32_bf16 v[80:83], a[12:15], a[16:19], 0
  s_waitcnt lgkmcnt(4)
  v_mfma_f32_16x16x32_bf16 v[96:99], a[0:3], a[16:19], 0
  ds_read_b64_tr_b16 a[12:13], v9 offset:14432
  ds_read_b64_tr_b16 a[14:15], v9 offset:16224
  v_mfma_f32_16x16x32_bf16 v[100:103], a[0:3], a[20:23], 0
  s_add_u32 m0, s18, 32768
  v_mfma_f32_16x16x32_bf16 v[104:107], a[0:3], a[24:27], 0
  buffer_load_dwordx4 v5, s[4:7], s16 offen  lds
  v_mfma_f32_16x16x32_bf16 v[108:111], a[0:3], a[28:31], 0
  s_waitcnt lgkmcnt(4)
  v_mfma_f32_16x16x32_bf16 v[124:127], a[4:7], a[28:31], 0
  ds_read_b64_tr_b16 a[0:1], v9 offset:128
  ds_read_b64_tr_b16 a[2:3], v9 offset:1920
  v_mfma_f32_16x16x32_bf16 v[120:123], a[4:7], a[24:27], 0
  s_add_u32 m0, s18, 33792
  v_mfma_f32_16x16x32_bf16 v[116:119], a[4:7], a[20:23], 0
  buffer_load_dwordx4 v6, s[4:7], s16 offen  lds
  v_mfma_f32_16x16x32_bf16 v[112:115], a[4:7], a[16:19], 0
  s_waitcnt lgkmcnt(4)
  v_mfma_f32_16x16x32_bf16 v[128:131], a[8:11], a[16:19], 0
  ds_read_b64_tr_b16 a[4:5], v9 offset:14464
  ds_read_b64_tr_b16 a[6:7], v9 offset:16256
  v_mfma_f32_16x16x32_bf16 v[132:135], a[8:11], a[20:23], 0
  s_add_u32 m0, s18, 34816
  v_mfma_f32_16x16x32_bf16 v[136:139], a[8:11], a[24:27], 0
  buffer_load_dwordx4 v7, s[4:7], s16 offen  lds
  s_add_u32 s16, s16, 458752
  s_add_u32 s18, s18, s22
  s_sub_u32 s22, 0, s22
  v_mfma_f32_16x16x32_bf16 v[140:143], a[8:11], a[28:31], 0
  s_waitcnt lgkmcnt(4)
  v_mfma_f32_16x16x32_bf16 v[156:159], a[12:15], a[28:31], 0
  ds_read_b64_tr_b16 a[8:9], v9 offset:160
  ds_read_b64_tr_b16 a[10:11], v9 offset:1952
  v_mfma_f32_16x16x32_bf16 v[152:155], a[12:15], a[24:27], 0
  buffer_load_dwordx4 a[48:51], v8, s[8:11], s17 offen offset:0 sc1
  v_mfma_f32_16x16x32_bf16 v[148:151], a[12:15], a[20:23], 0
  v_mfma_f32_16x16x32_bf16 v[144:147], a[12:15], a[16:19], 0
  s_waitcnt lgkmcnt(4)
  v_mfma_f32_16x16x32_bf16 v[160:163], a[0:3], a[16:19], 0
  ds_read_b64_tr_b16 a[12:13], v9 offset:14496
  ds_read_b64_tr_b16 a[14:15], v9 offset:16288
  v_mfma_f32_16x16x32_bf16 v[164:167], a[0:3], a[20:23], 0
  buffer_load_dwordx4 a[52:55], v8, s[8:11], s17 offen offset:256 sc1
  v_mfma_f32_16x16x32_bf16 v[168:171], a[0:3], a[24:27], 0
  v_mfma_f32_16x16x32_bf16 v[172:175], a[0:3], a[28:31], 0
  s_waitcnt lgkmcnt(4)
  v_mfma_f32_16x16x32_bf16 v[188:191], a[4:7], a[28:31], 0
  ds_read_b64_tr_b16 a[0:1], v9 offset:192
  ds_read_b64_tr_b16 a[2:3], v9 offset:1984
  v_mfma_f32_16x16x32_bf16 v[184:187], a[4:7], a[24:27], 0
  buffer_load_dwordx4 a[56:59], v8, s[8:11], s17 offen offset:512 sc1
  v_mfma_f32_16x16x32_bf16 v[180:183], a[4:7], a[20:23], 0
  v_mfma_f32_16x16x32_bf16 v[176:179], a[4:7], a[16:19], 0
  s_waitcnt lgkmcnt(4)
  v_mfma_f32_16x16x32_bf16 v[192:195], a[8:11], a[16:19], 0
  ds_read_b64_tr_b16 a[4:5], v9 offset:14528
  ds_read_b64_tr_b16 a[6:7], v9 offset:16320
  v_mfma_f32_16x16x32_bf16 v[196:199], a[8:11], a[20:23], 0
  buffer_load_dwordx4 a[60:63], v8, s[8:11], s17 offen offset:768 sc1
  s_add_u32 s17, s17, 131072
  v_mfma_f32_16x16x32_bf16 v[200:203], a[8:11], a[24:27], 0
  v_mfma_f32_16x16x32_bf16 v[204:207], a[8:11], a[28:31], 0
  s_waitcnt lgkmcnt(4)
  v_mfma_f32_16x16x32_bf16 v[220:223], a[12:15], a[28:31], 0
  ds_read_b64_tr_b16 a[8:9], v9 offset:7168
  ds_read_b64_tr_b16 a[10:11], v9 offset:8960
  v_mfma_f32_16x16x32_bf16 v[216:219], a[12:15], a[24:27], 0
  v_mfma_f32_16x16x32_bf16 v[212:215], a[12:15], a[20:23], 0
  buffer_load_dwordx4 a[64:67], v8, s[8:11], s17 offen offset:0 sc1
  v_mfma_f32_16x16x32_bf16 v[208:211], a[12:15], a[16:19], 0
  s_waitcnt lgkmcnt(4)
  v_mfma_f32_16x16x32_bf16 v[224:227], a[0:3], a[16:19], 0
  ds_read_b64_tr_b16 a[12:13], v9 offset:21504
  ds_read_b64_tr_b16 a[14:15], v9 offset:23296
  v_mfma_f32_16x16x32_bf16 v[228:231], a[0:3], a[20:23], 0
  v_mfma_f32_16x16x32_bf16 v[232:235], a[0:3], a[24:27], 0
  buffer_load_dwordx4 a[68:71], v8, s[8:11], s17 offen offset:256 sc1
  v_mfma_f32_16x16x32_bf16 v[236:239], a[0:3], a[28:31], 0
  s_waitcnt lgkmcnt(4)
  v_mfma_f32_16x16x32_bf16 v[252:255], a[4:7], a[28:31], 0
  ds_read_b64_tr_b16 a[0:1], v9 offset:7200
  ds_read_b64_tr_b16 a[2:3], v9 offset:8992
  v_mfma_f32_16x16x32_bf16 v[248:251], a[4:7], a[24:27], 0
  v_mfma_f32_16x16x32_bf16 v[244:247], a[4:7], a[20:23], 0
  buffer_load_dwordx4 a[72:75], v8, s[8:11], s17 offen offset:512 sc1
  v_mfma_f32_16x16x32_bf16 v[240:243], a[4:7], a[16:19], 0
  s_waitcnt vmcnt(14) lgkmcnt(4)
  v_mfma_f32_16x16x32_bf16 v[32:35], a[8:11], a[32:35], v[32:35]
  ds_read_b64_tr_b16 a[4:5], v9 offset:21536
  ds_read_b64_tr_b16 a[6:7], v9 offset:23328
  v_mfma_f32_16x16x32_bf16 v[36:39], a[8:11], a[36:39], v[36:39]
  v_mfma_f32_16x16x32_bf16 v[40:43], a[8:11], a[40:43], v[40:43]
  buffer_load_dwordx4 a[76:79], v8, s[8:11], s17 offen offset:768 sc1
  s_add_u32 s17, s17, 131072
  v_mfma_f32_16x16x32_bf16 v[44:47], a[8:11], a[44:47], v[44:47]
  s_waitcnt lgkmcnt(4)
  v_mfma_f32_16x16x32_bf16 v[60:63], a[12:15], a[44:47], v[60:63]
  ds_read_b64_tr_b16 a[8:9], v9 offset:7232
  ds_read_b64_tr_b16 a[10:11], v9 offset:9024
  v_mfma_f32_16x16x32_bf16 v[56:59], a[12:15], a[40:43], v[56:59]
  v_mfma_f32_16x16x32_bf16 v[52:55], a[12:15], a[36:39], v[52:55]
  v_mfma_f32_16x16x32_bf16 v[48:51], a[12:15], a[32:35], v[48:51]
  s_waitcnt lgkmcnt(4)
  v_mfma_f32_16x16x32_bf16 v[64:67], a[0:3], a[32:35], v[64:67]
  ds_read_b64_tr_b16 a[12:13], v9 offset:21568
  ds_read_b64_tr_b16 a[14:15], v9 offset:23360
  v_mfma_f32_16x16x32_bf16 v[68:71], a[0:3], a[36:39], v[68:71]
  buffer_load_dwordx4 a[16:19], v8, s[8:11], s17 offen offset:0 sc1
  v_mfma_f32_16x16x32_bf16 v[72:75], a[0:3], a[40:43], v[72:75]
  v_mfma_f32_16x16x32_bf16 v[76:79], a[0:3], a[44:47], v[76:79]
  s_waitcnt lgkmcnt(4)
  v_mfma_f32_16x16x32_bf16 v[92:95], a[4:7], a[44:47], v[92:95]
  ds_read_b64_tr_b16 a[0:1], v9 offset:7264
  ds_read_b64_tr_b16 a[2:3], v9 offset:9056
  v_mfma_f32_16x16x32_bf16 v[88:91], a[4:7], a[40:43], v[88:91]
  buffer_load_dwordx4 a[20:23], v8, s[8:11], s17 offen offset:256 sc1
  v_mfma_f32_16x16x32_bf16 v[84:87], a[4:7], a[36:39], v[84:87]
  v_mfma_f32_16x16x32_bf16 v[80:83], a[4:7], a[32:35], v[80:83]
  s_waitcnt lgkmcnt(4)
  v_mfma_f32_16x16x32_bf16 v[96:99], a[8:11], a[32:35], v[96:99]
  ds_read_b64_tr_b16 a[4:5], v9 offset:21600
  ds_read_b64_tr_b16 a[6:7], v9 offset:23392
  v_mfma_f32_16x16x32_bf16 v[100:103], a[8:11], a[36:39], v[100:103]
  buffer_load_dwordx4 a[24:27], v8, s[8:11], s17 offen offset:512 sc1
  v_mfma_f32_16x16x32_bf16 v[104:107], a[8:11], a[40:43], v[104:107]
  v_mfma_f32_16x16x32_bf16 v[108:111], a[8:11], a[44:47], v[108:111]
  s_waitcnt lgkmcnt(4)
  v_mfma_f32_16x16x32_bf16 v[124:127], a[12:15], a[44:47], v[124:127]
  ds_read_b64_tr_b16 a[8:9], v9 offset:7296
  ds_read_b64_tr_b16 a[10:11], v9 offset:9088
  v_mfma_f32_16x16x32_bf16 v[120:123], a[12:15], a[40:43], v[120:123]
  buffer_load_dwordx4 a[28:31], v8, s[8:11], s17 offen offset:768 sc1
  s_add_u32 s17, s17, 131072
  v_mfma_f32_16x16x32_bf16 v[116:119], a[12:15], a[36:39], v[116:119]
  v_mfma_f32_16x16x32_bf16 v[112:115], a[12:15], a[32:35], v[112:115]
  s_waitcnt lgkmcnt(4)
  v_mfma_f32_16x16x32_bf16 v[128:131], a[0:3], a[32:35], v[128:131]
  ds_read_b64_tr_b16 a[12:13], v9 offset:21632
  ds_read_b64_tr_b16 a[14:15], v9 offset:23424
  v_mfma_f32_16x16x32_bf16 v[132:135], a[0:3], a[36:39], v[132:135]
  s_add_u32 m0, s18, 0
  v_mfma_f32_16x16x32_bf16 v[136:139], a[0:3], a[40:43], v[136:139]
  buffer_load_dwordx4 v1, s[4:7], s16 offen  lds
  v_mfma_f32_16x16x32_bf16 v[140:143], a[0:3], a[44:47], v[140:143]
  buffer_load_dwordx4 a[80:83], v16, s[8:11], s55 offen
  s_add_u32 s55, s55, 1048576
  s_waitcnt lgkmcnt(4)
  v_mfma_f32_16x16x32_bf16 v[156:159], a[4:7], a[44:47], v[156:159]
  ds_read_b64_tr_b16 a[0:1], v9 offset:7328
  ds_read_b64_tr_b16 a[2:3], v9 offset:9120
  v_mfma_f32_16x16x32_bf16 v[152:155], a[4:7], a[40:43], v[152:155]
  s_add_u32 m0, s18, 1024
  v_mfma_f32_16x16x32_bf16 v[148:151], a[4:7], a[36:39], v[148:151]
  buffer_load_dwordx4 v2, s[4:7], s16 offen  lds
  v_mfma_f32_16x16x32_bf16 v[144:147], a[4:7], a[32:35], v[144:147]
  s_waitcnt lgkmcnt(4)
  v_mfma_f32_16x16x32_bf16 v[160:163], a[8:11], a[32:35], v[160:163]
  ds_read_b64_tr_b16 a[4:5], v9 offset:21664
  ds_read_b64_tr_b16 a[6:7], v9 offset:23456
  v_mfma_f32_16x16x32_bf16 v[164:167], a[8:11], a[36:39], v[164:167]
  s_add_u32 m0, s18, 2048
  v_mfma_f32_16x16x32_bf16 v[168:171], a[8:11], a[40:43], v[168:171]
  buffer_load_dwordx4 v3, s[4:7], s16 offen  lds
  v_mfma_f32_16x16x32_bf16 v[172:175], a[8:11], a[44:47], v[172:175]
  buffer_load_dwordx4 a[84:87], v16, s[8:11], s55 offen
  s_add_u32 s55, s55, 1048576
  s_waitcnt lgkmcnt(4)
  v_mfma_f32_16x16x32_bf16 v[188:191], a[12:15], a[44:47], v[188:191]
  ds_read_b64_tr_b16 a[8:9], v9 offset:7360
  ds_read_b64_tr_b16 a[10:11], v9 offset:9152
  v_mfma_f32_16x16x32_bf16 v[184:187], a[12:15], a[40:43], v[184:187]
  s_add_u32 m0, s18, 3072
  v_mfma_f32_16x16x32_bf16 v[180:183], a[12:15], a[36:39], v[180:183]
  buffer_load_dwordx4 v4, s[4:7], s16 offen  lds
  v_mfma_f32_16x16x32_bf16 v[176:179], a[12:15], a[32:35], v[176:179]
  s_waitcnt lgkmcnt(4)
  v_mfma_f32_16x16x32_bf16 v[192:195], a[0:3], a[32:35], v[192:195]
  ds_read_b64_tr_b16 a[12:13], v9 offset:21696
  ds_read_b64_tr_b16 a[14:15], v9 offset:23488
  v_mfma_f32_16x16x32_bf16 v[196:199], a[0:3], a[36:39], v[196:199]
  s_add_u32 m0, s18, 4096
  v_mfma_f32_16x16x32_bf16 v[200:203], a[0:3], a[40:43], v[200:203]
  buffer_load_dwordx4 v5, s[4:7], s16 offen  lds
  v_mfma_f32_16x16x32_bf16 v[204:207], a[0:3], a[44:47], v[204:207]
  buffer_load_dwordx4 a[88:91], v16, s[8:11], s55 offen
  s_add_u32 s55, s55, 1048576
  s_waitcnt vmcnt(20)
  s_barrier
  s_waitcnt lgkmcnt(4)
  v_mfma_f32_16x16x32_bf16 v[220:223], a[4:7], a[44:47], v[220:223]
  ds_read_b64_tr_b16 a[0:1], v9 offset:28672
  ds_read_b64_tr_b16 a[2:3], v9 offset:30464
  v_mfma_f32_16x16x32_bf16 v[216:219], a[4:7], a[40:43], v[216:219]
  s_add_u32 m0, s18, 5120
  v_mfma_f32_16x16x32_bf16 v[212:215], a[4:7], a[36:39], v[212:215]
  buffer_load_dwordx4 v6, s[4:7], s16 offen  lds
  v_mfma_f32_16x16x32_bf16 v[208:211], a[4:7], a[32:35], v[208:211]
  s_waitcnt lgkmcnt(4)
  v_mfma_f32_16x16x32_bf16 v[224:227], a[8:11], a[32:35], v[224:227]
  ds_read_b64_tr_b16 a[4:5], v9 offset:43008
  ds_read_b64_tr_b16 a[6:7], v9 offset:44800
  v_mfma_f32_16x16x32_bf16 v[228:231], a[8:11], a[36:39], v[228:231]
  s_add_u32 m0, s18, 6144
  v_mfma_f32_16x16x32_bf16 v[232:235], a[8:11], a[40:43], v[232:235]
  buffer_load_dwordx4 v7, s[4:7], s16 offen  lds
  s_add_u32 s16, s16, 458752
  v_mfma_f32_16x16x32_bf16 v[236:239], a[8:11], a[44:47], v[236:239]
  buffer_load_dwordx4 a[92:95], v16, s[8:11], s55 offen
  s_add_u32 s55, s55, 1048576
  s_waitcnt lgkmcnt(4)
  v_mfma_f32_16x16x32_bf16 v[252:255], a[12:15], a[44:47], v[252:255]
  ds_read_b64_tr_b16 a[8:9], v9 offset:28704
  ds_read_b64_tr_b16 a[10:11], v9 offset:30496
  v_mfma_f32_16x16x32_bf16 v[248:251], a[12:15], a[40:43], v[248:251]
  v_mfma_f32_16x16x32_bf16 v[244:247], a[12:15], a[36:39], v[244:247]
  v_mfma_f32_16x16x32_bf16 v[240:243], a[12:15], a[32:35], v[240:243]
  s_waitcnt vmcnt(19) lgkmcnt(4)
  v_mfma_f32_16x16x32_bf16 v[32:35], a[0:3], a[48:51], v[32:35]
  ds_read_b64_tr_b16 a[12:13], v9 offset:43040
  ds_read_b64_tr_b16 a[14:15], v9 offset:44832
  v_mfma_f32_16x16x32_bf16 v[36:39], a[0:3], a[52:55], v[36:39]
  v_mfma_f32_16x16x32_bf16 v[40:43], a[0:3], a[56:59], v[40:43]
  v_mfma_f32_16x16x32_bf16 v[44:47], a[0:3], a[60:63], v[44:47]
  buffer_load_dword v28, v19, s[60:63], s59 offen
  s_add_u32 s59, s59, 28672
  s_waitcnt lgkmcnt(4)
  v_mfma_f32_16x16x32_bf16 v[60:63], a[4:7], a[60:63], v[60:63]
  ds_read_b64_tr_b16 a[0:1], v9 offset:28736
  ds_read_b64_tr_b16 a[2:3], v9 offset:30528
  v_mfma_f32_16x16x32_bf16 v[56:59], a[4:7], a[56:59], v[56:59]
  buffer_load_dwordx4 a[32:35], v8, s[8:11], s17 offen offset:0 sc1
  v_mfma_f32_16x16x32_bf16 v[52:55], a[4:7], a[52:55], v[52:55]
  v_mfma_f32_16x16x32_bf16 v[48:51], a[4:7], a[48:51], v[48:51]
  s_waitcnt lgkmcnt(4)
  v_mfma_f32_16x16x32_bf16 v[64:67], a[8:11], a[48:51], v[64:67]
  ds_read_b64_tr_b16 a[4:5], v9 offset:43072
  ds_read_b64_tr_b16 a[6:7], v9 offset:44864
  v_mfma_f32_16x16x32_bf16 v[68:71], a[8:11], a[52:55], v[68:71]
  v_mfma_f32_16x16x32_bf16 v[72:75], a[8:11], a[56:59], v[72:75]
  v_mfma_f32_16x16x32_bf16 v[76:79], a[8:11], a[60:63], v[76:79]
  buffer_load_dword v29, v19, s[60:63], s59 offen
  s_add_u32 s59, s59, 28672
  s_waitcnt lgkmcnt(4)
  v_mfma_f32_16x16x32_bf16 v[92:95], a[12:15], a[60:63], v[92:95]
  ds_read_b64_tr_b16 a[8:9], v9 offset:28768
  ds_read_b64_tr_b16 a[10:11], v9 offset:30560
  v_mfma_f32_16x16x32_bf16 v[88:91], a[12:15], a[56:59], v[88:91]
  buffer_load_dwordx4 a[36:39], v8, s[8:11], s17 offen offset:256 sc1
  v_mfma_f32_16x16x32_bf16 v[84:87], a[12:15], a[52:55], v[84:87]
  v_mfma_f32_16x16x32_bf16 v[80:83], a[12:15], a[48:51], v[80:83]
  s_waitcnt lgkmcnt(4)
  v_mfma_f32_16x16x32_bf16 v[96:99], a[0:3], a[48:51], v[96:99]
  ds_read_b64_tr_b16 a[12:13], v9 offset:43104
  ds_read_b64_tr_b16 a[14:15], v9 offset:44896
  v_mfma_f32_16x16x32_bf16 v[100:103], a[0:3], a[52:55], v[100:103]
  v_mfma_f32_16x16x32_bf16 v[104:107], a[0:3], a[56:59], v[104:107]
  v_mfma_f32_16x16x32_bf16 v[108:111], a[0:3], a[60:63], v[108:111]
  buffer_load_dword v30, v19, s[60:63], s59 offen
  s_add_u32 s59, s59, 28672
  s_waitcnt lgkmcnt(4)
  v_mfma_f32_16x16x32_bf16 v[124:127], a[4:7], a[60:63], v[124:127]
  ds_read_b64_tr_b16 a[0:1], v9 offset:28800
  ds_read_b64_tr_b16 a[2:3], v9 offset:30592
  v_mfma_f32_16x16x32_bf16 v[120:123], a[4:7], a[56:59], v[120:123]
  buffer_load_dwordx4 a[40:43], v8, s[8:11], s17 offen offset:512 sc1
  v_mfma_f32_16x16x32_bf16 v[116:119], a[4:7], a[52:55], v[116:119]
  v_mfma_f32_16x16x32_bf16 v[112:115], a[4:7], a[48:51], v[112:115]
  s_waitcnt lgkmcnt(4)
  v_mfma_f32_16x16x32_bf16 v[128:131], a[8:11], a[48:51], v[128:131]
  ds_read_b64_tr_b16 a[4:5], v9 offset:43136
  ds_read_b64_tr_b16 a[6:7], v9 offset:44928
  v_mfma_f32_16x16x32_bf16 v[132:135], a[8:11], a[52:55], v[132:135]
  s_waitcnt vmcnt(15)
  v_accvgpr_read_b32 v12, a80
  v_mfma_f32_16x16x32_bf16 v[136:139], a[8:11], a[56:59], v[136:139]
  v_dot2c_f32_bf16 v22, s23, v12
  v_mfma_f32_16x16x32_bf16 v[140:143], a[8:11], a[60:63], v[140:143]
  buffer_load_dword v31, v19, s[60:63], s59 offen
  s_add_u32 s59, s59, 28672
  v_dot2c_f32_bf16 v23, v12, v12
  v_accvgpr_read_b32 v13, a81
  s_waitcnt lgkmcnt(4)
  v_mfma_f32_16x16x32_bf16 v[156:159], a[12:15], a[60:63], v[156:159]
  ds_read_b64_tr_b16 a[8:9], v9 offset:28832
  ds_read_b64_tr_b16 a[10:11], v9 offset:30624
  v_mfma_f32_16x16x32_bf16 v[152:155], a[12:15], a[56:59], v[152:155]
  buffer_load_dwordx4 a[44:47], v8, s[8:11], s17 offen offset:768 sc1
  s_add_u32 s17, s17, 131072
  v_dot2c_f32_bf16 v22, s23, v13
  v_mfma_f32_16x16x32_bf16 v[148:151], a[12:15], a[52:55], v[148:151]
  v_dot2c_f32_bf16 v23, v13, v13
  v_mfma_f32_16x16x32_bf16 v[144:147], a[12:15], a[48:51], v[144:147]
  v_accvgpr_read_b32 v12, a82
  v_dot2c_f32_bf16 v22, s23, v12
  s_waitcnt lgkmcnt(4)
  v_mfma_f32_16x16x32_bf16 v[160:163], a[0:3], a[48:51], v[160:163]
  ds_read_b64_tr_b16 a[12:13], v9 offset:43168
  ds_read_b64_tr_b16 a[14:15], v9 offset:44960
  v_mfma_f32_16x16x32_bf16 v[164:167], a[0:3], a[52:55], v[164:167]
  s_add_u32 m0, s18, 28672
  v_dot2c_f32_bf16 v23, v12, v12
  v_mfma_f32_16x16x32_bf16 v[168:171], a[0:3], a[56:59], v[168:171]
  buffer_load_dwordx4 v1, s[4:7], s16 offen  lds
  v_accvgpr_read_b32 v13, a83
  v_mfma_f32_16x16x32_bf16 v[172:175], a[0:3], a[60:63], v[172:175]
  v_dot2c_f32_bf16 v22, s23, v13
  v_dot2c_f32_bf16 v23, v13, v13
  s_waitcnt lgkmcnt(4)
  v_mfma_f32_16x16x32_bf16 v[188:191], a[4:7], a[60:63], v[188:191]
  ds_read_b64_tr_b16 a[0:1], v9 offset:28864
  ds_read_b64_tr_b16 a[2:3], v9 offset:30656
  v_mfma_f32_16x16x32_bf16 v[184:187], a[4:7], a[56:59], v[184:187]
  s_waitcnt vmcnt(15)
  v_accvgpr_read_b32 v12, a84
  v_mfma_f32_16x16x32_bf16 v[180:183], a[4:7], a[52:55], v[180:183]
  v_dot2c_f32_bf16 v22, s23, v12
  v_mfma_f32_16x16x32_bf16 v[176:179], a[4:7], a[48:51], v[176:179]
  v_dot2c_f32_bf16 v23, v12, v12
  v_accvgpr_read_b32 v13, a85
  s_waitcnt lgkmcnt(4)
  v_mfma_f32_16x16x32_bf16 v[192:195], a[8:11], a[48:51], v[192:195]
  ds_read_b64_tr_b16 a[4:5], v9 offset:43200
  ds_read_b64_tr_b16 a[6:7], v9 offset:44992
  v_mfma_f32_16x16x32_bf16 v[196:199], a[8:11], a[52:55], v[196:199]
  s_add_u32 m0, s18, 29696
  v_dot2c_f32_bf16 v22, s23, v13
  v_mfma_f32_16x16x32_bf16 v[200:203], a[8:11], a[56:59], v[200:203]
  buffer_load_dwordx4 v2, s[4:7], s16 offen  lds
  v_dot2c_f32_bf16 v23, v13, v13
  v_mfma_f32_16x16x32_bf16 v[204:207], a[8:11], a[60:63], v[204:207]
  v_accvgpr_read_b32 v12, a86
  v_dot2c_f32_bf16 v22, s23, v12
  s_waitcnt lgkmcnt(4)
  v_mfma_f32_16x16x32_bf16 v[220:223], a[12:15], a[60:63], v[220:223]
  ds_read_b64_tr_b16 a[8:9], v9 offset:35840
  ds_read_b64_tr_b16 a[10:11], v9 offset:37632
  v_mfma_f32_16x16x32_bf16 v[216:219], a[12:15], a[56:59], v[216:219]
  v_dot2c_f32_bf16 v23, v12, v12
  v_mfma_f32_16x16x32_bf16 v[212:215], a[12:15], a[52:55], v[212:215]
  v_accvgpr_read_b32 v13, a87
  v_mfma_f32_16x16x32_bf16 v[208:211], a[12:15], a[48:51], v[208:211]
  v_dot2c_f32_bf16 v22, s23, v13
  v_dot2c_f32_bf16 v23, v13, v13
  s_waitcnt lgkmcnt(4)
  v_mfma_f32_16x16x32_bf16 v[224:227], a[0:3], a[48:51], v[224:227]
  ds_read_b64_tr_b16 a[12:13], v9 offset:50176
  ds_read_b64_tr_b16 a[14:15], v9 offset:51968
  v_mfma_f32_16x16x32_bf16 v[228:231], a[0:3], a[52:55], v[228:231]
  s_add_u32 m0, s18, 30720
  s_waitcnt vmcnt(13)
  v_accvgpr_read_b32 v12, a88
  v_mfma_f32_16x16x32_bf16 v[232:235], a[0:3], a[56:59], v[232:235]
  buffer_load_dwordx4 v3, s[4:7], s16 offen  lds
  v_dot2c_f32_bf16 v22, s23, v12
  v_mfma_f32_16x16x32_bf16 v[236:239], a[0:3], a[60:63], v[236:239]
  v_dot2c_f32_bf16 v23, v12, v12
  v_accvgpr_read_b32 v13, a89
  s_waitcnt lgkmcnt(4)
  v_mfma_f32_16x16x32_bf16 v[252:255], a[4:7], a[60:63], v[252:255]
  ds_read_b64_tr_b16 a[0:1], v9 offset:35872
  ds_read_b64_tr_b16 a[2:3], v9 offset:37664
  v_mfma_f32_16x16x32_bf16 v[248:251], a[4:7], a[56:59], v[248:251]
  v_dot2c_f32_bf16 v22, s23, v13
  v_mfma_f32_16x16x32_bf16 v[244:247], a[4:7], a[52:55], v[244:247]
  v_dot2c_f32_bf16 v23, v13, v13
  v_mfma_f32_16x16x32_bf16 v[240:243], a[4:7], a[48:51], v[240:243]
  v_accvgpr_read_b32 v12, a90
  v_dot2c_f32_bf16 v22, s23, v12
  s_waitcnt lgkmcnt(4)
  v_mfma_f32_16x16x32_bf16 v[32:35], a[8:11], a[64:67], v[32:35]
  ds_read_b64_tr_b16 a[4:5], v9 offset:50208
  ds_read_b64_tr_b16 a[6:7], v9 offset:52000
  v_mfma_f32_16x16x32_bf16 v[36:39], a[8:11], a[68:71], v[36:39]
  s_add_u32 m0, s18, 31744
  v_dot2c_f32_bf16 v23, v12, v12
  v_mfma_f32_16x16x32_bf16 v[40:43], a[8:11], a[72:75], v[40:43]
  buffer_load_dwordx4 v4, s[4:7], s16 offen  lds
  v_accvgpr_read_b32 v13, a91
  v_mfma_f32_16x16x32_bf16 v[44:47], a[8:11], a[76:79], v[44:47]
  v_dot2c_f32_bf16 v22, s23, v13
  v_dot2c_f32_bf16 v23, v13, v13
  s_waitcnt lgkmcnt(4)
  v_mfma_f32_16x16x32_bf16 v[60:63], a[12:15], a[76:79], v[60:63]
  ds_read_b64_tr_b16 a[8:9], v9 offset:35904
  ds_read_b64_tr_b16 a[10:11], v9 offset:37696
  v_mfma_f32_16x16x32_bf16 v[56:59], a[12:15], a[72:75], v[56:59]
  buffer_load_dwordx4 a[48:51], v8, s[8:11], s17 offen offset:0 sc1
  s_waitcnt vmcnt(13)
  v_accvgpr_read_b32 v12, a92
  v_mfma_f32_16x16x32_bf16 v[52:55], a[12:15], a[68:71], v[52:55]
  v_dot2c_f32_bf16 v22, s23, v12
  v_mfma_f32_16x16x32_bf16 v[48:51], a[12:15], a[64:67], v[48:51]
  v_dot2c_f32_bf16 v23, v12, v12
  v_accvgpr_read_b32 v13, a93
  s_waitcnt lgkmcnt(4)
  v_mfma_f32_16x16x32_bf16 v[64:67], a[0:3], a[64:67], v[64:67]
  ds_read_b64_tr_b16 a[12:13], v9 offset:50240
  ds_read_b64_tr_b16 a[14:15], v9 offset:52032
  v_mfma_f32_16x16x32_bf16 v[68:71], a[0:3], a[68:71], v[68:71]
  v_dot2c_f32_bf16 v22, s23, v13
  v_mfma_f32_16x16x32_bf16 v[72:75], a[0:3], a[72:75], v[72:75]
  buffer_load_dword a96, v11, s[68:71], s72 offen
  s_add_u32 s72, s72, 1048576
  v_dot2c_f32_bf16 v23, v13, v13
  v_mfma_f32_16x16x32_bf16 v[76:79], a[0:3], a[76:79], v[76:79]
  v_accvgpr_read_b32 v12, a94
  v_dot2c_f32_bf16 v22, s23, v12
  s_waitcnt lgkmcnt(4)
  v_mfma_f32_16x16x32_bf16 v[92:95], a[4:7], a[76:79], v[92:95]
  ds_read_b64_tr_b16 a[0:1], v9 offset:35936
  ds_read_b64_tr_b16 a[2:3], v9 offset:37728
  v_mfma_f32_16x16x32_bf16 v[88:91], a[4:7], a[72:75], v[88:91]
  buffer_load_dwordx4 a[52:55], v8, s[8:11], s17 offen offset:256 sc1
  v_dot2c_f32_bf16 v23, v12, v12
  v_mfma_f32_16x16x32_bf16 v[84:87], a[4:7], a[68:71], v[84:87]
  v_accvgpr_read_b32 v13, a95
  v_mfma_f32_16x16x32_bf16 v[80:83], a[4:7], a[64:67], v[80:83]
  v_dot2c_f32_bf16 v22, s23, v13
  v_dot2c_f32_bf16 v23, v13, v13
  s_waitcnt lgkmcnt(4)
  v_mfma_f32_16x16x32_bf16 v[96:99], a[8:11], a[64:67], v[96:99]
  ds_read_b64_tr_b16 a[4:5], v9 offset:50272
  ds_read_b64_tr_b16 a[6:7], v9 offset:52064
  v_mfma_f32_16x16x32_bf16 v[100:103], a[8:11], a[68:71], v[100:103]
  s_waitcnt vmcnt(8)
  v_add_f32 v28, v28, v29
  v_mfma_f32_16x16x32_bf16 v[104:107], a[8:11], a[72:75], v[104:107]
  v_add_f32 v30, v30, v31
  v_mfma_f32_16x16x32_bf16 v[108:111], a[8:11], a[76:79], v[108:111]
  v_add_f32 v28, v28, v30
  ds_write_b32 v18, v28
  s_waitcnt lgkmcnt(5)
  v_mfma_f32_16x16x32_bf16 v[124:127], a[12:15], a[76:79], v[124:127]
  ds_read_b64_tr_b16 a[8:9], v9 offset:35968
  ds_read_b64_tr_b16 a[10:11], v9 offset:37760
  v_mfma_f32_16x16x32_bf16 v[120:123], a[12:15], a[72:75], v[120:123]
  buffer_load_dwordx4 a[56:59], v8, s[8:11], s17 offen offset:512 sc1
  v_add_f32_dpp v22, v22, v22 row_ror:8 row_mask:0xf bank_mask:0xf
  v_mfma_f32_16x16x32_bf16 v[116:119], a[12:15], a[68:71], v[116:119]
  v_add_f32_dpp v23, v23, v23 row_ror:8 row_mask:0xf bank_mask:0xf
  v_mfma_f32_16x16x32_bf16 v[112:115], a[12:15], a[64:67], v[112:115]
  v_mov_b32 v24, v22
  v_mov_b32 v25, v23
  s_waitcnt lgkmcnt(5)
  v_mfma_f32_16x16x32_bf16 v[128:131], a[0:3], a[64:67], v[128:131]
  ds_read_b64_tr_b16 a[12:13], v9 offset:50304
  ds_read_b64_tr_b16 a[14:15], v9 offset:52096
  v_mfma_f32_16x16x32_bf16 v[132:135], a[0:3], a[68:71], v[132:135]
  s_nop 0
  v_mfma_f32_16x16x32_bf16 v[136:139], a[0:3], a[72:75], v[136:139]
  v_permlane16_swap_b32 v24, v22
  v_mfma_f32_16x16x32_bf16 v[140:143], a[0:3], a[76:79], v[140:143]
  v_permlane16_swap_b32 v25, v23
  v_add_f32 v22, v22, v24
  s_waitcnt lgkmcnt(5)
  v_mfma_f32_16x16x32_bf16 v[156:159], a[4:7], a[76:79], v[156:159]
  ds_read_b64_tr_b16 a[0:1], v9 offset:36000
  ds_read_b64_tr_b16 a[2:3], v9 offset:37792
  v_mfma_f32_16x16x32_bf16 v[152:155], a[4:7], a[72:75], v[152:155]
  buffer_load_dwordx4 a[60:63], v8, s[8:11], s17 offen offset:768 sc1
  s_add_u32 s17, s17, 131072
  v_add_f32 v23, v23, v25
  v_mfma_f32_16x16x32_bf16 v[148:151], a[4:7], a[68:71], v[148:151]
  v_mov_b32 v24, v22
  v_mfma_f32_16x16x32_bf16 v[144:147], a[4:7], a[64:67], v[144:147]
  v_mov_b32 v25, v23
  s_nop 0
  s_waitcnt lgkmcnt(4)
  v_mfma_f32_16x16x32_bf16 v[160:163], a[8:11], a[64:67], v[160:163]
  ds_read_b64_tr_b16 a[4:5], v9 offset:50336
  ds_read_b64_tr_b16 a[6:7], v9 offset:52128
  v_mfma_f32_16x16x32_bf16 v[164:167], a[8:11], a[68:71], v[164:167]
  s_add_u32 m0, s18, 32768
  v_permlane32_swap_b32 v24, v22
  v_mfma_f32_16x16x32_bf16 v[168:171], a[8:11], a[72:75], v[168:171]
  buffer_load_dwordx4 v5, s[4:7], s16 offen  lds
  v_permlane32_swap_b32 v25, v23
  v_mfma_f32_16x16x32_bf16 v[172:175], a[8:11], a[76:79], v[172:175]
  v_add_f32 v22, v22, v24
  v_add_f32 v23, v23, v25
  s_waitcnt lgkmcnt(4)
  v_mfma_f32_16x16x32_bf16 v[188:191], a[12:15], a[76:79], v[188:191]
  ds_read_b64_tr_b16 a[8:9], v9 offset:36032
  ds_read_b64_tr_b16 a[10:11], v9 offset:37824
  v_mfma_f32_16x16x32_bf16 v[184:187], a[12:15], a[72:75], v[184:187]
  ds_write_b64 v20, v[22:23]
  v_mfma_f32_16x16x32_bf16 v[180:183], a[12:15], a[68:71], v[180:183]
  v_mfma_f32_16x16x32_bf16 v[176:179], a[12:15], a[64:67], v[176:179]
  s_waitcnt lgkmcnt(5)
  v_mfma_f32_16x16x32_bf16 v[192:195], a[0:3], a[64:67], v[192:195]
  ds_read_b64_tr_b16 a[12:13], v9 offset:50368
  ds_read_b64_tr_b16 a[14:15], v9 offset:52160
  v_mfma_f32_16x16x32_bf16 v[196:199], a[0:3], a[68:71], v[196:199]
  s_add_u32 m0, s18, 33792
  v_mfma_f32_16x16x32_bf16 v[200:203], a[0:3], a[72:75], v[200:203]
  buffer_load_dwordx4 v6, s[4:7], s16 offen  lds
  v_mfma_f32_16x16x32_bf16 v[204:207], a[0:3], a[76:79], v[204:207]
  s_waitcnt lgkmcnt(2)
  s_barrier
  v_add_u32 v9, s21, v9
  s_sub_u32 s21, 0, s21
  v_mfma_f32_16x16x32_bf16 v[220:223], a[4:7], a[76:79], v[220:223]
  ds_read_b64_tr_b16 a[0:1], v9 offset:0
  ds_read_b64_tr_b16 a[2:3], v9 offset:1792
  v_mfma_f32_16x16x32_bf16 v[216:219], a[4:7], a[72:75], v[216:219]
  v_mfma_f32_16x16x32_bf16 v[212:215], a[4:7], a[68:71], v[212:215]
  v_mfma_f32_16x16x32_bf16 v[208:211], a[4:7], a[64:67], v[208:211]
  v_mfma_f32_16x16x32_bf16 v[224:227], a[8:11], a[64:67], v[224:227]
  ds_read_b64_tr_b16 a[4:5], v9 offset:14336
  ds_read_b64_tr_b16 a[6:7], v9 offset:16128
  v_mfma_f32_16x16x32_bf16 v[228:231], a[8:11], a[68:71], v[228:231]
  s_add_u32 m0, s18, 34816
  v_mfma_f32_16x16x32_bf16 v[232:235], a[8:11], a[72:75], v[232:235]
  buffer_load_dwordx4 v7, s[4:7], s16 offen  lds
  s_add_u32 s16, s16, 458752
  s_add_u32 s18, s18, s22
  s_sub_u32 s22, 0, s22
  v_mfma_f32_16x16x32_bf16 v[236:239], a[8:11], a[76:79], v[236:239]
  s_waitcnt lgkmcnt(4)
  v_mfma_f32_16x16x32_bf16 v[252:255], a[12:15], a[76:79], v[252:255]
  ds_read_b64_tr_b16 a[8:9], v9 offset:32
  ds_read_b64_tr_b16 a[10:11], v9 offset:1824
  v_mfma_f32_16x16x32_bf16 v[248:251], a[12:15], a[72:75], v[248:251]
  v_mfma_f32_16x16x32_bf16 v[244:247], a[12:15], a[68:71], v[244:247]
  v_mfma_f32_16x16x32_bf16 v[240:243], a[12:15], a[64:67], v[240:243]
  .p2align 6
L_b_kernel_loop:
  s_cmp_eq_u32 s19, 1
  s_cbranch_scc1 L_b_kernel_fin
L_b_kernel_finret:
  s_waitcnt lgkmcnt(4)
  v_mfma_f32_16x16x32_bf16 v[32:35], a[0:3], a[16:19], v[32:35]
  ds_read_b64_tr_b16 a[12:13], v9 offset:14368
  ds_read_b64_tr_b16 a[14:15], v9 offset:16160
  v_mfma_f32_16x16x32_bf16 v[36:39], a[0:3], a[20:23], v[36:39]
  v_mfma_f32_16x16x32_bf16 v[40:43], a[0:3], a[24:27], v[40:43]
  v_mfma_f32_16x16x32_bf16 v[44:47], a[0:3], a[28:31], v[44:47]
  s_waitcnt lgkmcnt(4)
  v_mfma_f32_16x16x32_bf16 v[60:63], a[4:7], a[28:31], v[60:63]
  ds_read_b64_tr_b16 a[0:1], v9 offset:64
  ds_read_b64_tr_b16 a[2:3], v9 offset:1856
  v_mfma_f32_16x16x32_bf16 v[56:59], a[4:7], a[24:27], v[56:59]
  buffer_load_dwordx4 a[64:67], v8, s[8:11], s17 offen offset:0 sc1
  v_mfma_f32_16x16x32_bf16 v[52:55], a[4:7], a[20:23], v[52:55]
  v_mfma_f32_16x16x32_bf16 v[48:51], a[4:7], a[16:19], v[48:51]
  s_waitcnt lgkmcnt(4)
  v_mfma_f32_16x16x32_bf16 v[64:67], a[8:11], a[16:19], v[64:67]
  ds_read_b64_tr_b16 a[4:5], v9 offset:14400
  ds_read_b64_tr_b16 a[6:7], v9 offset:16192
  v_mfma_f32_16x16x32_bf16 v[68:71], a[8:11], a[20:23], v[68:71]
  v_mfma_f32_16x16x32_bf16 v[72:75], a[8:11], a[24:27], v[72:75]
  v_mfma_f32_16x16x32_bf16 v[76:79], a[8:11], a[28:31], v[76:79]
  s_waitcnt lgkmcnt(4)
  v_mfma_f32_16x16x32_bf16 v[92:95], a[12:15], a[28:31], v[92:95]
  ds_read_b64_tr_b16 a[8:9], v9 offset:96
  ds_read_b64_tr_b16 a[10:11], v9 offset:1888
  v_mfma_f32_16x16x32_bf16 v[88:91], a[12:15], a[24:27], v[88:91]
  buffer_load_dwordx4 a[68:71], v8, s[8:11], s17 offen offset:256 sc1
  v_mfma_f32_16x16x32_bf16 v[84:87], a[12:15], a[20:23], v[84:87]
  v_mfma_f32_16x16x32_bf16 v[80:83], a[12:15], a[16:19], v[80:83]
  s_waitcnt lgkmcnt(4)
  v_mfma_f32_16x16x32_bf16 v[96:99], a[0:3], a[16:19], v[96:99]
  ds_read_b64_tr_b16 a[12:13], v9 offset:14432
  ds_read_b64_tr_b16 a[14:15], v9 offset:16224
  v_mfma_f32_16x16x32_bf16 v[100:103], a[0:3], a[20:23], v[100:103]
  v_mfma_f32_16x16x32_bf16 v[104:107], a[0:3], a[24:27], v[104:107]
  v_mfma_f32_16x16x32_bf16 v[108:111], a[0:3], a[28:31], v[108:111]
  s_waitcnt lgkmcnt(4)
  v_mfma_f32_16x16x32_bf16 v[124:127], a[4:7], a[28:31], v[124:127]
  ds_read_b64_tr_b16 a[0:1], v9 offset:128
  ds_read_b64_tr_b16 a[2:3], v9 offset:1920
  v_mfma_f32_16x16x32_bf16 v[120:123], a[4:7], a[24:27], v[120:123]
  buffer_load_dwordx4 a[72:75], v8, s[8:11], s17 offen offset:512 sc1
  v_mfma_f32_16x16x32_bf16 v[116:119], a[4:7], a[20:23], v[116:119]
  v_mfma_f32_16x16x32_bf16 v[112:115], a[4:7], a[16:19], v[112:115]
  s_waitcnt lgkmcnt(4)
  v_mfma_f32_16x16x32_bf16 v[128:131], a[8:11], a[16:19], v[128:131]
  ds_read_b64_tr_b16 a[4:5], v9 offset:14464
  ds_read_b64_tr_b16 a[6:7], v9 offset:16256
  v_mfma_f32_16x16x32_bf16 v[132:135], a[8:11], a[20:23], v[132:135]
  v_mfma_f32_16x16x32_bf16 v[136:139], a[8:11], a[24:27], v[136:139]
  v_mfma_f32_16x16x32_bf16 v[140:143], a[8:11], a[28:31], v[140:143]
  s_waitcnt lgkmcnt(4)
  v_mfma_f32_16x16x32_bf16 v[156:159], a[12:15], a[28:31], v[156:159]
  ds_read_b64_tr_b16 a[8:9], v9 offset:160
  ds_read_b64_tr_b16 a[10:11], v9 offset:1952
  v_mfma_f32_16x16x32_bf16 v[152:155], a[12:15], a[24:27], v[152:155]
  buffer_load_dwordx4 a[76:79], v8, s[8:11], s17 offen offset:768 sc1
  s_add_u32 s17, s17, 131072
  v_mfma_f32_16x16x32_bf16 v[148:151], a[12:15], a[20:23], v[148:151]
  v_mfma_f32_16x16x32_bf16 v[144:147], a[12:15], a[16:19], v[144:147]
  s_waitcnt lgkmcnt(4)
  v_mfma_f32_16x16x32_bf16 v[160:163], a[0:3], a[16:19], v[160:163]
  ds_read_b64_tr_b16 a[12:13], v9 offset:14496
  ds_read_b64_tr_b16 a[14:15], v9 offset:16288
  v_mfma_f32_16x16x32_bf16 v[164:167], a[0:3], a[20:23], v[164:167]
  s_add_u32 m0, s18, 0
  v_mfma_f32_16x16x32_bf16 v[168:171], a[0:3], a[24:27], v[168:171]
  buffer_load_dwordx4 v1, s[4:7], s16 offen  lds
  v_mfma_f32_16x16x32_bf16 v[172:175], a[0:3], a[28:31], v[172:175]
  s_waitcnt lgkmcnt(4)
  v_mfma_f32_16x16x32_bf16 v[188:191], a[4:7], a[28:31], v[188:191]
  ds_read_b64_tr_b16 a[0:1], v9 offset:192
  ds_read_b64_tr_b16 a[2:3], v9 offset:1984
  v_mfma_f32_16x16x32_bf16 v[184:187], a[4:7], a[24:27], v[184:187]
  v_mfma_f32_16x16x32_bf16 v[180:183], a[4:7], a[20:23], v[180:183]
  v_mfma_f32_16x16x32_bf16 v[176:179], a[4:7], a[16:19], v[176:179]
  s_waitcnt lgkmcnt(4)
  v_mfma_f32_16x16x32_bf16 v[192:195], a[8:11], a[16:19], v[192:195]
  ds_read_b64_tr_b16 a[4:5], v9 offset:14528
  ds_read_b64_tr_b16 a[6:7], v9 offset:16320
  v_mfma_f32_16x16x32_bf16 v[196:199], a[8:11], a[20:23], v[196:199]
  s_add_u32 m0, s18, 1024
  v_mfma_f32_16x16x32_bf16 v[200:203], a[8:11], a[24:27], v[200:203]
  buffer_load_dwordx4 v2, s[4:7], s16 offen  lds
  v_mfma_f32_16x16x32_bf16 v[204:207], a[8:11], a[28:31], v[204:207]
  s_waitcnt lgkmcnt(4)
  v_mfma_f32_16x16x32_bf16 v[220:223], a[12:15], a[28:31], v[220:223]
  ds_read_b64_tr_b16 a[8:9], v9 offset:7168
  ds_read_b64_tr_b16 a[10:11], v9 offset:8960
  v_mfma_f32_16x16x32_bf16 v[216:219], a[12:15], a[24:27], v[216:219]
  v_mfma_f32_16x16x32_bf16 v[212:215], a[12:15], a[20:23], v[212:215]
  v_mfma_f32_16x16x32_bf16 v[208:211], a[12:15], a[16:19], v[208:211]
  s_waitcnt lgkmcnt(4)
  v_mfma_f32_16x16x32_bf16 v[224:227], a[0:3], a[16:19], v[224:227]
  ds_read_b64_tr_b16 a[12:13], v9 offset:21504
  ds_read_b64_tr_b16 a[14:15], v9 offset:23296
  v_mfma_f32_16x16x32_bf16 v[228:231], a[0:3], a[20:23], v[228:231]
  s_add_u32 m0, s18, 2048
  v_mfma_f32_16x16x32_bf16 v[232:235], a[0:3], a[24:27], v[232:235]
  buffer_load_dwordx4 v3, s[4:7], s16 offen  lds
  v_mfma_f32_16x16x32_bf16 v[236:239], a[0:3], a[28:31], v[236:239]
  s_waitcnt lgkmcnt(4)
  v_mfma_f32_16x16x32_bf16 v[252:255], a[4:7], a[28:31], v[252:255]
  ds_read_b64_tr_b16 a[0:1], v9 offset:7200
  ds_read_b64_tr_b16 a[2:3], v9 offset:8992
  v_mfma_f32_16x16x32_bf16 v[248:251], a[4:7], a[24:27], v[248:251]
  v_mfma_f32_16x16x32_bf16 v[244:247], a[4:7], a[20:23], v[244:247]
  v_mfma_f32_16x16x32_bf16 v[240:243], a[4:7], a[16:19], v[240:243]
  s_waitcnt vmcnt(18) lgkmcnt(4)
  v_mfma_f32_16x16x32_bf16 v[32:35], a[8:11], a[32:35], v[32:35]
  ds_read_b64_tr_b16 a[4:5], v9 offset:21536
  ds_read_b64_tr_b16 a[6:7], v9 offset:23328
  v_mfma_f32_16x16x32_bf16 v[36:39], a[8:11], a[36:39], v[36:39]
  s_add_u32 m0, s18, 3072
  v_mfma_f32_16x16x32_bf16 v[40:43], a[8:11], a[40:43], v[40:43]
  buffer_load_dwordx4 v4, s[4:7], s16 offen  lds
  v_mfma_f32_16x16x32_bf16 v[44:47], a[8:11], a[44:47], v[44:47]
  s_waitcnt lgkmcnt(4)
  v_mfma_f32_16x16x32_bf16 v[60:63], a[12:15], a[44:47], v[60:63]
  ds_read_b64_tr_b16 a[8:9], v9 offset:7232
  ds_read_b64_tr_b16 a[10:11], v9 offset:9024
  v_mfma_f32_16x16x32_bf16 v[56:59], a[12:15], a[40:43], v[56:59]
  buffer_load_dwordx4 a[16:19], v8, s[8:11], s17 offen offset:0 sc1
  v_mfma_f32_16x16x32_bf16 v[52:55], a[12:15], a[36:39], v[52:55]
  v_mfma_f32_16x16x32_bf16 v[48:51], a[12:15], a[32:35], v[48:51]
  s_waitcnt lgkmcnt(4)
  v_mfma_f32_16x16x32_bf16 v[64:67], a[0:3], a[32:35], v[64:67]
  ds_read_b64_tr_b16 a[12:13], v9 offset:21568
  ds_read_b64_tr_b16 a[14:15], v9 offset:23360
  v_mfma_f32_16x16x32_bf16 v[68:71], a[0:3], a[36:39], v[68:71]
  v_mfma_f32_16x16x32_bf16 v[72:75], a[0:3], a[40:43], v[72:75]
  buffer_load_dword a96, v11, s[68:71], s72 offen
  s_add_u32 s72, s72, 1048576
  v_mfma_f32_16x16x32_bf16 v[76:79], a[0:3], a[44:47], v[76:79]
  s_waitcnt lgkmcnt(4)
  v_mfma_f32_16x16x32_bf16 v[92:95], a[4:7], a[44:47], v[92:95]
  ds_read_b64_tr_b16 a[0:1], v9 offset:7264
  ds_read_b64_tr_b16 a[2:3], v9 offset:9056
  v_mfma_f32_16x16x32_bf16 v[88:91], a[4:7], a[40:43], v[88:91]
  buffer_load_dwordx4 a[20:23], v8, s[8:11], s17 offen offset:256 sc1
  v_mfma_f32_16x16x32_bf16 v[84:87], a[4:7], a[36:39], v[84:87]
  v_mfma_f32_16x16x32_bf16 v[80:83], a[4:7], a[32:35], v[80:83]
  s_waitcnt lgkmcnt(4)
  v_mfma_f32_16x16x32_bf16 v[96:99], a[8:11], a[32:35], v[96:99]
  ds_read_b64_tr_b16 a[4:5], v9 offset:21600
  ds_read_b64_tr_b16 a[6:7], v9 offset:23392
  v_mfma_f32_16x16x32_bf16 v[100:103], a[8:11], a[36:39], v[100:103]
  v_mfma_f32_16x16x32_bf16 v[104:107], a[8:11], a[40:43], v[104:107]
  v_mfma_f32_16x16x32_bf16 v[108:111], a[8:11], a[44:47], v[108:111]
  s_waitcnt lgkmcnt(4)
  v_mfma_f32_16x16x32_bf16 v[124:127], a[12:15], a[44:47], v[124:127]
  ds_read_b64_tr_b16 a[8:9], v9 offset:7296
  ds_read_b64_tr_b16 a[10:11], v9 offset:9088
  v_mfma_f32_16x16x32_bf16 v[120:123], a[12:15], a[40:43], v[120:123]
  buffer_load_dwordx4 a[24:27], v8, s[8:11], s17 offen offset:512 sc1
  v_mfma_f32_16x16x32_bf16 v[116:119], a[12:15], a[36:39], v[116:119]
  v_mfma_f32_16x16x32_bf16 v[112:115], a[12:15], a[32:35], v[112:115]
  s_waitcnt lgkmcnt(4)
  v_mfma_f32_16x16x32_bf16 v[128:131], a[0:3], a[32:35], v[128:131]
  ds_read_b64_tr_b16 a[12:13], v9 offset:21632
  ds_read_b64_tr_b16 a[14:15], v9 offset:23424
  v_mfma_f32_16x16x32_bf16 v[132:135], a[0:3], a[36:39], v[132:135]
  v_mfma_f32_16x16x32_bf16 v[136:139], a[0:3], a[40:43], v[136:139]
  v_mfma_f32_16x16x32_bf16 v[140:143], a[0:3], a[44:47], v[140:143]
  s_waitcnt lgkmcnt(4)
  v_mfma_f32_16x16x32_bf16 v[156:159], a[4:7], a[44:47], v[156:159]
  ds_read_b64_tr_b16 a[0:1], v9 offset:7328
  ds_read_b64_tr_b16 a[2:3], v9 offset:9120
  v_mfma_f32_16x16x32_bf16 v[152:155], a[4:7], a[40:43], v[152:155]
  buffer_load_dwordx4 a[28:31], v8, s[8:11], s17 offen offset:768 sc1
  s_add_u32 s17, s17, 131072
  v_mfma_f32_16x16x32_bf16 v[148:151], a[4:7], a[36:39], v[148:151]
  v_mfma_f32_16x16x32_bf16 v[144:147], a[4:7], a[32:35], v[144:147]
  s_waitcnt lgkmcnt(4)
  v_mfma_f32_16x16x32_bf16 v[160:163], a[8:11], a[32:35], v[160:163]
  ds_read_b64_tr_b16 a[4:5], v9 offset:21664
  ds_read_b64_tr_b16 a[6:7], v9 offset:23456
  v_mfma_f32_16x16x32_bf16 v[164:167], a[8:11], a[36:39], v[164:167]
  s_add_u32 m0, s18, 4096
  v_mfma_f32_16x16x32_bf16 v[168:171], a[8:11], a[40:43], v[168:171]
  buffer_load_dwordx4 v5, s[4:7], s16 offen  lds
  v_mfma_f32_16x16x32_bf16 v[172:175], a[8:11], a[44:47], v[172:175]
  s_waitcnt lgkmcnt(4)
  v_mfma_f32_16x16x32_bf16 v[188:191], a[12:15], a[44:47], v[188:191]
  ds_read_b64_tr_b16 a[8:9], v9 offset:7360
  ds_read_b64_tr_b16 a[10:11], v9 offset:9152
  v_mfma_f32_16x16x32_bf16 v[184:187], a[12:15], a[40:43], v[184:187]
  v_mfma_f32_16x16x32_bf16 v[180:183], a[12:15], a[36:39], v[180:183]
  v_mfma_f32_16x16x32_bf16 v[176:179], a[12:15], a[32:35], v[176:179]
  s_waitcnt lgkmcnt(4)
  v_mfma_f32_16x16x32_bf16 v[192:195], a[0:3], a[32:35], v[192:195]
  ds_read_b64_tr_b16 a[12:13], v9 offset:21696
  ds_read_b64_tr_b16 a[14:15], v9 offset:23488
  v_mfma_f32_16x16x32_bf16 v[196:199], a[0:3], a[36:39], v[196:199]
  s_add_u32 m0, s18, 5120
  v_mfma_f32_16x16x32_bf16 v[200:203], a[0:3], a[40:43], v[200:203]
  buffer_load_dwordx4 v6, s[4:7], s16 offen  lds
  v_mfma_f32_16x16x32_bf16 v[204:207], a[0:3], a[44:47], v[204:207]
  s_waitcnt vmcnt(15)
  s_barrier
  s_waitcnt lgkmcnt(4)
  v_mfma_f32_16x16x32_bf16 v[220:223], a[4:7], a[44:47], v[220:223]
  ds_read_b64_tr_b16 a[0:1], v9 offset:28672
  ds_read_b64_tr_b16 a[2:3], v9 offset:30464
  v_mfma_f32_16x16x32_bf16 v[216:219], a[4:7], a[40:43], v[216:219]
  v_mfma_f32_16x16x32_bf16 v[212:215], a[4:7], a[36:39], v[212:215]
  v_mfma_f32_16x16x32_bf16 v[208:211], a[4:7], a[32:35], v[208:211]
  s_waitcnt lgkmcnt(4)
  v_mfma_f32_16x16x32_bf16 v[224:227], a[8:11], a[32:35], v[224:227]
  ds_read_b64_tr_b16 a[4:5], v9 offset:43008
  ds_read_b64_tr_b16 a[6:7], v9 offset:44800
  v_mfma_f32_16x16x32_bf16 v[228:231], a[8:11], a[36:39], v[228:231]
  s_add_u32 m0, s18, 6144
  v_mfma_f32_16x16x32_bf16 v[232:235], a[8:11], a[40:43], v[232:235]
  buffer_load_dwordx4 v7, s[4:7], s16 offen  lds
  s_add_u32 s16, s16, 458752
  v_mfma_f32_16x16x32_bf16 v[236:239], a[8:11], a[44:47], v[236:239]
  s_waitcnt lgkmcnt(4)
  v_mfma_f32_16x16x32_bf16 v[252:255], a[12:15], a[44:47], v[252:255]
  ds_read_b64_tr_b16 a[8:9], v9 offset:28704
  ds_read_b64_tr_b16 a[10:11], v9 offset:30496
  v_mfma_f32_16x16x32_bf16 v[248:251], a[12:15], a[40:43], v[248:251]
  v_mfma_f32_16x16x32_bf16 v[244:247], a[12:15], a[36:39], v[244:247]
  v_mfma_f32_16x16x32_bf16 v[240:243], a[12:15], a[32:35], v[240:243]
  s_waitcnt lgkmcnt(4)
  v_mfma_f32_16x16x32_bf16 v[32:35], a[0:3], a[48:51], v[32:35]
  ds_read_b64_tr_b16 a[12:13], v9 offset:43040
  ds_read_b64_tr_b16 a[14:15], v9 offset:44832
  v_mfma_f32_16x16x32_bf16 v[36:39], a[0:3], a[52:55], v[36:39]
  v_mfma_f32_16x16x32_bf16 v[40:43], a[0:3], a[56:59], v[40:43]
  v_mfma_f32_16x16x32_bf16 v[44:47], a[0:3], a[60:63], v[44:47]
  s_waitcnt lgkmcnt(4)
  v_mfma_f32_16x16x32_bf16 v[60:63], a[4:7], a[60:63], v[60:63]
  ds_read_b64_tr_b16 a[0:1], v9 offset:28736
  ds_read_b64_tr_b16 a[2:3], v9 offset:30528
  v_mfma_f32_16x16x32_bf16 v[56:59], a[4:7], a[56:59], v[56:59]
  buffer_load_dwordx4 a[32:35], v8, s[8:11], s17 offen offset:0 sc1
  v_mfma_f32_16x16x32_bf16 v[52:55], a[4:7], a[52:55], v[52:55]
  v_mfma_f32_16x16x32_bf16 v[48:51], a[4:7], a[48:51], v[48:51]
  s_waitcnt lgkmcnt(4)
  v_mfma_f32_16x16x32_bf16 v[64:67], a[8:11], a[48:51], v[64:67]
  ds_read_b64_tr_b16 a[4:5], v9 offset:43072
  ds_read_b64_tr_b16 a[6:7], v9 offset:44864
  v_mfma_f32_16x16x32_bf16 v[68:71], a[8:11], a[52:55], v[68:71]
  v_mfma_f32_16x16x32_bf16 v[72:75], a[8:11], a[56:59], v[72:75]
  v_mfma_f32_16x16x32_bf16 v[76:79], a[8:11], a[60:63], v[76:79]
  s_waitcnt lgkmcnt(4)
  v_mfma_f32_16x16x32_bf16 v[92:95], a[12:15], a[60:63], v[92:95]
  ds_read_b64_tr_b16 a[8:9], v9 offset:28768
  ds_read_b64_tr_b16 a[10:11], v9 offset:30560
  v_mfma_f32_16x16x32_bf16 v[88:91], a[12:15], a[56:59], v[88:91]
  buffer_load_dwordx4 a[36:39], v8, s[8:11], s17 offen offset:256 sc1
  v_mfma_f32_16x16x32_bf16 v[84:87], a[12:15], a[52:55], v[84:87]
  v_mfma_f32_16x16x32_bf16 v[80:83], a[12:15], a[48:51], v[80:83]
  s_waitcnt lgkmcnt(4)
  v_mfma_f32_16x16x32_bf16 v[96:99], a[0:3], a[48:51], v[96:99]
  ds_read_b64_tr_b16 a[12:13], v9 offset:43104
  ds_read_b64_tr_b16 a[14:15], v9 offset:44896
  v_mfma_f32_16x16x32_bf16 v[100:103], a[0:3], a[52:55], v[100:103]
  v_mfma_f32_16x16x32_bf16 v[104:107], a[0:3], a[56:59], v[104:107]
  v_mfma_f32_16x16x32_bf16 v[108:111], a[0:3], a[60:63], v[108:111]
  s_waitcnt lgkmcnt(4)
  v_mfma_f32_16x16x32_bf16 v[124:127], a[4:7], a[60:63], v[124:127]
  ds_read_b64_tr_b16 a[0:1], v9 offset:28800
  ds_read_b64_tr_b16 a[2:3], v9 offset:30592
  v_mfma_f32_16x16x32_bf16 v[120:123], a[4:7], a[56:59], v[120:123]
  buffer_load_dwordx4 a[40:43], v8, s[8:11], s17 offen offset:512 sc1
  v_mfma_f32_16x16x32_bf16 v[116:119], a[4:7], a[52:55], v[116:119]
  v_mfma_f32_16x16x32_bf16 v[112:115], a[4:7], a[48:51], v[112:115]
  s_waitcnt lgkmcnt(4)
  v_mfma_f32_16x16x32_bf16 v[128:131], a[8:11], a[48:51], v[128:131]
  ds_read_b64_tr_b16 a[4:5], v9 offset:43136
  ds_read_b64_tr_b16 a[6:7], v9 offset:44928
  v_mfma_f32_16x16x32_bf16 v[132:135], a[8:11], a[52:55], v[132:135]
  v_mfma_f32_16x16x32_bf16 v[136:139], a[8:11], a[56:59], v[136:139]
  v_mfma_f32_16x16x32_bf16 v[140:143], a[8:11], a[60:63], v[140:143]
  s_waitcnt lgkmcnt(4)
  v_mfma_f32_16x16x32_bf16 v[156:159], a[12:15], a[60:63], v[156:159]
  ds_read_b64_tr_b16 a[8:9], v9 offset:28832
  ds_read_b64_tr_b16 a[10:11], v9 offset:30624
  v_mfma_f32_16x16x32_bf16 v[152:155], a[12:15], a[56:59], v[152:155]
  buffer_load_dwordx4 a[44:47], v8, s[8:11], s17 offen offset:768 sc1
  s_add_u32 s17, s17, 131072
  v_mfma_f32_16x16x32_bf16 v[148:151], a[12:15], a[52:55], v[148:151]
  v_mfma_f32_16x16x32_bf16 v[144:147], a[12:15], a[48:51], v[144:147]
  s_waitcnt lgkmcnt(4)
  v_mfma_f32_16x16x32_bf16 v[160:163], a[0:3], a[48:51], v[160:163]
  ds_read_b64_tr_b16 a[12:13], v9 offset:43168
  ds_read_b64_tr_b16 a[14:15], v9 offset:44960
  v_mfma_f32_16x16x32_bf16 v[164:167], a[0:3], a[52:55], v[164:167]
  s_add_u32 m0, s18, 28672
  v_mfma_f32_16x16x32_bf16 v[168:171], a[0:3], a[56:59], v[168:171]
  buffer_load_dwordx4 v1, s[4:7], s16 offen  lds
  v_mfma_f32_16x16x32_bf16 v[172:175], a[0:3], a[60:63], v[172:175]
  s_waitcnt lgkmcnt(4)
  v_mfma_f32_16x16x32_bf16 v[188:191], a[4:7], a[60:63], v[188:191]
  ds_read_b64_tr_b16 a[0:1], v9 offset:28864
  ds_read_b64_tr_b16 a[2:3], v9 offset:30656
  v_mfma_f32_16x16x32_bf16 v[184:187], a[4:7], a[56:59], v[184:187]
  v_mfma_f32_16x16x32_bf16 v[180:183], a[4:7], a[52:55], v[180:183]
  v_mfma_f32_16x16x32_bf16 v[176:179], a[4:7], a[48:51], v[176:179]
  s_waitcnt lgkmcnt(4)
  v_mfma_f32_16x16x32_bf16 v[192:195], a[8:11], a[48:51], v[192:195]
  ds_read_b64_tr_b16 a[4:5], v9 offset:43200
  ds_read_b64_tr_b16 a[6:7], v9 offset:44992
  v_mfma_f32_16x16x32_bf16 v[196:199], a[8:11], a[52:55], v[196:199]
  s_add_u32 m0, s18, 29696
  v_mfma_f32_16x16x32_bf16 v[200:203], a[8:11], a[56:59], v[200:203]
  buffer_load_dwordx4 v2, s[4:7], s16 offen  lds
  v_mfma_f32_16x16x32_bf16 v[204:207], a[8:11], a[60:63], v[204:207]
  s_waitcnt lgkmcnt(4)
  v_mfma_f32_16x16x32_bf16 v[220:223], a[12:15], a[60:63], v[220:223]
  ds_read_b64_tr_b16 a[8:9], v9 offset:35840
  ds_read_b64_tr_b16 a[10:11], v9 offset:37632
  v_mfma_f32_16x16x32_bf16 v[216:219], a[12:15], a[56:59], v[216:219]
  v_mfma_f32_16x16x32_bf16 v[212:215], a[12:15], a[52:55], v[212:215]
  v_mfma_f32_16x16x32_bf16 v[208:211], a[12:15], a[48:51], v[208:211]
  s_waitcnt lgkmcnt(4)
  v_mfma_f32_16x16x32_bf16 v[224:227], a[0:3], a[48:51], v[224:227]
  ds_read_b64_tr_b16 a[12:13], v9 offset:50176
  ds_read_b64_tr_b16 a[14:15], v9 offset:51968
  v_mfma_f32_16x16x32_bf16 v[228:231], a[0:3], a[52:55], v[228:231]
  s_add_u32 m0, s18, 30720
  v_mfma_f32_16x16x32_bf16 v[232:235], a[0:3], a[56:59], v[232:235]
  buffer_load_dwordx4 v3, s[4:7], s16 offen  lds
  v_mfma_f32_16x16x32_bf16 v[236:239], a[0:3], a[60:63], v[236:239]
  s_waitcnt lgkmcnt(4)
  v_mfma_f32_16x16x32_bf16 v[252:255], a[4:7], a[60:63], v[252:255]
  ds_read_b64_tr_b16 a[0:1], v9 offset:35872
  ds_read_b64_tr_b16 a[2:3], v9 offset:37664
  v_mfma_f32_16x16x32_bf16 v[248:251], a[4:7], a[56:59], v[248:251]
  v_mfma_f32_16x16x32_bf16 v[244:247], a[4:7], a[52:55], v[244:247]
  v_mfma_f32_16x16x32_bf16 v[240:243], a[4:7], a[48:51], v[240:243]
  s_waitcnt vmcnt(19) lgkmcnt(4)
  v_mfma_f32_16x16x32_bf16 v[32:35], a[8:11], a[64:67], v[32:35]
  ds_read_b64_tr_b16 a[4:5], v9 offset:50208
  ds_read_b64_tr_b16 a[6:7], v9 offset:52000
  v_mfma_f32_16x16x32_bf16 v[36:39], a[8:11], a[68:71], v[36:39]
  s_add_u32 m0, s18, 31744
  v_mfma_f32_16x16x32_bf16 v[40:43], a[8:11], a[72:75], v[40:43]
  buffer_load_dwordx4 v4, s[4:7], s16 offen  lds
  v_mfma_f32_16x16x32_bf16 v[44:47], a[8:11], a[76:79], v[44:47]
  s_waitcnt lgkmcnt(4)
  v_mfma_f32_16x16x32_bf16 v[60:63], a[12:15], a[76:79], v[60:63]
  ds_read_b64_tr_b16 a[8:9], v9 offset:35904
  ds_read_b64_tr_b16 a[10:11], v9 offset:37696
  v_mfma_f32_16x16x32_bf16 v[56:59], a[12:15], a[72:75], v[56:59]
  buffer_load_dwordx4 a[48:51], v8, s[8:11], s17 offen offset:0 sc1
  v_mfma_f32_16x16x32_bf16 v[52:55], a[12:15], a[68:71], v[52:55]
  v_mfma_f32_16x16x32_bf16 v[48:51], a[12:15], a[64:67], v[48:51]
  s_waitcnt lgkmcnt(4)
  v_mfma_f32_16x16x32_bf16 v[64:67], a[0:3], a[64:67], v[64:67]
  ds_read_b64_tr_b16 a[12:13], v9 offset:50240
  ds_read_b64_tr_b16 a[14:15], v9 offset:52032
  v_mfma_f32_16x16x32_bf16 v[68:71], a[0:3], a[68:71], v[68:71]
  v_mfma_f32_16x16x32_bf16 v[72:75], a[0:3], a[72:75], v[72:75]
  v_mfma_f32_16x16x32_bf16 v[76:79], a[0:3], a[76:79], v[76:79]
  s_waitcnt lgkmcnt(4)
  v_mfma_f32_16x16x32_bf16 v[92:95], a[4:7], a[76:79], v[92:95]
  ds_read_b64_tr_b16 a[0:1], v9 offset:35936
  ds_read_b64_tr_b16 a[2:3], v9 offset:37728
  v_mfma_f32_16x16x32_bf16 v[88:91], a[4:7], a[72:75], v[88:91]
  buffer_load_dwordx4 a[52:55], v8, s[8:11], s17 offen offset:256 sc1
  v_mfma_f32_16x16x32_bf16 v[84:87], a[4:7], a[68:71], v[84:87]
  v_mfma_f32_16x16x32_bf16 v[80:83], a[4:7], a[64:67], v[80:83]
  s_waitcnt lgkmcnt(4)
  v_mfma_f32_16x16x32_bf16 v[96:99], a[8:11], a[64:67], v[96:99]
  ds_read_b64_tr_b16 a[4:5], v9 offset:50272
  ds_read_b64_tr_b16 a[6:7], v9 offset:52064
  v_mfma_f32_16x16x32_bf16 v[100:103], a[8:11], a[68:71], v[100:103]
  v_mfma_f32_16x16x32_bf16 v[104:107], a[8:11], a[72:75], v[104:107]
  v_mfma_f32_16x16x32_bf16 v[108:111], a[8:11], a[76:79], v[108:111]
  s_waitcnt lgkmcnt(4)
  v_mfma_f32_16x16x32_bf16 v[124:127], a[12:15], a[76:79], v[124:127]
  ds_read_b64_tr_b16 a[8:9], v9 offset:35968
  ds_read_b64_tr_b16 a[10:11], v9 offset:37760
  v_mfma_f32_16x16x32_bf16 v[120:123], a[12:15], a[72:75], v[120:123]
  buffer_load_dwordx4 a[56:59], v8, s[8:11], s17 offen offset:512 sc1
  v_mfma_f32_16x16x32_bf16 v[116:119], a[12:15], a[68:71], v[116:119]
  v_mfma_f32_16x16x32_bf16 v[112:115], a[12:15], a[64:67], v[112:115]
  s_waitcnt lgkmcnt(4)
  v_mfma_f32_16x16x32_bf16 v[128:131], a[0:3], a[64:67], v[128:131]
  ds_read_b64_tr_b16 a[12:13], v9 offset:50304
  ds_read_b64_tr_b16 a[14:15], v9 offset:52096
  v_mfma_f32_16x16x32_bf16 v[132:135], a[0:3], a[68:71], v[132:135]
  v_mfma_f32_16x16x32_bf16 v[136:139], a[0:3], a[72:75], v[136:139]
  v_mfma_f32_16x16x32_bf16 v[140:143], a[0:3], a[76:79], v[140:143]
  s_waitcnt lgkmcnt(4)
  v_mfma_f32_16x16x32_bf16 v[156:159], a[4:7], a[76:79], v[156:159]
  ds_read_b64_tr_b16 a[0:1], v9 offset:36000
  ds_read_b64_tr_b16 a[2:3], v9 offset:37792
  v_mfma_f32_16x16x32_bf16 v[152:155], a[4:7], a[72:75], v[152:155]
  buffer_load_dwordx4 a[60:63], v8, s[8:11], s17 offen offset:768 sc1
  s_add_u32 s17, s17, 131072
  v_mfma_f32_16x16x32_bf16 v[148:151], a[4:7], a[68:71], v[148:151]
  v_mfma_f32_16x16x32_bf16 v[144:147], a[4:7], a[64:67], v[144:147]
  s_waitcnt lgkmcnt(4)
  v_mfma_f32_16x16x32_bf16 v[160:163], a[8:11], a[64:67], v[160:163]
  ds_read_b64_tr_b16 a[4:5], v9 offset:50336
  ds_read_b64_tr_b16 a[6:7], v9 offset:52128
  v_mfma_f32_16x16x32_bf16 v[164:167], a[8:11], a[68:71], v[164:167]
  s_add_u32 m0, s18, 32768
  v_mfma_f32_16x16x32_bf16 v[168:171], a[8:11], a[72:75], v[168:171]
  buffer_load_dwordx4 v5, s[4:7], s16 offen  lds
  v_mfma_f32_16x16x32_bf16 v[172:175], a[8:11], a[76:79], v[172:175]
  s_waitcnt lgkmcnt(4)
  v_mfma_f32_16x16x32_bf16 v[188:191], a[12:15], a[76:79], v[188:191]
  ds_read_b64_tr_b16 a[8:9], v9 offset:36032
  ds_read_b64_tr_b16 a[10:11], v9 offset:37824
  v_mfma_f32_16x16x32_bf16 v[184:187], a[12:15], a[72:75], v[184:187]
  v_mfma_f32_16x16x32_bf16 v[180:183], a[12:15], a[68:71], v[180:183]
  v_mfma_f32_16x16x32_bf16 v[176:179], a[12:15], a[64:67], v[176:179]
  s_waitcnt lgkmcnt(4)
  v_mfma_f32_16x16x32_bf16 v[192:195], a[0:3], a[64:67], v[192:195]
  ds_read_b64_tr_b16 a[12:13], v9 offset:50368
  ds_read_b64_tr_b16 a[14:15], v9 offset:52160
  v_mfma_f32_16x16x32_bf16 v[196:199], a[0:3], a[68:71], v[196:199]
  s_add_u32 m0, s18, 33792
  v_mfma_f32_16x16x32_bf16 v[200:203], a[0:3], a[72:75], v[200:203]
  buffer_load_dwordx4 v6, s[4:7], s16 offen  lds
  v_mfma_f32_16x16x32_bf16 v[204:207], a[0:3], a[76:79], v[204:207]
  s_waitcnt vmcnt(14)
  s_barrier
  v_add_u32 v9, s21, v9
  s_sub_u32 s21, 0, s21
  s_waitcnt lgkmcnt(4)
  v_mfma_f32_16x16x32_bf16 v[220:223], a[4:7], a[76:79], v[220:223]
  ds_read_b64_tr_b16 a[0:1], v9 offset:0
  ds_read_b64_tr_b16 a[2:3], v9 offset:1792
  v_mfma_f32_16x16x32_bf16 v[216:219], a[4:7], a[72:75], v[216:219]
  v_mfma_f32_16x16x32_bf16 v[212:215], a[4:7], a[68:71], v[212:215]
  v_mfma_f32_16x16x32_bf16 v[208:211], a[4:7], a[64:67], v[208:211]
  s_waitcnt lgkmcnt(4)
  v_mfma_f32_16x16x32_bf16 v[224:227], a[8:11], a[64:67], v[224:227]
  ds_read_b64_tr_b16 a[4:5], v9 offset:14336
  ds_read_b64_tr_b16 a[6:7], v9 offset:16128
  v_mfma_f32_16x16x32_bf16 v[228:231], a[8:11], a[68:71], v[228:231]
  s_add_u32 m0, s18, 34816
  v_mfma_f32_16x16x32_bf16 v[232:235], a[8:11], a[72:75], v[232:235]
  buffer_load_dwordx4 v7, s[4:7], s16 offen  lds
  s_add_u32 s16, s16, 458752
  s_add_u32 s18, s18, s22
  s_sub_u32 s22, 0, s22
  v_mfma_f32_16x16x32_bf16 v[236:239], a[8:11], a[76:79], v[236:239]
  s_waitcnt lgkmcnt(4)
  v_mfma_f32_16x16x32_bf16 v[252:255], a[12:15], a[76:79], v[252:255]
  ds_read_b64_tr_b16 a[8:9], v9 offset:32
  ds_read_b64_tr_b16 a[10:11], v9 offset:1824
  v_mfma_f32_16x16x32_bf16 v[248:251], a[12:15], a[72:75], v[248:251]
  v_mfma_f32_16x16x32_bf16 v[244:247], a[12:15], a[68:71], v[244:247]
  v_mfma_f32_16x16x32_bf16 v[240:243], a[12:15], a[64:67], v[240:243]
  s_add_u32 s19, s19, 1
  s_cmp_lt_u32 s19, 7
  s_cbranch_scc1 L_b_kernel_loop
L_b_kernel_go:
  v_mov_b32 v1, v9
  s_waitcnt lgkmcnt(4)
  v_mfma_f32_16x16x32_bf16 v[32:35], a[0:3], a[16:19], v[32:35]
  ds_read_b64_tr_b16 a[12:13], v1 offset:14368
  ds_read_b64_tr_b16 a[14:15], v1 offset:16160
  buffer_load_dwordx4 a[64:67], v8, s[8:11], s17 offen offset:0 sc1
  buffer_load_dwordx4 a[68:71], v8, s[8:11], s17 offen offset:256 sc1
  v_mfma_f32_16x16x32_bf16 v[36:39], a[0:3], a[20:23], v[36:39]
  buffer_load_dwordx4 a[72:75], v8, s[8:11], s17 offen offset:512 sc1
  buffer_load_dwordx4 a[76:79], v8, s[8:11], s17 offen offset:768 sc1
  s_add_u32 s17, s17, 131072
  v_mfma_f32_16x16x32_bf16 v[40:43], a[0:3], a[24:27], v[40:43]
  buffer_load_dword v28, v26, s[64:67], 0 offen offset:0 sc1
  buffer_load_dword v29, v26, s[64:67], 0 offen offset:64 sc1
  v_mfma_f32_16x16x32_bf16 v[44:47], a[0:3], a[28:31], v[44:47]
  buffer_load_dword v30, v26, s[64:67], 0 offen offset:128 sc1
  buffer_load_dword v31, v26, s[64:67], 0 offen offset:192 sc1
  s_waitcnt lgkmcnt(4)
  v_mfma_f32_16x16x32_bf16 v[60:63], a[4:7], a[28:31], v[60:63]
  ds_read_b64_tr_b16 a[0:1], v1 offset:64
  ds_read_b64_tr_b16 a[2:3], v1 offset:1856
  s_and_b32 s53, s2, 1
  v_mfma_f32_16x16x32_bf16 v[56:59], a[4:7], a[24:27], v[56:59]
  s_bfe_u32 s3, s2, 0x20001
  s_lshl_b32 s3, s3, 2
  v_mfma_f32_16x16x32_bf16 v[52:55], a[4:7], a[20:23], v[52:55]
  s_bfe_u32 s29, s2, 0x20003
  s_add_u32 s3, s3, s29
  v_mfma_f32_16x16x32_bf16 v[48:51], a[4:7], a[16:19], v[48:51]
  s_lshr_b32 s27, s2, 5
  s_waitcnt lgkmcnt(4)
  v_mfma_f32_16x16x32_bf16 v[64:67], a[8:11], a[16:19], v[64:67]
  ds_read_b64_tr_b16 a[4:5], v1 offset:14400
  ds_read_b64_tr_b16 a[6:7], v1 offset:16192
  s_and_b32 s56, s3, 14
  v_mfma_f32_16x16x32_bf16 v[68:71], a[8:11], a[20:23], v[68:71]
  s_add_u32 s56, s56, s53
  s_lshl_b32 s56, s56, 7
  v_mfma_f32_16x16x32_bf16 v[72:75], a[8:11], a[24:27], v[72:75]
  s_lshl_b32 s3, s3, 7
  s_lshl_b32 s29, s28, 5
  v_mfma_f32_16x16x32_bf16 v[76:79], a[8:11], a[28:31], v[76:79]
  s_add_u32 s3, s3, s29
  s_waitcnt lgkmcnt(4)
  v_mfma_f32_16x16x32_bf16 v[92:95], a[12:15], a[28:31], v[92:95]
  ds_read_b64_tr_b16 a[8:9], v1 offset:7168
  ds_read_b64_tr_b16 a[10:11], v1 offset:8960
  s_mul_i32 s16, s53, 3670016
  v_mfma_f32_16x16x32_bf16 v[88:91], a[12:15], a[24:27], v[88:91]
  s_mul_i32 s17, s53, 7340032
  s_lshl_b32 s18, s28, 12
  v_mfma_f32_16x16x32_bf16 v[84:87], a[12:15], a[20:23], v[84:87]
  s_add_u32 s18, s18, 65536
  s_lshl_b32 s29, s27, 8
  v_mfma_f32_16x16x32_bf16 v[80:83], a[12:15], a[16:19], v[80:83]
  s_add_u32 s4, s92, s29
  s_waitcnt lgkmcnt(4)
  v_mfma_f32_16x16x32_bf16 v[96:99], a[0:3], a[16:19], v[96:99]
  ds_read_b64_tr_b16 a[12:13], v1 offset:21504
  ds_read_b64_tr_b16 a[14:15], v1 offset:23296
  s_addc_u32 s5, s93, 0
  v_mfma_f32_16x16x32_bf16 v[100:103], a[0:3], a[20:23], v[100:103]
  s_sub_u32 s6, 7340032, s29
  s_mov_b32 s7, 0x20000
  v_mfma_f32_16x16x32_bf16 v[104:107], a[0:3], a[24:27], v[104:107]
  s_lshl_b32 s27, s27, 1
  s_add_u32 s27, s27, s53
  v_mfma_f32_16x16x32_bf16 v[108:111], a[0:3], a[28:31], v[108:111]
  s_mul_i32 s73, s26, 458752
  s_waitcnt lgkmcnt(4)
  v_mfma_f32_16x16x32_bf16 v[124:127], a[4:7], a[28:31], v[124:127]
  ds_read_b64_tr_b16 a[0:1], v1 offset:7200
  ds_read_b64_tr_b16 a[2:3], v1 offset:8992
  s_add_u32 s76, s24, 26214400
  v_mfma_f32_16x16x32_bf16 v[120:123], a[4:7], a[24:27], v[120:123]
  s_addc_u32 s77, s25, 0
  s_mov_b32 s78, 8388608
  v_mfma_f32_16x16x32_bf16 v[116:119], a[4:7], a[20:23], v[116:119]
  s_mov_b32 s79, 0x20000
  s_lshl_b32 s80, s2, 2
  v_mfma_f32_16x16x32_bf16 v[112:115], a[4:7], a[16:19], v[112:115]
  s_add_u32 s80, s80, s28
  s_waitcnt vmcnt(19) lgkmcnt(4)
  v_mfma_f32_16x16x32_bf16 v[32:35], a[8:11], a[32:35], v[32:35]
  ds_read_b64_tr_b16 a[4:5], v1 offset:21536
  ds_read_b64_tr_b16 a[6:7], v1 offset:23328
  s_xor_b32 s81, s80, 4
  v_mfma_f32_16x16x32_bf16 v[36:39], a[8:11], a[36:39], v[36:39]
  s_lshl_b32 s82, s80, 6
  s_add_u32 s82, s82, 8192
  v_mfma_f32_16x16x32_bf16 v[40:43], a[8:11], a[40:43], v[40:43]
  s_lshl_b32 s83, s81, 6
  s_add_u32 s83, s83, 8192
  v_mfma_f32_16x16x32_bf16 v[44:47], a[8:11], a[44:47], v[44:47]
  s_mul_i32 s80, s80, 4096
  s_waitcnt lgkmcnt(4)
  v_mfma_f32_16x16x32_bf16 v[60:63], a[12:15], a[44:47], v[60:63]
  ds_read_b64_tr_b16 a[8:9], v1 offset:7232
  ds_read_b64_tr_b16 a[10:11], v1 offset:9024
  s_mul_i32 s81, s81, 4096
  v_mfma_f32_16x16x32_bf16 v[56:59], a[12:15], a[40:43], v[56:59]
  s_add_u32 s52, s52, 73728
  s_add_u32 s56, s56, 73728
  v_mfma_f32_16x16x32_bf16 v[52:55], a[12:15], a[36:39], v[52:55]
  s_lshl_b32 s57, s27, 18
  s_add_u32 s58, s57, 131072
  v_mfma_f32_16x16x32_bf16 v[48:51], a[12:15], a[32:35], v[48:51]
  s_lshl_b32 s27, s27, 7
  s_waitcnt lgkmcnt(4)
  v_mfma_f32_16x16x32_bf16 v[64:67], a[0:3], a[32:35], v[64:67]
  ds_read_b64_tr_b16 a[12:13], v1 offset:21568
  ds_read_b64_tr_b16 a[14:15], v1 offset:23360
  s_add_u32 s84, s94, s27
  v_mfma_f32_16x16x32_bf16 v[68:71], a[0:3], a[36:39], v[68:71]
  s_addc_u32 s85, s95, 0
  s_sub_u32 s86, 4194304, s27
  v_mfma_f32_16x16x32_bf16 v[72:75], a[0:3], a[40:43], v[72:75]
  s_mov_b32 s87, 0x20000
  s_cmp_eq_u32 s28, 0
  v_mfma_f32_16x16x32_bf16 v[76:79], a[0:3], a[44:47], v[76:79]
  s_cselect_b32 s62, 81920, 0
  s_waitcnt vmcnt(8)
  s_barrier
  s_waitcnt lgkmcnt(4)
  v_mfma_f32_16x16x32_bf16 v[92:95], a[4:7], a[44:47], v[92:95]
  ds_read_b64_tr_b16 a[0:1], v1 offset:28672
  ds_read_b64_tr_b16 a[2:3], v1 offset:30464
  s_mov_b32 s60, s64
  v_mfma_f32_16x16x32_bf16 v[88:91], a[4:7], a[40:43], v[88:91]
  s_mov_b32 s61, s65
  s_mov_b32 s63, 0x20000
  v_mfma_f32_16x16x32_bf16 v[84:87], a[4:7], a[36:39], v[84:87]
  v_and_b32 v2, 63, v0
  v_lshrrev_b32 v3, 4, v2
  v_mfma_f32_16x16x32_bf16 v[80:83], a[4:7], a[32:35], v[80:83]
  s_mul_i32 s29, s28, 112
  s_waitcnt lgkmcnt(4)
  v_mfma_f32_16x16x32_bf16 v[96:99], a[8:11], a[32:35], v[96:99]
  ds_read_b64_tr_b16 a[4:5], v1 offset:43008
  ds_read_b64_tr_b16 a[6:7], v1 offset:44800
  v_add_lshl_u32 v4, v3, s29, 11
  v_mfma_f32_16x16x32_bf16 v[100:103], a[8:11], a[36:39], v[100:103]
  v_and_b32 v5, 1, v3
  v_and_b32 v3, 2, v3
  v_mfma_f32_16x16x32_bf16 v[104:107], a[8:11], a[40:43], v[104:107]
  v_lshl_add_u32 v3, v3, 1, v5
  v_and_b32 v2, 15, v2
  v_mfma_f32_16x16x32_bf16 v[108:111], a[8:11], a[44:47], v[108:111]
  v_xor_b32 v3, v3, v2
  s_waitcnt lgkmcnt(4)
  v_mfma_f32_16x16x32_bf16 v[124:127], a[12:15], a[44:47], v[124:127]
  ds_read_b64_tr_b16 a[8:9], v1 offset:35840
  ds_read_b64_tr_b16 a[10:11], v1 offset:37632
  v_lshl_add_u32 v6, v3, 4, v4
  v_mfma_f32_16x16x32_bf16 v[120:123], a[12:15], a[40:43], v[120:123]
  v_add_u32 v7, 8192, v6
  v_xor_b32 v8, 128, v6
  v_mfma_f32_16x16x32_bf16 v[116:119], a[12:15], a[36:39], v[116:119]
  v_add_u32 v8, 16384, v8
  v_add_u32 v9, 8192, v8
  v_mfma_f32_16x16x32_bf16 v[112:115], a[12:15], a[32:35], v[112:115]
  s_waitcnt vmcnt(0)
  v_min_u32 v2, v28, v29
  v_min3_u32 v2, v2, v30, v31
  v_cmp_eq_u32 vcc, 0, v2
  s_cbranch_vccnz L_b_kernel_spin0
L_b_kernel_ret0:
  s_waitcnt lgkmcnt(4)
  v_mfma_f32_16x16x32_bf16 v[32:35], a[0:3], a[48:51], v[32:35]
  ds_read_b64_tr_b16 a[12:13], v1 offset:50176
  ds_read_b64_tr_b16 a[14:15], v1 offset:51968
  v_and_b32 v2, 0xffff0000, v28
  v_mfma_f32_16x16x32_bf16 v[36:39], a[0:3], a[52:55], v[36:39]
  v_lshlrev_b32 v12, 16, v28
  v_rcp_f32 v16, v2
  v_mfma_f32_16x16x32_bf16 v[40:43], a[0:3], a[56:59], v[40:43]
  v_mul_f32 v20, v2, v2
  v_xor_b32 v12, 0x80000000, v12
  v_mfma_f32_16x16x32_bf16 v[44:47], a[0:3], a[60:63], v[44:47]
  v_and_b32 v2, 0xffff0000, v29
  s_waitcnt lgkmcnt(4)
  v_mfma_f32_16x16x32_bf16 v[60:63], a[4:7], a[60:63], v[60:63]
  ds_read_b64_tr_b16 a[0:1], v1 offset:28704
  ds_read_b64_tr_b16 a[2:3], v1 offset:30496
  v_lshlrev_b32 v13, 16, v29
  v_mfma_f32_16x16x32_bf16 v[56:59], a[4:7], a[56:59], v[56:59]
  v_rcp_f32 v17, v2
  v_mul_f32 v21, v2, v2
  v_mfma_f32_16x16x32_bf16 v[52:55], a[4:7], a[52:55], v[52:55]
  v_xor_b32 v13, 0x80000000, v13
  v_and_b32 v2, 0xffff0000, v30
  v_mfma_f32_16x16x32_bf16 v[48:51], a[4:7], a[48:51], v[48:51]
  v_lshlrev_b32 v14, 16, v30
  s_waitcnt lgkmcnt(4)
  v_mfma_f32_16x16x32_bf16 v[32:35], a[8:11], a[64:67], v[32:35]
  ds_read_b64_tr_b16 a[4:5], v1 offset:43040
  ds_read_b64_tr_b16 a[6:7], v1 offset:44832
  v_rcp_f32 v18, v2
  v_mfma_f32_16x16x32_bf16 v[36:39], a[8:11], a[68:71], v[36:39]
  v_mul_f32 v22, v2, v2
  v_xor_b32 v14, 0x80000000, v14
  v_mfma_f32_16x16x32_bf16 v[40:43], a[8:11], a[72:75], v[40:43]
  v_and_b32 v2, 0xffff0000, v31
  v_lshlrev_b32 v15, 16, v31
  v_mfma_f32_16x16x32_bf16 v[44:47], a[8:11], a[76:79], v[44:47]
  v_rcp_f32 v19, v2
  s_waitcnt lgkmcnt(4)
  v_mfma_f32_16x16x32_bf16 v[60:63], a[12:15], a[76:79], v[60:63]
  ds_read_b64_tr_b16 a[8:9], v1 offset:35872
  ds_read_b64_tr_b16 a[10:11], v1 offset:37664
  v_mul_f32 v23, v2, v2
  v_mfma_f32_16x16x32_bf16 v[56:59], a[12:15], a[72:75], v[56:59]
  v_xor_b32 v15, 0x80000000, v15
  v_mov_b32 v11, v27
  v_mfma_f32_16x16x32_bf16 v[52:55], a[12:15], a[68:71], v[52:55]
  ds_read_b128 v[24:27], v11
  ds_read_b128 v[28:31], v11 offset:448
  v_mfma_f32_16x16x32_bf16 v[48:51], a[12:15], a[64:67], v[48:51]
  v_mul_f32 v16, 0xbfb8aa3b, v16
  s_waitcnt lgkmcnt(6)
  v_mfma_f32_16x16x32_bf16 v[64:67], a[0:3], a[48:51], v[64:67]
  ds_read_b64_tr_b16 a[12:13], v1 offset:50208
  ds_read_b64_tr_b16 a[14:15], v1 offset:52000
  v_mul_f32 v17, 0xbfb8aa3b, v17
  v_mfma_f32_16x16x32_bf16 v[68:71], a[0:3], a[52:55], v[68:71]
  v_mul_f32 v18, 0xbfb8aa3b, v18
  v_mul_f32 v19, 0xbfb8aa3b, v19
  v_mfma_f32_16x16x32_bf16 v[72:75], a[0:3], a[56:59], v[72:75]
  s_add_u32 m0, s18, 0
  v_mfma_f32_16x16x32_bf16 v[76:79], a[0:3], a[60:63], v[76:79]
  buffer_load_dwordx4 v6, s[4:7], s16 offen  lds
  s_waitcnt lgkmcnt(6)
  v_mfma_f32_16x16x32_bf16 v[92:95], a[4:7], a[60:63], v[92:95]
  ds_read_b64_tr_b16 a[0:1], v1 offset:28736
  ds_read_b64_tr_b16 a[2:3], v1 offset:30528
  v_mfma_f32_16x16x32_bf16 v[88:91], a[4:7], a[56:59], v[88:91]
  v_mfma_f32_16x16x32_bf16 v[84:87], a[4:7], a[52:55], v[84:87]
  v_mfma_f32_16x16x32_bf16 v[80:83], a[4:7], a[48:51], v[80:83]
  s_waitcnt lgkmcnt(4)
  v_fmac_f32 v32, v24, v12
  v_mfma_f32_16x16x32_bf16 v[64:67], a[8:11], a[64:67], v[64:67]
  ds_read_b64_tr_b16 a[4:5], v1 offset:43072
  ds_read_b64_tr_b16 a[6:7], v1 offset:44864
  v_mfma_f32_16x16x32_bf16 v[68:71], a[8:11], a[68:71], v[68:71]
  v_fmac_f32 v33, v25, v12
  v_mfma_f32_16x16x32_bf16 v[72:75], a[8:11], a[72:75], v[72:75]
  s_add_u32 m0, s18, 1024
  v_fmac_f32 v34, v26, v12
  v_mfma_f32_16x16x32_bf16 v[76:79], a[8:11], a[76:79], v[76:79]
  buffer_load_dwordx4 v7, s[4:7], s16 offen  lds
  v_fmac_f32 v35, v27, v12
  s_waitcnt lgkmcnt(4)
  v_mfma_f32_16x16x32_bf16 v[92:95], a[12:15], a[76:79], v[92:95]
  ds_read_b64_tr_b16 a[8:9], v1 offset:35904
  ds_read_b64_tr_b16 a[10:11], v1 offset:37696
  v_mfma_f32_16x16x32_bf16 v[88:91], a[12:15], a[72:75], v[88:91]
  v_mul_f32 v2, v32, v16
  v_mfma_f32_16x16x32_bf16 v[84:87], a[12:15], a[68:71], v[84:87]
  v_mul_f32 v3, v33, v16
  v_mfma_f32_16x16x32_bf16 v[80:83], a[12:15], a[64:67], v[80:83]
  v_mul_f32 v4, v34, v16
  s_waitcnt lgkmcnt(4)
  v_mfma_f32_16x16x32_bf16 v[96:99], a[0:3], a[48:51], v[96:99]
  ds_read_b64_tr_b16 a[12:13], v1 offset:50240
  ds_read_b64_tr_b16 a[14:15], v1 offset:52032
  v_mfma_f32_16x16x32_bf16 v[100:103], a[0:3], a[52:55], v[100:103]
  v_mul_f32 v5, v35, v16
  v_mfma_f32_16x16x32_bf16 v[104:107], a[0:3], a[56:59], v[104:107]
  s_add_u32 m0, s18, 2048
  v_exp_f32 v2, v2
  v_mfma_f32_16x16x32_bf16 v[108:111], a[0:3], a[60:63], v[108:111]
  buffer_load_dwordx4 v8, s[4:7], s16 offen  lds
  v_fmac_f32 v48, v28, v12
  s_waitcnt lgkmcnt(4)
  v_mfma_f32_16x16x32_bf16 v[124:127], a[4:7], a[60:63], v[124:127]
  ds_read_b64_tr_b16 a[0:1], v1 offset:96
  ds_read_b64_tr_b16 a[2:3], v1 offset:1888
  v_mfma_f32_16x16x32_bf16 v[120:123], a[4:7], a[56:59], v[120:123]
  v_exp_f32 v3, v3
  v_mfma_f32_16x16x32_bf16 v[116:119], a[4:7], a[52:55], v[116:119]
  v_fmac_f32 v49, v29, v12
  v_mfma_f32_16x16x32_bf16 v[112:115], a[4:7], a[48:51], v[112:115]
  v_exp_f32 v4, v4
  s_waitcnt lgkmcnt(4)
  v_mfma_f32_16x16x32_bf16 v[96:99], a[8:11], a[64:67], v[96:99]
  ds_read_b64_tr_b16 a[4:5], v1 offset:14432
  ds_read_b64_tr_b16 a[6:7], v1 offset:16224
  v_mfma_f32_16x16x32_bf16 v[100:103], a[8:11], a[68:71], v[100:103]
  v_fmac_f32 v50, v30, v12
  v_mfma_f32_16x16x32_bf16 v[104:107], a[8:11], a[72:75], v[104:107]
  s_add_u32 m0, s18, 3072
  v_exp_f32 v5, v5
  v_mfma_f32_16x16x32_bf16 v[108:111], a[8:11], a[76:79], v[108:111]
  buffer_load_dwordx4 v9, s[4:7], s16 offen  lds
  s_add_u32 s16, s16, 917504
  v_fmac_f32 v51, v31, v12
  s_waitcnt lgkmcnt(4)
  v_mfma_f32_16x16x32_bf16 v[124:127], a[12:15], a[76:79], v[124:127]
  ds_read_b64_tr_b16 a[8:9], v1 offset:7264
  ds_read_b64_tr_b16 a[10:11], v1 offset:9056
  v_mfma_f32_16x16x32_bf16 v[120:123], a[12:15], a[72:75], v[120:123]
  v_fma_f32 v2, v2, v20, v20
  v_mfma_f32_16x16x32_bf16 v[116:119], a[12:15], a[68:71], v[116:119]
  v_fma_f32 v3, v3, v20, v20
  v_mfma_f32_16x16x32_bf16 v[112:115], a[12:15], a[64:67], v[112:115]
  v_fma_f32 v4, v4, v20, v20
  s_waitcnt lgkmcnt(4)
  v_mfma_f32_16x16x32_bf16 v[128:131], a[0:3], a[16:19], v[128:131]
  ds_read_b64_tr_b16 a[12:13], v1 offset:21600
  ds_read_b64_tr_b16 a[14:15], v1 offset:23392
  v_mfma_f32_16x16x32_bf16 v[132:135], a[0:3], a[20:23], v[132:135]
  v_fma_f32 v5, v5, v20, v20
  v_mfma_f32_16x16x32_bf16 v[136:139], a[0:3], a[24:27], v[136:139]
  s_add_u32 m0, s18, 16384
  v_rcp_f32 v2, v2
  v_mfma_f32_16x16x32_bf16 v[140:143], a[0:3], a[28:31], v[140:143]
  buffer_load_dwordx4 v6, s[4:7], s16 offen  lds
  v_mul_f32 v32, v32, v48
  s_waitcnt lgkmcnt(4)
  v_mfma_f32_16x16x32_bf16 v[156:159], a[4:7], a[28:31], v[156:159]
  ds_read_b64_tr_b16 a[0:1], v1 offset:28768
  ds_read_b64_tr_b16 a[2:3], v1 offset:30560
  v_mfma_f32_16x16x32_bf16 v[152:155], a[4:7], a[24:27], v[152:155]
  v_rcp_f32 v3, v3
  v_mfma_f32_16x16x32_bf16 v[148:151], a[4:7], a[20:23], v[148:151]
  v_mul_f32 v33, v33, v49
  v_mfma_f32_16x16x32_bf16 v[144:147], a[4:7], a[16:19], v[144:147]
  v_rcp_f32 v4, v4
  s_waitcnt lgkmcnt(4)
  v_mfma_f32_16x16x32_bf16 v[128:131], a[8:11], a[32:35], v[128:131]
  ds_read_b64_tr_b16 a[4:5], v1 offset:43104
  ds_read_b64_tr_b16 a[6:7], v1 offset:44896
  v_mfma_f32_16x16x32_bf16 v[132:135], a[8:11], a[36:39], v[132:135]
  v_mul_f32 v34, v34, v50
  v_mfma_f32_16x16x32_bf16 v[136:139], a[8:11], a[40:43], v[136:139]
  s_add_u32 m0, s18, 17408
  v_rcp_f32 v5, v5
  v_mfma_f32_16x16x32_bf16 v[140:143], a[8:11], a[44:47], v[140:143]
  buffer_load_dwordx4 v7, s[4:7], s16 offen  lds
  v_mul_f32 v35, v35, v51
  s_waitcnt lgkmcnt(4)
  v_mfma_f32_16x16x32_bf16 v[156:159], a[12:15], a[44:47], v[156:159]
  ds_read_b64_tr_b16 a[8:9], v1 offset:35936
  ds_read_b64_tr_b16 a[10:11], v1 offset:37728
  v_mfma_f32_16x16x32_bf16 v[152:155], a[12:15], a[40:43], v[152:155]
  v_mul_f32 v32, v32, v2
  v_mfma_f32_16x16x32_bf16 v[148:151], a[12:15], a[36:39], v[148:151]
  v_mul_f32 v33, v33, v3
  v_mfma_f32_16x16x32_bf16 v[144:147], a[12:15], a[32:35], v[144:147]
  v_mul_f32 v34, v34, v4
  s_waitcnt lgkmcnt(4)
  v_mfma_f32_16x16x32_bf16 v[128:131], a[0:3], a[48:51], v[128:131]
  ds_read_b64_tr_b16 a[12:13], v1 offset:50272
  ds_read_b64_tr_b16 a[14:15], v1 offset:52064
  v_mfma_f32_16x16x32_bf16 v[132:135], a[0:3], a[52:55], v[132:135]
  v_mul_f32 v35, v35, v5
  v_mfma_f32_16x16x32_bf16 v[136:139], a[0:3], a[56:59], v[136:139]
  s_add_u32 m0, s18, 18432
  v_cvt_pk_bf16_f32 v35, v34, v35
  v_mfma_f32_16x16x32_bf16 v[140:143], a[0:3], a[60:63], v[140:143]
  buffer_load_dwordx4 v8, s[4:7], s16 offen  lds
  v_cvt_pk_bf16_f32 v34, v32, v33
  s_waitcnt lgkmcnt(4)
  v_mfma_f32_16x16x32_bf16 v[156:159], a[4:7], a[60:63], v[156:159]
  ds_read_b64_tr_b16 a[0:1], v1 offset:128
  ds_read_b64_tr_b16 a[2:3], v1 offset:1920
  v_mfma_f32_16x16x32_bf16 v[152:155], a[4:7], a[56:59], v[152:155]
  ds_read_b128 v[48:51], v11 offset:64
  v_mfma_f32_16x16x32_bf16 v[148:151], a[4:7], a[52:55], v[148:151]
  v_fmac_f32 v36, v24, v13
  v_mfma_f32_16x16x32_bf16 v[144:147], a[4:7], a[48:51], v[144:147]
  v_fmac_f32 v37, v25, v13
  s_waitcnt lgkmcnt(5)
  v_mfma_f32_16x16x32_bf16 v[128:131], a[8:11], a[64:67], v[128:131]
  ds_read_b64_tr_b16 a[4:5], v1 offset:14464
  ds_read_b64_tr_b16 a[6:7], v1 offset:16256
  v_mfma_f32_16x16x32_bf16 v[132:135], a[8:11], a[68:71], v[132:135]
  v_fmac_f32 v38, v26, v13
  v_mfma_f32_16x16x32_bf16 v[136:139], a[8:11], a[72:75], v[136:139]
  s_add_u32 m0, s18, 19456
  v_fmac_f32 v39, v27, v13
  v_mfma_f32_16x16x32_bf16 v[140:143], a[8:11], a[76:79], v[140:143]
  buffer_load_dwordx4 v9, s[4:7], s16 offen  lds
  s_add_u32 s16, s16, 917504
  v_mul_f32 v2, v36, v17
  s_waitcnt lgkmcnt(5)
  v_mfma_f32_16x16x32_bf16 v[156:159], a[12:15], a[76:79], v[156:159]
  ds_read_b64_tr_b16 a[8:9], v1 offset:7296
  ds_read_b64_tr_b16 a[10:11], v1 offset:9088
  v_mfma_f32_16x16x32_bf16 v[152:155], a[12:15], a[72:75], v[152:155]
  v_mul_f32 v3, v37, v17
  v_mfma_f32_16x16x32_bf16 v[148:151], a[12:15], a[68:71], v[148:151]
  v_mul_f32 v4, v38, v17
  v_mfma_f32_16x16x32_bf16 v[144:147], a[12:15], a[64:67], v[144:147]
  v_mul_f32 v5, v39, v17
  s_waitcnt lgkmcnt(5)
  v_mfma_f32_16x16x32_bf16 v[160:163], a[0:3], a[16:19], v[160:163]
  ds_read_b64_tr_b16 a[12:13], v1 offset:21632
  ds_read_b64_tr_b16 a[14:15], v1 offset:23424
  v_mfma_f32_16x16x32_bf16 v[164:167], a[0:3], a[20:23], v[164:167]
  v_exp_f32 v2, v2
  v_mfma_f32_16x16x32_bf16 v[168:171], a[0:3], a[24:27], v[168:171]
  s_add_u32 m0, s18, 32768
  v_fmac_f32 v52, v28, v13
  v_mfma_f32_16x16x32_bf16 v[172:175], a[0:3], a[28:31], v[172:175]
  buffer_load_dwordx4 v6, s[4:7], s16 offen  lds
  v_exp_f32 v3, v3
  s_waitcnt lgkmcnt(4)
  v_mfma_f32_16x16x32_bf16 v[188:191], a[4:7], a[28:31], v[188:191]
  ds_read_b64_tr_b16 a[0:1], v1 offset:28800
  ds_read_b64_tr_b16 a[2:3], v1 offset:30592
  v_mfma_f32_16x16x32_bf16 v[184:187], a[4:7], a[24:27], v[184:187]
  v_fmac_f32 v53, v29, v13
  v_mfma_f32_16x16x32_bf16 v[180:183], a[4:7], a[20:23], v[180:183]
  v_exp_f32 v4, v4
  v_mfma_f32_16x16x32_bf16 v[176:179], a[4:7], a[16:19], v[176:179]
  v_fmac_f32 v54, v30, v13
  s_waitcnt lgkmcnt(4)
  v_mfma_f32_16x16x32_bf16 v[160:163], a[8:11], a[32:35], v[160:163]
  ds_read_b64_tr_b16 a[4:5], v1 offset:43136
  ds_read_b64_tr_b16 a[6:7], v1 offset:44928
  v_mfma_f32_16x16x32_bf16 v[164:167], a[8:11], a[36:39], v[164:167]
  v_exp_f32 v5, v5
  v_mfma_f32_16x16x32_bf16 v[168:171], a[8:11], a[40:43], v[168:171]
  s_add_u32 m0, s18, 33792
  v_fmac_f32 v55, v31, v13
  v_mfma_f32_16x16x32_bf16 v[172:175], a[8:11], a[44:47], v[172:175]
  buffer_load_dwordx4 v7, s[4:7], s16 offen  lds
  v_fma_f32 v2, v2, v21, v21
  s_waitcnt lgkmcnt(4)
  v_mfma_f32_16x16x32_bf16 v[188:191], a[12:15], a[44:47], v[188:191]
  ds_read_b64_tr_b16 a[8:9], v1 offset:35968
  ds_read_b64_tr_b16 a[10:11], v1 offset:37760
  v_mfma_f32_16x16x32_bf16 v[184:187], a[12:15], a[40:43], v[184:187]
  v_fma_f32 v3, v3, v21, v21
  v_mfma_f32_16x16x32_bf16 v[180:183], a[12:15], a[36:39], v[180:183]
  v_fma_f32 v4, v4, v21, v21
  v_mfma_f32_16x16x32_bf16 v[176:179], a[12:15], a[32:35], v[176:179]
  v_fma_f32 v5, v5, v21, v21
  s_waitcnt lgkmcnt(4)
  v_mfma_f32_16x16x32_bf16 v[160:163], a[0:3], a[48:51], v[160:163]
  ds_read_b64_tr_b16 a[12:13], v1 offset:50304
  ds_read_b64_tr_b16 a[14:15], v1 offset:52096
  v_mfma_f32_16x16x32_bf16 v[164:167], a[0:3], a[52:55], v[164:167]
  v_rcp_f32 v2, v2
  v_mfma_f32_16x16x32_bf16 v[168:171], a[0:3], a[56:59], v[168:171]
  s_add_u32 m0, s18, 34816
  v_mul_f32 v36, v36, v52
  v_mfma_f32_16x16x32_bf16 v[172:175], a[0:3], a[60:63], v[172:175]
  buffer_load_dwordx4 v8, s[4:7], s16 offen  lds
  v_rcp_f32 v3, v3
  s_waitcnt lgkmcnt(4)
  v_mfma_f32_16x16x32_bf16 v[188:191], a[4:7], a[60:63], v[188:191]
  ds_read_b64_tr_b16 a[0:1], v1 offset:160
  ds_read_b64_tr_b16 a[2:3], v1 offset:1952
  v_mfma_f32_16x16x32_bf16 v[184:187], a[4:7], a[56:59], v[184:187]
  v_mul_f32 v37, v37, v53
  v_mfma_f32_16x16x32_bf16 v[180:183], a[4:7], a[52:55], v[180:183]
  v_rcp_f32 v4, v4
  v_mfma_f32_16x16x32_bf16 v[176:179], a[4:7], a[48:51], v[176:179]
  v_mul_f32 v38, v38, v54
  s_waitcnt lgkmcnt(4)
  v_mfma_f32_16x16x32_bf16 v[160:163], a[8:11], a[64:67], v[160:163]
  ds_read_b64_tr_b16 a[4:5], v1 offset:14496
  ds_read_b64_tr_b16 a[6:7], v1 offset:16288
  v_mfma_f32_16x16x32_bf16 v[164:167], a[8:11], a[68:71], v[164:167]
  v_rcp_f32 v5, v5
  v_mfma_f32_16x16x32_bf16 v[168:171], a[8:11], a[72:75], v[168:171]
  s_add_u32 m0, s18, 35840
  v_mul_f32 v39, v39, v55
  v_mfma_f32_16x16x32_bf16 v[172:175], a[8:11], a[76:79], v[172:175]
  buffer_load_dwordx4 v9, s[4:7], s16 offen  lds
  s_add_u32 s16, s16, 917504
  v_mul_f32 v36, v36, v2
  s_waitcnt lgkmcnt(4)
  v_mfma_f32_16x16x32_bf16 v[188:191], a[12:15], a[76:79], v[188:191]
  ds_read_b64_tr_b16 a[8:9], v1 offset:7328
  ds_read_b64_tr_b16 a[10:11], v1 offset:9120
  v_mfma_f32_16x16x32_bf16 v[184:187], a[12:15], a[72:75], v[184:187]
  v_mul_f32 v37, v37, v3
  v_mfma_f32_16x16x32_bf16 v[180:183], a[12:15], a[68:71], v[180:183]
  v_mul_f32 v38, v38, v4
  v_mfma_f32_16x16x32_bf16 v[176:179], a[12:15], a[64:67], v[176:179]
  v_mul_f32 v39, v39, v5
  s_waitcnt lgkmcnt(4)
  v_mfma_f32_16x16x32_bf16 v[192:195], a[0:3], a[16:19], v[192:195]
  ds_read_b64_tr_b16 a[12:13], v1 offset:21664
  ds_read_b64_tr_b16 a[14:15], v1 offset:23456
  v_mfma_f32_16x16x32_bf16 v[196:199], a[0:3], a[20:23], v[196:199]
  v_cvt_pk_bf16_f32 v36, v36, v37
  v_mfma_f32_16x16x32_bf16 v[200:203], a[0:3], a[24:27], v[200:203]
  s_add_u32 m0, s18, 49152
  v_cvt_pk_bf16_f32 v37, v38, v39
  v_mfma_f32_16x16x32_bf16 v[204:207], a[0:3], a[28:31], v[204:207]
  buffer_load_dwordx4 v6, s[4:7], s16 offen  lds
  ds_read_b128 v[52:55], v11 offset:512
  s_waitcnt lgkmcnt(5)
  v_mfma_f32_16x16x32_bf16 v[220:223], a[4:7], a[28:31], v[220:223]
  ds_read_b64_tr_b16 a[0:1], v1 offset:28832
  ds_read_b64_tr_b16 a[2:3], v1 offset:30624
  v_mfma_f32_16x16x32_bf16 v[216:219], a[4:7], a[24:27], v[216:219]
  v_fmac_f32 v40, v24, v14
  v_mfma_f32_16x16x32_bf16 v[212:215], a[4:7], a[20:23], v[212:215]
  v_fmac_f32 v41, v25, v14
  v_mfma_f32_16x16x32_bf16 v[208:211], a[4:7], a[16:19], v[208:211]
  v_permlane16_swap_b32 v34, v36
  s_waitcnt lgkmcnt(5)
  v_mfma_f32_16x16x32_bf16 v[192:195], a[8:11], a[32:35], v[192:195]
  ds_read_b64_tr_b16 a[4:5], v1 offset:43168
  ds_read_b64_tr_b16 a[6:7], v1 offset:44960
  v_mfma_f32_16x16x32_bf16 v[196:199], a[8:11], a[36:39], v[196:199]
  v_permlane16_swap_b32 v35, v37
  v_mfma_f32_16x16x32_bf16 v[200:203], a[8:11], a[40:43], v[200:203]
  s_add_u32 m0, s18, 50176
  buffer_store_dwordx4 v[34:37], v10, s[12:15], s73 offen offset:0 sc1
  v_mfma_f32_16x16x32_bf16 v[204:207], a[8:11], a[44:47], v[204:207]
  buffer_load_dwordx4 v7, s[4:7], s16 offen  lds
  v_fmac_f32 v42, v26, v14
  s_waitcnt lgkmcnt(5)
  v_mfma_f32_16x16x32_bf16 v[220:223], a[12:15], a[44:47], v[220:223]
  ds_read_b64_tr_b16 a[8:9], v1 offset:36000
  ds_read_b64_tr_b16 a[10:11], v1 offset:37792
  v_mfma_f32_16x16x32_bf16 v[216:219], a[12:15], a[40:43], v[216:219]
  v_fmac_f32 v43, v27, v14
  v_mfma_f32_16x16x32_bf16 v[212:215], a[12:15], a[36:39], v[212:215]
  v_mul_f32 v2, v40, v18
  v_mfma_f32_16x16x32_bf16 v[208:211], a[12:15], a[32:35], v[208:211]
  v_mul_f32 v3, v41, v18
  s_waitcnt lgkmcnt(4)
  v_mfma_f32_16x16x32_bf16 v[192:195], a[0:3], a[48:51], v[192:195]
  ds_read_b64_tr_b16 a[12:13], v1 offset:50336
  ds_read_b64_tr_b16 a[14:15], v1 offset:52128
  v_mfma_f32_16x16x32_bf16 v[196:199], a[0:3], a[52:55], v[196:199]
  v_mul_f32 v4, v42, v18
  v_mfma_f32_16x16x32_bf16 v[200:203], a[0:3], a[56:59], v[200:203]
  s_add_u32 m0, s18, 51200
  v_mul_f32 v5, v43, v18
  v_mfma_f32_16x16x32_bf16 v[204:207], a[0:3], a[60:63], v[204:207]
  buffer_load_dwordx4 v8, s[4:7], s16 offen  lds
  v_exp_f32 v2, v2
  s_waitcnt lgkmcnt(4)
  v_mfma_f32_16x16x32_bf16 v[220:223], a[4:7], a[60:63], v[220:223]
  ds_read_b64_tr_b16 a[0:1], v1 offset:192
  ds_read_b64_tr_b16 a[2:3], v1 offset:1984
  v_mfma_f32_16x16x32_bf16 v[216:219], a[4:7], a[56:59], v[216:219]
  v_fmac_f32 v56, v28, v14
  v_mfma_f32_16x16x32_bf16 v[212:215], a[4:7], a[52:55], v[212:215]
  v_exp_f32 v3, v3
  v_mfma_f32_16x16x32_bf16 v[208:211], a[4:7], a[48:51], v[208:211]
  v_fmac_f32 v57, v29, v14
  s_waitcnt lgkmcnt(4)
  v_mfma_f32_16x16x32_bf16 v[192:195], a[8:11], a[64:67], v[192:195]
  ds_read_b64_tr_b16 a[4:5], v1 offset:14528
  ds_read_b64_tr_b16 a[6:7], v1 offset:16320
  v_mfma_f32_16x16x32_bf16 v[196:199], a[8:11], a[68:71], v[196:199]
  v_exp_f32 v4, v4
  v_mfma_f32_16x16x32_bf16 v[200:203], a[8:11], a[72:75], v[200:203]
  s_add_u32 m0, s18, 52224
  v_fmac_f32 v58, v30, v14
  v_mfma_f32_16x16x32_bf16 v[204:207], a[8:11], a[76:79], v[204:207]
  buffer_load_dwordx4 v9, s[4:7], s16 offen  lds
  s_add_u32 s16, s16, -2719744
  s_xor_b32 s18, s18, 65536
  v_exp_f32 v5, v5
  s_waitcnt lgkmcnt(4)
  v_mfma_f32_16x16x32_bf16 v[220:223], a[12:15], a[76:79], v[220:223]
  ds_read_b64_tr_b16 a[8:9], v1 offset:7360
  ds_read_b64_tr_b16 a[10:11], v1 offset:9152
  v_mfma_f32_16x16x32_bf16 v[216:219], a[12:15], a[72:75], v[216:219]
  v_fmac_f32 v59, v31, v14
  v_mfma_f32_16x16x32_bf16 v[212:215], a[12:15], a[68:71], v[212:215]
  v_fma_f32 v2, v2, v22, v22
  v_mfma_f32_16x16x32_bf16 v[208:211], a[12:15], a[64:67], v[208:211]
  v_fma_f32 v3, v3, v22, v22
  s_waitcnt lgkmcnt(4)
  v_mfma_f32_16x16x32_bf16 v[224:227], a[0:3], a[16:19], v[224:227]
  ds_read_b64_tr_b16 a[12:13], v1 offset:21696
  ds_read_b64_tr_b16 a[14:15], v1 offset:23488
  v_mfma_f32_16x16x32_bf16 v[228:231], a[0:3], a[20:23], v[228:231]
  v_fma_f32 v4, v4, v22, v22
  v_mfma_f32_16x16x32_bf16 v[232:235], a[0:3], a[24:27], v[232:235]
  v_fma_f32 v5, v5, v22, v22
  v_mfma_f32_16x16x32_bf16 v[236:239], a[0:3], a[28:31], v[236:239]
  v_rcp_f32 v2, v2
  s_waitcnt lgkmcnt(4)
  v_mfma_f32_16x16x32_bf16 v[252:255], a[4:7], a[28:31], v[252:255]
  ds_read_b64_tr_b16 a[0:1], v1 offset:28864
  ds_read_b64_tr_b16 a[2:3], v1 offset:30656
  v_mfma_f32_16x16x32_bf16 v[248:251], a[4:7], a[24:27], v[248:251]
  v_mul_f32 v40, v40, v56
  v_mfma_f32_16x16x32_bf16 v[244:247], a[4:7], a[20:23], v[244:247]
  v_rcp_f32 v3, v3
  v_mfma_f32_16x16x32_bf16 v[240:243], a[4:7], a[16:19], v[240:243]
  v_mul_f32 v41, v41, v57
  s_waitcnt lgkmcnt(4)
  v_mfma_f32_16x16x32_bf16 v[224:227], a[8:11], a[32:35], v[224:227]
  ds_read_b64_tr_b16 a[4:5], v1 offset:43200
  ds_read_b64_tr_b16 a[6:7], v1 offset:44992
  v_mfma_f32_16x16x32_bf16 v[228:231], a[8:11], a[36:39], v[228:231]
  v_rcp_f32 v4, v4
  v_mfma_f32_16x16x32_bf16 v[232:235], a[8:11], a[40:43], v[232:235]
  v_mul_f32 v42, v42, v58
  v_mfma_f32_16x16x32_bf16 v[236:239], a[8:11], a[44:47], v[236:239]
  v_rcp_f32 v5, v5
  s_waitcnt lgkmcnt(4)
  v_mfma_f32_16x16x32_bf16 v[252:255], a[12:15], a[44:47], v[252:255]
  ds_read_b64_tr_b16 a[8:9], v1 offset:36032
  ds_read_b64_tr_b16 a[10:11], v1 offset:37824
  v_mfma_f32_16x16x32_bf16 v[248:251], a[12:15], a[40:43], v[248:251]
  v_mul_f32 v43, v43, v59
  v_mfma_f32_16x16x32_bf16 v[244:247], a[12:15], a[36:39], v[244:247]
  v_mul_f32 v40, v40, v2
  v_mfma_f32_16x16x32_bf16 v[240:243], a[12:15], a[32:35], v[240:243]
  v_mul_f32 v41, v41, v3
  s_waitcnt lgkmcnt(4)
  v_mfma_f32_16x16x32_bf16 v[224:227], a[0:3], a[48:51], v[224:227]
  ds_read_b64_tr_b16 a[12:13], v1 offset:50368
  ds_read_b64_tr_b16 a[14:15], v1 offset:52160
  v_mfma_f32_16x16x32_bf16 v[228:231], a[0:3], a[52:55], v[228:231]
  v_mul_f32 v42, v42, v4
  v_mfma_f32_16x16x32_bf16 v[232:235], a[0:3], a[56:59], v[232:235]
  v_mul_f32 v43, v43, v5
  v_mfma_f32_16x16x32_bf16 v[236:239], a[0:3], a[60:63], v[236:239]
  v_cvt_pk_bf16_f32 v43, v42, v43
  s_waitcnt lgkmcnt(4)
  v_mfma_f32_16x16x32_bf16 v[252:255], a[4:7], a[60:63], v[252:255]
  v_mfma_f32_16x16x32_bf16 v[248:251], a[4:7], a[56:59], v[248:251]
  v_cvt_pk_bf16_f32 v42, v40, v41
  v_mfma_f32_16x16x32_bf16 v[244:247], a[4:7], a[52:55], v[244:247]
  v_fmac_f32 v44, v24, v15
  v_mfma_f32_16x16x32_bf16 v[240:243], a[4:7], a[48:51], v[240:243]
  v_fmac_f32 v45, v25, v15
  s_waitcnt lgkmcnt(2)
  v_mfma_f32_16x16x32_bf16 v[224:227], a[8:11], a[64:67], v[224:227]
  v_mfma_f32_16x16x32_bf16 v[228:231], a[8:11], a[68:71], v[228:231]
  v_fmac_f32 v46, v26, v15
  v_mfma_f32_16x16x32_bf16 v[232:235], a[8:11], a[72:75], v[232:235]
  v_fmac_f32 v47, v27, v15
  v_mfma_f32_16x16x32_bf16 v[236:239], a[8:11], a[76:79], v[236:239]
  v_mul_f32 v2, v44, v19
  s_waitcnt lgkmcnt(0)
  v_mfma_f32_16x16x32_bf16 v[252:255], a[12:15], a[76:79], v[252:255]
  v_mfma_f32_16x16x32_bf16 v[248:251], a[12:15], a[72:75], v[248:251]
  v_mul_f32 v3, v45, v19
  v_mfma_f32_16x16x32_bf16 v[244:247], a[12:15], a[68:71], v[244:247]
  v_mul_f32 v4, v46, v19
  v_mfma_f32_16x16x32_bf16 v[240:243], a[12:15], a[64:67], v[240:243]
  v_mul_f32 v5, v47, v19
  s_nop 7
  v_exp_f32 v2, v2
  v_fmac_f32 v60, v28, v15
  v_exp_f32 v3, v3
  v_fmac_f32 v61, v29, v15
  v_exp_f32 v4, v4
  v_fmac_f32 v62, v30, v15
  v_exp_f32 v5, v5
  v_fmac_f32 v63, v31, v15
  v_fma_f32 v2, v2, v23, v23
  v_fma_f32 v3, v3, v23, v23
  v_fma_f32 v4, v4, v23, v23
  v_fma_f32 v5, v5, v23, v23
  v_rcp_f32 v2, v2
  v_mul_f32 v44, v44, v60
  v_rcp_f32 v3, v3
  v_mul_f32 v45, v45, v61
  v_rcp_f32 v4, v4
  v_mul_f32 v46, v46, v62
  v_rcp_f32 v5, v5
  v_mul_f32 v47, v47, v63
  v_mul_f32 v44, v44, v2
  v_mul_f32 v45, v45, v3
  v_mul_f32 v46, v46, v4
  v_mul_f32 v47, v47, v5
  v_cvt_pk_bf16_f32 v44, v44, v45
  v_cvt_pk_bf16_f32 v45, v46, v47
  s_nop 1
  v_permlane16_swap_b32 v42, v44
  v_permlane16_swap_b32 v43, v45
  buffer_store_dwordx4 v[42:45], v10, s[12:15], s73 offen offset:512 sc1
  s_add_u32 s73, s73, 65536
  v_and_b32 v60, 63, v0
  v_lshrrev_b32 v61, 4, v60
  v_and_b32 v56, 1, v61
  v_and_b32 v63, 15, v60
  v_add_u32 v63, s3, v63
  v_lshrrev_b32 v57, 1, v61
  v_mul_u32_u24 v58, 14, v57
  v_add_lshl_u32 v58, v58, v56, 11
  v_add_lshl_u32 v24, v58, v63, 4
  v_lshlrev_b32 v57, 11, v61
  v_add_lshl_u32 v25, v57, v63, 4
  v_and_b32 v26, 3, v63
  v_bfe_u32 v57, v63, 6, 2
  v_lshl_or_b32 v26, v57, 2, v26
  v_bfe_u32 v57, v63, 5, 1
  v_lshl_or_b32 v26, v57, 4, v26
  v_bfe_u32 v57, v63, 2, 3
  v_lshl_or_b32 v26, v57, 5, v26
  v_bfe_u32 v57, v63, 9, 2
  v_lshl_or_b32 v26, v57, 8, v26
  v_bfe_u32 v57, v63, 8, 1
  v_lshl_or_b32 v26, v57, 10, v26
  v_lshlrev_b32 v26, 11, v26
  v_lshl_add_u32 v26, v61, 4, v26
  v_lshlrev_b32 v27, 4, v60
  v_bfe_u32 v57, v60, 2, 2
  v_lshl_add_u32 v58, v61, 3, v57
  v_lshlrev_b32 v58, 8, v58
  v_and_b32 v59, 1, v57
  v_and_b32 v57, 2, v57
  v_lshl_add_u32 v59, v57, 1, v59
  v_xor_b32 v56, s53, v56
  v_lshl_add_u32 v59, v56, 3, v59
  v_and_b32 v57, 2, v60
  v_or_b32 v59, v59, v57
  v_lshl_add_u32 v58, v59, 4, v58
  v_and_b32 v57, 1, v60
  v_lshl_add_u32 v32, v57, 3, v58
  v_add_u32 v32, 65536, v32
  v_xor_b32 v33, 16, v32
  v_xor_b32 v34, 64, v32
  v_xor_b32 v35, 80, v32
  v_xor_b32 v36, 128, v32
  v_xor_b32 v37, 144, v32
  v_xor_b32 v38, 192, v32
  v_xor_b32 v39, 208, v32
  v_mov_b32 v60, 0
  v_mov_b32 v61, 1
  v_pk_fma_f32 v[64:65], v[48:49], v[12:13], v[64:65] op_sel:[0,0,0] op_sel_hi:[1,0,1]
  v_pk_fma_f32 v[66:67], v[50:51], v[12:13], v[66:67] op_sel:[0,0,0] op_sel_hi:[1,0,1]
  v_pk_mul_f32 v[2:3], v[64:65], v[16:17] op_sel:[0,0] op_sel_hi:[1,0]
  v_pk_mul_f32 v[4:5], v[66:67], v[16:17] op_sel:[0,0] op_sel_hi:[1,0]
  v_exp_f32 v2, v2
  v_exp_f32 v3, v3
  v_exp_f32 v4, v4
  v_exp_f32 v5, v5
  v_pk_fma_f32 v[80:81], v[52:53], v[12:13], v[80:81] op_sel:[0,0,0] op_sel_hi:[1,0,1]
  v_pk_fma_f32 v[82:83], v[54:55], v[12:13], v[82:83] op_sel:[0,0,0] op_sel_hi:[1,0,1]
  v_pk_fma_f32 v[2:3], v[2:3], v[20:21], v[20:21] op_sel:[0,0,0] op_sel_hi:[1,0,0]
  v_pk_fma_f32 v[4:5], v[4:5], v[20:21], v[20:21] op_sel:[0,0,0] op_sel_hi:[1,0,0]
  v_rcp_f32 v2, v2
  v_rcp_f32 v3, v3
  v_rcp_f32 v4, v4
  v_rcp_f32 v5, v5
  v_pk_mul_f32 v[64:65], v[64:65], v[80:81]
  v_pk_mul_f32 v[66:67], v[66:67], v[82:83]
  v_pk_mul_f32 v[64:65], v[64:65], v[2:3]
  v_pk_mul_f32 v[66:67], v[66:67], v[4:5]
  v_cvt_pk_bf16_f32 v67, v66, v67
  v_cvt_pk_bf16_f32 v66, v64, v65
  ds_read_b128 v[80:83], v11 offset:128
  v_pk_fma_f32 v[68:69], v[48:49], v[12:13], v[68:69] op_sel:[0,1,0] op_sel_hi:[1,1,1]
  v_pk_fma_f32 v[70:71], v[50:51], v[12:13], v[70:71] op_sel:[0,1,0] op_sel_hi:[1,1,1]
  v_pk_mul_f32 v[2:3], v[68:69], v[16:17] op_sel:[0,1] op_sel_hi:[1,1]
  v_pk_mul_f32 v[4:5], v[70:71], v[16:17] op_sel:[0,1] op_sel_hi:[1,1]
  v_exp_f32 v2, v2
  v_exp_f32 v3, v3
  v_exp_f32 v4, v4
  v_exp_f32 v5, v5
  v_pk_fma_f32 v[84:85], v[52:53], v[12:13], v[84:85] op_sel:[0,1,0] op_sel_hi:[1,1,1]
  v_pk_fma_f32 v[86:87], v[54:55], v[12:13], v[86:87] op_sel:[0,1,0] op_sel_hi:[1,1,1]
  v_pk_fma_f32 v[2:3], v[2:3], v[20:21], v[20:21] op_sel:[0,1,1] op_sel_hi:[1,1,1]
  v_pk_fma_f32 v[4:5], v[4:5], v[20:21], v[20:21] op_sel:[0,1,1] op_sel_hi:[1,1,1]
  v_rcp_f32 v2, v2
  v_rcp_f32 v3, v3
  v_rcp_f32 v4, v4
  v_rcp_f32 v5, v5
  v_pk_mul_f32 v[68:69], v[68:69], v[84:85]
  v_pk_mul_f32 v[70:71], v[70:71], v[86:87]
  v_pk_mul_f32 v[68:69], v[68:69], v[2:3]
  v_pk_mul_f32 v[70:71], v[70:71], v[4:5]
  v_cvt_pk_bf16_f32 v68, v68, v69
  v_cvt_pk_bf16_f32 v69, v70, v71
  ds_read_b128 v[84:87], v11 offset:576
  v_pk_fma_f32 v[72:73], v[48:49], v[14:15], v[72:73] op_sel:[0,0,0] op_sel_hi:[1,0,1]
  v_pk_fma_f32 v[74:75], v[50:51], v[14:15], v[74:75] op_sel:[0,0,0] op_sel_hi:[1,0,1]
  v_permlane16_swap_b32 v66, v68
  v_permlane16_swap_b32 v67, v69
  buffer_store_dwordx4 v[66:69], v10, s[12:15], s73 offen offset:0 sc1
  v_pk_mul_f32 v[2:3], v[72:73], v[18:19] op_sel:[0,0] op_sel_hi:[1,0]
  v_pk_mul_f32 v[4:5], v[74:75], v[18:19] op_sel:[0,0] op_sel_hi:[1,0]
  v_exp_f32 v2, v2
  v_exp_f32 v3, v3
  v_exp_f32 v4, v4
  v_exp_f32 v5, v5
  v_pk_fma_f32 v[88:89], v[52:53], v[14:15], v[88:89] op_sel:[0,0,0] op_sel_hi:[1,0,1]
  v_pk_fma_f32 v[90:91], v[54:55], v[14:15], v[90:91] op_sel:[0,0,0] op_sel_hi:[1,0,1]
  v_pk_fma_f32 v[2:3], v[2:3], v[22:23], v[22:23] op_sel:[0,0,0] op_sel_hi:[1,0,0]
  v_pk_fma_f32 v[4:5], v[4:5], v[22:23], v[22:23] op_sel:[0,0,0] op_sel_hi:[1,0,0]
  v_rcp_f32 v2, v2
  v_rcp_f32 v3, v3
  v_rcp_f32 v4, v4
  v_rcp_f32 v5, v5
  v_pk_mul_f32 v[72:73], v[72:73], v[88:89]
  v_pk_mul_f32 v[74:75], v[74:75], v[90:91]
  v_pk_mul_f32 v[72:73], v[72:73], v[2:3]
  v_pk_mul_f32 v[74:75], v[74:75], v[4:5]
  v_cvt_pk_bf16_f32 v75, v74, v75
  v_cvt_pk_bf16_f32 v74, v72, v73
  v_pk_fma_f32 v[76:77], v[48:49], v[14:15], v[76:77] op_sel:[0,1,0] op_sel_hi:[1,1,1]
  v_pk_fma_f32 v[78:79], v[50:51], v[14:15], v[78:79] op_sel:[0,1,0] op_sel_hi:[1,1,1]
  v_pk_mul_f32 v[2:3], v[76:77], v[18:19] op_sel:[0,1] op_sel_hi:[1,1]
  v_pk_mul_f32 v[4:5], v[78:79], v[18:19] op_sel:[0,1] op_sel_hi:[1,1]
  v_exp_f32 v2, v2
  v_exp_f32 v3, v3
  v_exp_f32 v4, v4
  v_exp_f32 v5, v5
  v_pk_fma_f32 v[92:93], v[52:53], v[14:15], v[92:93] op_sel:[0,1,0] op_sel_hi:[1,1,1]
  v_pk_fma_f32 v[94:95], v[54:55], v[14:15], v[94:95] op_sel:[0,1,0] op_sel_hi:[1,1,1]
  v_pk_fma_f32 v[2:3], v[2:3], v[22:23], v[22:23] op_sel:[0,1,1] op_sel_hi:[1,1,1]
  v_pk_fma_f32 v[4:5], v[4:5], v[22:23], v[22:23] op_sel:[0,1,1] op_sel_hi:[1,1,1]
  v_rcp_f32 v2, v2
  v_rcp_f32 v3, v3
  v_rcp_f32 v4, v4
  v_rcp_f32 v5, v5
  v_pk_mul_f32 v[76:77], v[76:77], v[92:93]
  v_pk_mul_f32 v[78:79], v[78:79], v[94:95]
  v_pk_mul_f32 v[76:77], v[76:77], v[2:3]
  v_pk_mul_f32 v[78:79], v[78:79], v[4:5]
  v_cvt_pk_bf16_f32 v76, v76, v77
  v_cvt_pk_bf16_f32 v77, v78, v79
  s_nop 1
  v_permlane16_swap_b32 v74, v76
  v_permlane16_swap_b32 v75, v77
  buffer_store_dwordx4 v[74:77], v10, s[12:15], s73 offen offset:512 sc1
  s_add_u32 s73, s73, 65536
  s_waitcnt lgkmcnt(0)
  v_pk_fma_f32 v[96:97], v[80:81], v[12:13], v[96:97] op_sel:[0,0,0] op_sel_hi:[1,0,1]
  v_pk_fma_f32 v[98:99], v[82:83], v[12:13], v[98:99] op_sel:[0,0,0] op_sel_hi:[1,0,1]
  v_pk_mul_f32 v[2:3], v[96:97], v[16:17] op_sel:[0,0] op_sel_hi:[1,0]
  v_pk_mul_f32 v[4:5], v[98:99], v[16:17] op_sel:[0,0] op_sel_hi:[1,0]
  v_exp_f32 v2, v2
  v_exp_f32 v3, v3
  v_exp_f32 v4, v4
  v_exp_f32 v5, v5
  v_pk_fma_f32 v[112:113], v[84:85], v[12:13], v[112:113] op_sel:[0,0,0] op_sel_hi:[1,0,1]
  v_pk_fma_f32 v[114:115], v[86:87], v[12:13], v[114:115] op_sel:[0,0,0] op_sel_hi:[1,0,1]
  v_pk_fma_f32 v[2:3], v[2:3], v[20:21], v[20:21] op_sel:[0,0,0] op_sel_hi:[1,0,0]
  v_pk_fma_f32 v[4:5], v[4:5], v[20:21], v[20:21] op_sel:[0,0,0] op_sel_hi:[1,0,0]
  v_rcp_f32 v2, v2
  v_rcp_f32 v3, v3
  v_rcp_f32 v4, v4
  v_rcp_f32 v5, v5
  v_pk_mul_f32 v[96:97], v[96:97], v[112:113]
  v_pk_mul_f32 v[98:99], v[98:99], v[114:115]
  v_pk_mul_f32 v[96:97], v[96:97], v[2:3]
  v_pk_mul_f32 v[98:99], v[98:99], v[4:5]
  v_cvt_pk_bf16_f32 v99, v98, v99
  v_cvt_pk_bf16_f32 v98, v96, v97
  ds_read_b128 v[112:115], v11 offset:192
  v_pk_fma_f32 v[100:101], v[80:81], v[12:13], v[100:101] op_sel:[0,1,0] op_sel_hi:[1,1,1]
  v_pk_fma_f32 v[102:103], v[82:83], v[12:13], v[102:103] op_sel:[0,1,0] op_sel_hi:[1,1,1]
  v_pk_mul_f32 v[2:3], v[100:101], v[16:17] op_sel:[0,1] op_sel_hi:[1,1]
  v_pk_mul_f32 v[4:5], v[102:103], v[16:17] op_sel:[0,1] op_sel_hi:[1,1]
  v_exp_f32 v2, v2
  v_exp_f32 v3, v3
  v_exp_f32 v4, v4
  v_exp_f32 v5, v5
  v_pk_fma_f32 v[116:117], v[84:85], v[12:13], v[116:117] op_sel:[0,1,0] op_sel_hi:[1,1,1]
  v_pk_fma_f32 v[118:119], v[86:87], v[12:13], v[118:119] op_sel:[0,1,0] op_sel_hi:[1,1,1]
  v_pk_fma_f32 v[2:3], v[2:3], v[20:21], v[20:21] op_sel:[0,1,1] op_sel_hi:[1,1,1]
  v_pk_fma_f32 v[4:5], v[4:5], v[20:21], v[20:21] op_sel:[0,1,1] op_sel_hi:[1,1,1]
  v_rcp_f32 v2, v2
  v_rcp_f32 v3, v3
  v_rcp_f32 v4, v4
  v_rcp_f32 v5, v5
  v_pk_mul_f32 v[100:101], v[100:101], v[116:117]
  v_pk_mul_f32 v[102:103], v[102:103], v[118:119]
  v_pk_mul_f32 v[100:101], v[100:101], v[2:3]
  v_pk_mul_f32 v[102:103], v[102:103], v[4:5]
  v_cvt_pk_bf16_f32 v100, v100, v101
  v_cvt_pk_bf16_f32 v101, v102, v103
  ds_read_b128 v[116:119], v11 offset:640
  v_pk_fma_f32 v[104:105], v[80:81], v[14:15], v[104:105] op_sel:[0,0,0] op_sel_hi:[1,0,1]
  v_pk_fma_f32 v[106:107], v[82:83], v[14:15], v[106:107] op_sel:[0,0,0] op_sel_hi:[1,0,1]
  v_permlane16_swap_b32 v98, v100
  v_permlane16_swap_b32 v99, v101
  buffer_store_dwordx4 v[98:101], v10, s[12:15], s73 offen offset:0 sc1
  v_pk_mul_f32 v[2:3], v[104:105], v[18:19] op_sel:[0,0] op_sel_hi:[1,0]
  v_pk_mul_f32 v[4:5], v[106:107], v[18:19] op_sel:[0,0] op_sel_hi:[1,0]
  v_exp_f32 v2, v2
  v_exp_f32 v3, v3
  v_exp_f32 v4, v4
  v_exp_f32 v5, v5
  v_pk_fma_f32 v[120:121], v[84:85], v[14:15], v[120:121] op_sel:[0,0,0] op_sel_hi:[1,0,1]
  v_pk_fma_f32 v[122:123], v[86:87], v[14:15], v[122:123] op_sel:[0,0,0] op_sel_hi:[1,0,1]
  v_pk_fma_f32 v[2:3], v[2:3], v[22:23], v[22:23] op_sel:[0,0,0] op_sel_hi:[1,0,0]
  v_pk_fma_f32 v[4:5], v[4:5], v[22:23], v[22:23] op_sel:[0,0,0] op_sel_hi:[1,0,0]
  v_rcp_f32 v2, v2
  v_rcp_f32 v3, v3
  v_rcp_f32 v4, v4
  v_rcp_f32 v5, v5
  v_pk_mul_f32 v[104:105], v[104:105], v[120:121]
  v_pk_mul_f32 v[106:107], v[106:107], v[122:123]
  v_pk_mul_f32 v[104:105], v[104:105], v[2:3]
  v_pk_mul_f32 v[106:107], v[106:107], v[4:5]
  v_cvt_pk_bf16_f32 v107, v106, v107
  v_cvt_pk_bf16_f32 v106, v104, v105
  v_pk_fma_f32 v[108:109], v[80:81], v[14:15], v[108:109] op_sel:[0,1,0] op_sel_hi:[1,1,1]
  v_pk_fma_f32 v[110:111], v[82:83], v[14:15], v[110:111] op_sel:[0,1,0] op_sel_hi:[1,1,1]
  v_pk_mul_f32 v[2:3], v[108:109], v[18:19] op_sel:[0,1] op_sel_hi:[1,1]
  v_pk_mul_f32 v[4:5], v[110:111], v[18:19] op_sel:[0,1] op_sel_hi:[1,1]
  v_exp_f32 v2, v2
  v_exp_f32 v3, v3
  v_exp_f32 v4, v4
  v_exp_f32 v5, v5
  v_pk_fma_f32 v[124:125], v[84:85], v[14:15], v[124:125] op_sel:[0,1,0] op_sel_hi:[1,1,1]
  v_pk_fma_f32 v[126:127], v[86:87], v[14:15], v[126:127] op_sel:[0,1,0] op_sel_hi:[1,1,1]
  v_pk_fma_f32 v[2:3], v[2:3], v[22:23], v[22:23] op_sel:[0,1,1] op_sel_hi:[1,1,1]
  v_pk_fma_f32 v[4:5], v[4:5], v[22:23], v[22:23] op_sel:[0,1,1] op_sel_hi:[1,1,1]
  v_rcp_f32 v2, v2
  v_rcp_f32 v3, v3
  v_rcp_f32 v4, v4
  v_rcp_f32 v5, v5
  v_pk_mul_f32 v[108:109], v[108:109], v[124:125]
  v_pk_mul_f32 v[110:111], v[110:111], v[126:127]
  v_pk_mul_f32 v[108:109], v[108:109], v[2:3]
  v_pk_mul_f32 v[110:111], v[110:111], v[4:5]
  v_cvt_pk_bf16_f32 v108, v108, v109
  v_cvt_pk_bf16_f32 v109, v110, v111
  s_nop 1
  v_permlane16_swap_b32 v106, v108
  v_permlane16_swap_b32 v107, v109
  buffer_store_dwordx4 v[106:109], v10, s[12:15], s73 offen offset:512 sc1
  s_add_u32 s73, s73, 65536
  s_waitcnt lgkmcnt(0)
  v_pk_fma_f32 v[128:129], v[112:113], v[12:13], v[128:129] op_sel:[0,0,0] op_sel_hi:[1,0,1]
  v_pk_fma_f32 v[130:131], v[114:115], v[12:13], v[130:131] op_sel:[0,0,0] op_sel_hi:[1,0,1]
  v_pk_mul_f32 v[2:3], v[128:129], v[16:17] op_sel:[0,0] op_sel_hi:[1,0]
  v_pk_mul_f32 v[4:5], v[130:131], v[16:17] op_sel:[0,0] op_sel_hi:[1,0]
  v_exp_f32 v2, v2
  v_exp_f32 v3, v3
  v_exp_f32 v4, v4
  v_exp_f32 v5, v5
  v_pk_fma_f32 v[144:145], v[116:117], v[12:13], v[144:145] op_sel:[0,0,0] op_sel_hi:[1,0,1]
  v_pk_fma_f32 v[146:147], v[118:119], v[12:13], v[146:147] op_sel:[0,0,0] op_sel_hi:[1,0,1]
  v_pk_fma_f32 v[2:3], v[2:3], v[20:21], v[20:21] op_sel:[0,0,0] op_sel_hi:[1,0,0]
  v_pk_fma_f32 v[4:5], v[4:5], v[20:21], v[20:21] op_sel:[0,0,0] op_sel_hi:[1,0,0]
  v_rcp_f32 v2, v2
  v_rcp_f32 v3, v3
  v_rcp_f32 v4, v4
  v_rcp_f32 v5, v5
  v_pk_mul_f32 v[128:129], v[128:129], v[144:145]
  v_pk_mul_f32 v[130:131], v[130:131], v[146:147]
  v_pk_mul_f32 v[128:129], v[128:129], v[2:3]
  v_pk_mul_f32 v[130:131], v[130:131], v[4:5]
  v_cvt_pk_bf16_f32 v131, v130, v131
  v_cvt_pk_bf16_f32 v130, v128, v129
  ds_read_b128 v[144:147], v11 offset:256
  v_pk_fma_f32 v[132:133], v[112:113], v[12:13], v[132:133] op_sel:[0,1,0] op_sel_hi:[1,1,1]
  v_pk_fma_f32 v[134:135], v[114:115], v[12:13], v[134:135] op_sel:[0,1,0] op_sel_hi:[1,1,1]
  v_pk_mul_f32 v[2:3], v[132:133], v[16:17] op_sel:[0,1] op_sel_hi:[1,1]
  v_pk_mul_f32 v[4:5], v[134:135], v[16:17] op_sel:[0,1] op_sel_hi:[1,1]
  v_exp_f32 v2, v2
  v_exp_f32 v3, v3
  v_exp_f32 v4, v4
  v_exp_f32 v5, v5
  v_pk_fma_f32 v[148:149], v[116:117], v[12:13], v[148:149] op_sel:[0,1,0] op_sel_hi:[1,1,1]
  v_pk_fma_f32 v[150:151], v[118:119], v[12:13], v[150:151] op_sel:[0,1,0] op_sel_hi:[1,1,1]
  v_pk_fma_f32 v[2:3], v[2:3], v[20:21], v[20:21] op_sel:[0,1,1] op_sel_hi:[1,1,1]
  v_pk_fma_f32 v[4:5], v[4:5], v[20:21], v[20:21] op_sel:[0,1,1] op_sel_hi:[1,1,1]
  v_rcp_f32 v2, v2
  v_rcp_f32 v3, v3
  v_rcp_f32 v4, v4
  v_rcp_f32 v5, v5
  v_pk_mul_f32 v[132:133], v[132:133], v[148:149]
  v_pk_mul_f32 v[134:135], v[134:135], v[150:151]
  v_pk_mul_f32 v[132:133], v[132:133], v[2:3]
  v_pk_mul_f32 v[134:135], v[134:135], v[4:5]
  v_cvt_pk_bf16_f32 v132, v132, v133
  v_cvt_pk_bf16_f32 v133, v134, v135
  ds_read_b128 v[148:151], v11 offset:704
  v_pk_fma_f32 v[136:137], v[112:113], v[14:15], v[136:137] op_sel:[0,0,0] op_sel_hi:[1,0,1]
  v_pk_fma_f32 v[138:139], v[114:115], v[14:15], v[138:139] op_sel:[0,0,0] op_sel_hi:[1,0,1]
  v_permlane16_swap_b32 v130, v132
  v_permlane16_swap_b32 v131, v133
  buffer_store_dwordx4 v[130:133], v10, s[12:15], s73 offen offset:0 sc1
  v_pk_mul_f32 v[2:3], v[136:137], v[18:19] op_sel:[0,0] op_sel_hi:[1,0]
  v_pk_mul_f32 v[4:5], v[138:139], v[18:19] op_sel:[0,0] op_sel_hi:[1,0]
  v_exp_f32 v2, v2
  v_exp_f32 v3, v3
  v_exp_f32 v4, v4
  v_exp_f32 v5, v5
  v_pk_fma_f32 v[152:153], v[116:117], v[14:15], v[152:153] op_sel:[0,0,0] op_sel_hi:[1,0,1]
  v_pk_fma_f32 v[154:155], v[118:119], v[14:15], v[154:155] op_sel:[0,0,0] op_sel_hi:[1,0,1]
  v_pk_fma_f32 v[2:3], v[2:3], v[22:23], v[22:23] op_sel:[0,0,0] op_sel_hi:[1,0,0]
  v_pk_fma_f32 v[4:5], v[4:5], v[22:23], v[22:23] op_sel:[0,0,0] op_sel_hi:[1,0,0]
  v_rcp_f32 v2, v2
  v_rcp_f32 v3, v3
  v_rcp_f32 v4, v4
  v_rcp_f32 v5, v5
  v_pk_mul_f32 v[136:137], v[136:137], v[152:153]
  v_pk_mul_f32 v[138:139], v[138:139], v[154:155]
  v_pk_mul_f32 v[136:137], v[136:137], v[2:3]
  v_pk_mul_f32 v[138:139], v[138:139], v[4:5]
  v_cvt_pk_bf16_f32 v139, v138, v139
  v_cvt_pk_bf16_f32 v138, v136, v137
  v_pk_fma_f32 v[140:141], v[112:113], v[14:15], v[140:141] op_sel:[0,1,0] op_sel_hi:[1,1,1]
  v_pk_fma_f32 v[142:143], v[114:115], v[14:15], v[142:143] op_sel:[0,1,0] op_sel_hi:[1,1,1]
  v_pk_mul_f32 v[2:3], v[140:141], v[18:19] op_sel:[0,1] op_sel_hi:[1,1]
  v_pk_mul_f32 v[4:5], v[142:143], v[18:19] op_sel:[0,1] op_sel_hi:[1,1]
  v_exp_f32 v2, v2
  v_exp_f32 v3, v3
  v_exp_f32 v4, v4
  v_exp_f32 v5, v5
  v_pk_fma_f32 v[156:157], v[116:117], v[14:15], v[156:157] op_sel:[0,1,0] op_sel_hi:[1,1,1]
  v_pk_fma_f32 v[158:159], v[118:119], v[14:15], v[158:159] op_sel:[0,1,0] op_sel_hi:[1,1,1]
  v_pk_fma_f32 v[2:3], v[2:3], v[22:23], v[22:23] op_sel:[0,1,1] op_sel_hi:[1,1,1]
  v_pk_fma_f32 v[4:5], v[4:5], v[22:23], v[22:23] op_sel:[0,1,1] op_sel_hi:[1,1,1]
  v_rcp_f32 v2, v2
  v_rcp_f32 v3, v3
  v_rcp_f32 v4, v4
  v_rcp_f32 v5, v5
  v_pk_mul_f32 v[140:141], v[140:141], v[156:157]
  v_pk_mul_f32 v[142:143], v[142:143], v[158:159]
  v_pk_mul_f32 v[140:141], v[140:141], v[2:3]
  v_pk_mul_f32 v[142:143], v[142:143], v[4:5]
  v_cvt_pk_bf16_f32 v140, v140, v141
  v_cvt_pk_bf16_f32 v141, v142, v143
  s_nop 1
  v_permlane16_swap_b32 v138, v140
  v_permlane16_swap_b32 v139, v141
  buffer_store_dwordx4 v[138:141], v10, s[12:15], s73 offen offset:512 sc1
  s_add_u32 s73, s73, 65536
  s_waitcnt vmcnt(2)
  s_barrier
  s_mov_b64 exec, 1
  buffer_atomic_add v61, v60, s[60:63], s52 offen offset:0 sc1
  s_mov_b64 exec, -1
  s_waitcnt lgkmcnt(0)
  v_pk_fma_f32 v[160:161], v[144:145], v[12:13], v[160:161] op_sel:[0,0,0] op_sel_hi:[1,0,1]
  v_pk_fma_f32 v[162:163], v[146:147], v[12:13], v[162:163] op_sel:[0,0,0] op_sel_hi:[1,0,1]
  v_pk_mul_f32 v[2:3], v[160:161], v[16:17] op_sel:[0,0] op_sel_hi:[1,0]
  v_pk_mul_f32 v[4:5], v[162:163], v[16:17] op_sel:[0,0] op_sel_hi:[1,0]
  v_exp_f32 v2, v2
  v_exp_f32 v3, v3
  v_exp_f32 v4, v4
  v_exp_f32 v5, v5
  v_pk_fma_f32 v[176:177], v[148:149], v[12:13], v[176:177] op_sel:[0,0,0] op_sel_hi:[1,0,1]
  v_pk_fma_f32 v[178:179], v[150:151], v[12:13], v[178:179] op_sel:[0,0,0] op_sel_hi:[1,0,1]
  v_pk_fma_f32 v[2:3], v[2:3], v[20:21], v[20:21] op_sel:[0,0,0] op_sel_hi:[1,0,0]
  v_pk_fma_f32 v[4:5], v[4:5], v[20:21], v[20:21] op_sel:[0,0,0] op_sel_hi:[1,0,0]
  v_rcp_f32 v2, v2
  v_rcp_f32 v3, v3
  v_rcp_f32 v4, v4
  v_rcp_f32 v5, v5
  v_pk_mul_f32 v[160:161], v[160:161], v[176:177]
  v_pk_mul_f32 v[162:163], v[162:163], v[178:179]
  v_pk_mul_f32 v[160:161], v[160:161], v[2:3]
  v_pk_mul_f32 v[162:163], v[162:163], v[4:5]
  v_cvt_pk_bf16_f32 v163, v162, v163
  v_cvt_pk_bf16_f32 v162, v160, v161
  ds_read_b128 v[176:179], v11 offset:320
  v_pk_fma_f32 v[164:165], v[144:145], v[12:13], v[164:165] op_sel:[0,1,0] op_sel_hi:[1,1,1]
  v_pk_fma_f32 v[166:167], v[146:147], v[12:13], v[166:167] op_sel:[0,1,0] op_sel_hi:[1,1,1]
  v_pk_mul_f32 v[2:3], v[164:165], v[16:17] op_sel:[0,1] op_sel_hi:[1,1]
  v_pk_mul_f32 v[4:5], v[166:167], v[16:17] op_sel:[0,1] op_sel_hi:[1,1]
  v_exp_f32 v2, v2
  v_exp_f32 v3, v3
  v_exp_f32 v4, v4
  v_exp_f32 v5, v5
  v_pk_fma_f32 v[180:181], v[148:149], v[12:13], v[180:181] op_sel:[0,1,0] op_sel_hi:[1,1,1]
  v_pk_fma_f32 v[182:183], v[150:151], v[12:13], v[182:183] op_sel:[0,1,0] op_sel_hi:[1,1,1]
  v_pk_fma_f32 v[2:3], v[2:3], v[20:21], v[20:21] op_sel:[0,1,1] op_sel_hi:[1,1,1]
  v_pk_fma_f32 v[4:5], v[4:5], v[20:21], v[20:21] op_sel:[0,1,1] op_sel_hi:[1,1,1]
  v_rcp_f32 v2, v2
  v_rcp_f32 v3, v3
  v_rcp_f32 v4, v4
  v_rcp_f32 v5, v5
  v_pk_mul_f32 v[164:165], v[164:165], v[180:181]
  v_pk_mul_f32 v[166:167], v[166:167], v[182:183]
  v_pk_mul_f32 v[164:165], v[164:165], v[2:3]
  v_pk_mul_f32 v[166:167], v[166:167], v[4:5]
  v_cvt_pk_bf16_f32 v164, v164, v165
  v_cvt_pk_bf16_f32 v165, v166, v167
  ds_read_b128 v[180:183], v11 offset:768
  v_pk_fma_f32 v[168:169], v[144:145], v[14:15], v[168:169] op_sel:[0,0,0] op_sel_hi:[1,0,1]
  v_pk_fma_f32 v[170:171], v[146:147], v[14:15], v[170:171] op_sel:[0,0,0] op_sel_hi:[1,0,1]
  v_permlane16_swap_b32 v162, v164
  v_permlane16_swap_b32 v163, v165
  buffer_store_dwordx4 v[162:165], v10, s[12:15], s73 offen offset:0 sc1
  v_pk_mul_f32 v[2:3], v[168:169], v[18:19] op_sel:[0,0] op_sel_hi:[1,0]
  v_pk_mul_f32 v[4:5], v[170:171], v[18:19] op_sel:[0,0] op_sel_hi:[1,0]
  v_exp_f32 v2, v2
  v_exp_f32 v3, v3
  v_exp_f32 v4, v4
  v_exp_f32 v5, v5
  v_pk_fma_f32 v[184:185], v[148:149], v[14:15], v[184:185] op_sel:[0,0,0] op_sel_hi:[1,0,1]
  v_pk_fma_f32 v[186:187], v[150:151], v[14:15], v[186:187] op_sel:[0,0,0] op_sel_hi:[1,0,1]
  v_pk_fma_f32 v[2:3], v[2:3], v[22:23], v[22:23] op_sel:[0,0,0] op_sel_hi:[1,0,0]
  v_pk_fma_f32 v[4:5], v[4:5], v[22:23], v[22:23] op_sel:[0,0,0] op_sel_hi:[1,0,0]
  v_rcp_f32 v2, v2
  v_rcp_f32 v3, v3
  v_rcp_f32 v4, v4
  v_rcp_f32 v5, v5
  v_pk_mul_f32 v[168:169], v[168:169], v[184:185]
  v_pk_mul_f32 v[170:171], v[170:171], v[186:187]
  v_pk_mul_f32 v[168:169], v[168:169], v[2:3]
  v_pk_mul_f32 v[170:171], v[170:171], v[4:5]
  v_cvt_pk_bf16_f32 v171, v170, v171
  v_cvt_pk_bf16_f32 v170, v168, v169
  v_pk_fma_f32 v[172:173], v[144:145], v[14:15], v[172:173] op_sel:[0,1,0] op_sel_hi:[1,1,1]
  v_pk_fma_f32 v[174:175], v[146:147], v[14:15], v[174:175] op_sel:[0,1,0] op_sel_hi:[1,1,1]
  v_pk_mul_f32 v[2:3], v[172:173], v[18:19] op_sel:[0,1] op_sel_hi:[1,1]
  v_pk_mul_f32 v[4:5], v[174:175], v[18:19] op_sel:[0,1] op_sel_hi:[1,1]
  v_exp_f32 v2, v2
  v_exp_f32 v3, v3
  v_exp_f32 v4, v4
  v_exp_f32 v5, v5
  v_pk_fma_f32 v[188:189], v[148:149], v[14:15], v[188:189] op_sel:[0,1,0] op_sel_hi:[1,1,1]
  v_pk_fma_f32 v[190:191], v[150:151], v[14:15], v[190:191] op_sel:[0,1,0] op_sel_hi:[1,1,1]
  v_pk_fma_f32 v[2:3], v[2:3], v[22:23], v[22:23] op_sel:[0,1,1] op_sel_hi:[1,1,1]
  v_pk_fma_f32 v[4:5], v[4:5], v[22:23], v[22:23] op_sel:[0,1,1] op_sel_hi:[1,1,1]
  v_rcp_f32 v2, v2
  v_rcp_f32 v3, v3
  v_rcp_f32 v4, v4
  v_rcp_f32 v5, v5
  v_pk_mul_f32 v[172:173], v[172:173], v[188:189]
  v_pk_mul_f32 v[174:175], v[174:175], v[190:191]
  v_pk_mul_f32 v[172:173], v[172:173], v[2:3]
  v_pk_mul_f32 v[174:175], v[174:175], v[4:5]
  v_cvt_pk_bf16_f32 v172, v172, v173
  v_cvt_pk_bf16_f32 v173, v174, v175
  s_nop 1
  v_permlane16_swap_b32 v170, v172
  v_permlane16_swap_b32 v171, v173
  buffer_store_dwordx4 v[170:173], v10, s[12:15], s73 offen offset:512 sc1
  s_add_u32 s73, s73, 65536
  s_waitcnt lgkmcnt(0)
  v_pk_fma_f32 v[192:193], v[176:177], v[12:13], v[192:193] op_sel:[0,0,0] op_sel_hi:[1,0,1]
  v_pk_fma_f32 v[194:195], v[178:179], v[12:13], v[194:195] op_sel:[0,0,0] op_sel_hi:[1,0,1]
  v_pk_mul_f32 v[2:3], v[192:193], v[16:17] op_sel:[0,0] op_sel_hi:[1,0]
  v_pk_mul_f32 v[4:5], v[194:195], v[16:17] op_sel:[0,0] op_sel_hi:[1,0]
  v_exp_f32 v2, v2
  v_exp_f32 v3, v3
  v_exp_f32 v4, v4
  v_exp_f32 v5, v5
  v_pk_fma_f32 v[208:209], v[180:181], v[12:13], v[208:209] op_sel:[0,0,0] op_sel_hi:[1,0,1]
  v_pk_fma_f32 v[210:211], v[182:183], v[12:13], v[210:211] op_sel:[0,0,0] op_sel_hi:[1,0,1]
  v_pk_fma_f32 v[2:3], v[2:3], v[20:21], v[20:21] op_sel:[0,0,0] op_sel_hi:[1,0,0]
  v_pk_fma_f32 v[4:5], v[4:5], v[20:21], v[20:21] op_sel:[0,0,0] op_sel_hi:[1,0,0]
  v_rcp_f32 v2, v2
  v_rcp_f32 v3, v3
  v_rcp_f32 v4, v4
  v_rcp_f32 v5, v5
  v_pk_mul_f32 v[192:193], v[192:193], v[208:209]
  v_pk_mul_f32 v[194:195], v[194:195], v[210:211]
  v_pk_mul_f32 v[192:193], v[192:193], v[2:3]
  v_pk_mul_f32 v[194:195], v[194:195], v[4:5]
  v_cvt_pk_bf16_f32 v195, v194, v195
  v_cvt_pk_bf16_f32 v194, v192, v193
  ds_read_b128 v[208:211], v11 offset:384
  v_pk_fma_f32 v[196:197], v[176:177], v[12:13], v[196:197] op_sel:[0,1,0] op_sel_hi:[1,1,1]
  v_pk_fma_f32 v[198:199], v[178:179], v[12:13], v[198:199] op_sel:[0,1,0] op_sel_hi:[1,1,1]
  v_pk_mul_f32 v[2:3], v[196:197], v[16:17] op_sel:[0,1] op_sel_hi:[1,1]
  v_pk_mul_f32 v[4:5], v[198:199], v[16:17] op_sel:[0,1] op_sel_hi:[1,1]
  v_exp_f32 v2, v2
  v_exp_f32 v3, v3
  v_exp_f32 v4, v4
  v_exp_f32 v5, v5
  v_pk_fma_f32 v[212:213], v[180:181], v[12:13], v[212:213] op_sel:[0,1,0] op_sel_hi:[1,1,1]
  v_pk_fma_f32 v[214:215], v[182:183], v[12:13], v[214:215] op_sel:[0,1,0] op_sel_hi:[1,1,1]
  v_pk_fma_f32 v[2:3], v[2:3], v[20:21], v[20:21] op_sel:[0,1,1] op_sel_hi:[1,1,1]
  v_pk_fma_f32 v[4:5], v[4:5], v[20:21], v[20:21] op_sel:[0,1,1] op_sel_hi:[1,1,1]
  v_rcp_f32 v2, v2
  v_rcp_f32 v3, v3
  v_rcp_f32 v4, v4
  v_rcp_f32 v5, v5
  v_pk_mul_f32 v[196:197], v[196:197], v[212:213]
  v_pk_mul_f32 v[198:199], v[198:199], v[214:215]
  v_pk_mul_f32 v[196:197], v[196:197], v[2:3]
  v_pk_mul_f32 v[198:199], v[198:199], v[4:5]
  v_cvt_pk_bf16_f32 v196, v196, v197
  v_cvt_pk_bf16_f32 v197, v198, v199
  ds_read_b128 v[212:215], v11 offset:832
  v_pk_fma_f32 v[200:201], v[176:177], v[14:15], v[200:201] op_sel:[0,0,0] op_sel_hi:[1,0,1]
  v_pk_fma_f32 v[202:203], v[178:179], v[14:15], v[202:203] op_sel:[0,0,0] op_sel_hi:[1,0,1]
  v_permlane16_swap_b32 v194, v196
  v_permlane16_swap_b32 v195, v197
  buffer_store_dwordx4 v[194:197], v10, s[12:15], s73 offen offset:0 sc1
  v_pk_mul_f32 v[2:3], v[200:201], v[18:19] op_sel:[0,0] op_sel_hi:[1,0]
  v_pk_mul_f32 v[4:5], v[202:203], v[18:19] op_sel:[0,0] op_sel_hi:[1,0]
  v_exp_f32 v2, v2
  v_exp_f32 v3, v3
  v_exp_f32 v4, v4
  v_exp_f32 v5, v5
  v_pk_fma_f32 v[216:217], v[180:181], v[14:15], v[216:217] op_sel:[0,0,0] op_sel_hi:[1,0,1]
  v_pk_fma_f32 v[218:219], v[182:183], v[14:15], v[218:219] op_sel:[0,0,0] op_sel_hi:[1,0,1]
  v_pk_fma_f32 v[2:3], v[2:3], v[22:23], v[22:23] op_sel:[0,0,0] op_sel_hi:[1,0,0]
  v_pk_fma_f32 v[4:5], v[4:5], v[22:23], v[22:23] op_sel:[0,0,0] op_sel_hi:[1,0,0]
  v_rcp_f32 v2, v2
  v_rcp_f32 v3, v3
  v_rcp_f32 v4, v4
  v_rcp_f32 v5, v5
  v_pk_mul_f32 v[200:201], v[200:201], v[216:217]
  v_pk_mul_f32 v[202:203], v[202:203], v[218:219]
  v_pk_mul_f32 v[200:201], v[200:201], v[2:3]
  v_pk_mul_f32 v[202:203], v[202:203], v[4:5]
  v_cvt_pk_bf16_f32 v203, v202, v203
  v_cvt_pk_bf16_f32 v202, v200, v201
  v_pk_fma_f32 v[204:205], v[176:177], v[14:15], v[204:205] op_sel:[0,1,0] op_sel_hi:[1,1,1]
  v_pk_fma_f32 v[206:207], v[178:179], v[14:15], v[206:207] op_sel:[0,1,0] op_sel_hi:[1,1,1]
  v_pk_mul_f32 v[2:3], v[204:205], v[18:19] op_sel:[0,1] op_sel_hi:[1,1]
  v_pk_mul_f32 v[4:5], v[206:207], v[18:19] op_sel:[0,1] op_sel_hi:[1,1]
  v_exp_f32 v2, v2
  v_exp_f32 v3, v3
  v_exp_f32 v4, v4
  v_exp_f32 v5, v5
  v_pk_fma_f32 v[220:221], v[180:181], v[14:15], v[220:221] op_sel:[0,1,0] op_sel_hi:[1,1,1]
  v_pk_fma_f32 v[222:223], v[182:183], v[14:15], v[222:223] op_sel:[0,1,0] op_sel_hi:[1,1,1]
  v_pk_fma_f32 v[2:3], v[2:3], v[22:23], v[22:23] op_sel:[0,1,1] op_sel_hi:[1,1,1]
  v_pk_fma_f32 v[4:5], v[4:5], v[22:23], v[22:23] op_sel:[0,1,1] op_sel_hi:[1,1,1]
  v_rcp_f32 v2, v2
  v_rcp_f32 v3, v3
  v_rcp_f32 v4, v4
  v_rcp_f32 v5, v5
  v_pk_mul_f32 v[204:205], v[204:205], v[220:221]
  v_pk_mul_f32 v[206:207], v[206:207], v[222:223]
  v_pk_mul_f32 v[204:205], v[204:205], v[2:3]
  v_pk_mul_f32 v[206:207], v[206:207], v[4:5]
  v_cvt_pk_bf16_f32 v204, v204, v205
  v_cvt_pk_bf16_f32 v205, v206, v207
  s_nop 1
  v_permlane16_swap_b32 v202, v204
  v_permlane16_swap_b32 v203, v205
  buffer_store_dwordx4 v[202:205], v10, s[12:15], s73 offen offset:512 sc1
  s_add_u32 s73, s73, 65536
  s_waitcnt vmcnt(2)
  s_barrier
  s_mov_b64 exec, 1
  buffer_atomic_add v61, v60, s[60:63], s52 offen offset:2048 sc1
  s_mov_b64 exec, -1
  s_waitcnt lgkmcnt(0)
  s_mov_b64 exec, 1
  buffer_load_dword v62, v60, s[64:67], s56 offen sc1
  s_mov_b64 exec, -1
  v_pk_fma_f32 v[224:225], v[208:209], v[12:13], v[224:225] op_sel:[0,0,0] op_sel_hi:[1,0,1]
  v_pk_fma_f32 v[226:227], v[210:211], v[12:13], v[226:227] op_sel:[0,0,0] op_sel_hi:[1,0,1]
  v_pk_mul_f32 v[2:3], v[224:225], v[16:17] op_sel:[0,0] op_sel_hi:[1,0]
  v_pk_mul_f32 v[4:5], v[226:227], v[16:17] op_sel:[0,0] op_sel_hi:[1,0]
  v_exp_f32 v2, v2
  v_exp_f32 v3, v3
  v_exp_f32 v4, v4
  v_exp_f32 v5, v5
  v_pk_fma_f32 v[240:241], v[212:213], v[12:13], v[240:241] op_sel:[0,0,0] op_sel_hi:[1,0,1]
  v_pk_fma_f32 v[242:243], v[214:215], v[12:13], v[242:243] op_sel:[0,0,0] op_sel_hi:[1,0,1]
  v_pk_fma_f32 v[2:3], v[2:3], v[20:21], v[20:21] op_sel:[0,0,0] op_sel_hi:[1,0,0]
  v_pk_fma_f32 v[4:5], v[4:5], v[20:21], v[20:21] op_sel:[0,0,0] op_sel_hi:[1,0,0]
  v_rcp_f32 v2, v2
  v_rcp_f32 v3, v3
  v_rcp_f32 v4, v4
  v_rcp_f32 v5, v5
  v_pk_mul_f32 v[224:225], v[224:225], v[240:241]
  v_pk_mul_f32 v[226:227], v[226:227], v[242:243]
  v_pk_mul_f32 v[224:225], v[224:225], v[2:3]
  v_pk_mul_f32 v[226:227], v[226:227], v[4:5]
  v_cvt_pk_bf16_f32 v227, v226, v227
  v_cvt_pk_bf16_f32 v226, v224, v225
  v_pk_fma_f32 v[228:229], v[208:209], v[12:13], v[228:229] op_sel:[0,1,0] op_sel_hi:[1,1,1]
  v_pk_fma_f32 v[230:231], v[210:211], v[12:13], v[230:231] op_sel:[0,1,0] op_sel_hi:[1,1,1]
  v_pk_mul_f32 v[2:3], v[228:229], v[16:17] op_sel:[0,1] op_sel_hi:[1,1]
  v_pk_mul_f32 v[4:5], v[230:231], v[16:17] op_sel:[0,1] op_sel_hi:[1,1]
  v_exp_f32 v2, v2
  v_exp_f32 v3, v3
  v_exp_f32 v4, v4
  v_exp_f32 v5, v5
  v_pk_fma_f32 v[244:245], v[212:213], v[12:13], v[244:245] op_sel:[0,1,0] op_sel_hi:[1,1,1]
  v_pk_fma_f32 v[246:247], v[214:215], v[12:13], v[246:247] op_sel:[0,1,0] op_sel_hi:[1,1,1]
  v_pk_fma_f32 v[2:3], v[2:3], v[20:21], v[20:21] op_sel:[0,1,1] op_sel_hi:[1,1,1]
  v_pk_fma_f32 v[4:5], v[4:5], v[20:21], v[20:21] op_sel:[0,1,1] op_sel_hi:[1,1,1]
  v_rcp_f32 v2, v2
  v_rcp_f32 v3, v3
  v_rcp_f32 v4, v4
  v_rcp_f32 v5, v5
  v_pk_mul_f32 v[228:229], v[228:229], v[244:245]
  v_pk_mul_f32 v[230:231], v[230:231], v[246:247]
  v_pk_mul_f32 v[228:229], v[228:229], v[2:3]
  v_pk_mul_f32 v[230:231], v[230:231], v[4:5]
  v_cvt_pk_bf16_f32 v228, v228, v229
  v_cvt_pk_bf16_f32 v229, v230, v231
  v_pk_fma_f32 v[232:233], v[208:209], v[14:15], v[232:233] op_sel:[0,0,0] op_sel_hi:[1,0,1]
  v_pk_fma_f32 v[234:235], v[210:211], v[14:15], v[234:235] op_sel:[0,0,0] op_sel_hi:[1,0,1]
  v_permlane16_swap_b32 v226, v228
  v_permlane16_swap_b32 v227, v229
  buffer_store_dwordx4 v[226:229], v10, s[12:15], s73 offen offset:0 sc1
  v_pk_mul_f32 v[2:3], v[232:233], v[18:19] op_sel:[0,0] op_sel_hi:[1,0]
  v_pk_mul_f32 v[4:5], v[234:235], v[18:19] op_sel:[0,0] op_sel_hi:[1,0]
  v_exp_f32 v2, v2
  v_exp_f32 v3, v3
  v_exp_f32 v4, v4
  v_exp_f32 v5, v5
  s_waitcnt vmcnt(1)
  v_readfirstlane_b32 s29, v62
  s_cmp_lt_u32 s29, 16
  s_cbranch_scc1 L_b_kernel_spin1
L_b_kernel_ret1:
  buffer_load_dwordx4 a[100:103], v24, s[12:15], s17 offen offset:0 sc1
  v_pk_fma_f32 v[248:249], v[212:213], v[14:15], v[248:249] op_sel:[0,0,0] op_sel_hi:[1,0,1]
  v_pk_fma_f32 v[250:251], v[214:215], v[14:15], v[250:251] op_sel:[0,0,0] op_sel_hi:[1,0,1]
  buffer_load_dwordx4 a[104:107], v24, s[12:15], s17 offen offset:256 sc1
  s_add_u32 s17, s17, 917504
  v_pk_fma_f32 v[2:3], v[2:3], v[22:23], v[22:23] op_sel:[0,0,0] op_sel_hi:[1,0,0]
  v_pk_fma_f32 v[4:5], v[4:5], v[22:23], v[22:23] op_sel:[0,0,0] op_sel_hi:[1,0,0]
  buffer_load_dwordx4 a[108:111], v24, s[12:15], s17 offen offset:0 sc1
  v_rcp_f32 v2, v2
  v_rcp_f32 v3, v3
  buffer_load_dwordx4 a[112:115], v24, s[12:15], s17 offen offset:256 sc1
  s_add_u32 s17, s17, 917504
  v_rcp_f32 v4, v4
  v_rcp_f32 v5, v5
  buffer_load_dwordx4 a[116:119], v24, s[12:15], s17 offen offset:0 sc1
  v_pk_mul_f32 v[232:233], v[232:233], v[248:249]
  v_pk_mul_f32 v[234:235], v[234:235], v[250:251]
  buffer_load_dwordx4 a[120:123], v24, s[12:15], s17 offen offset:256 sc1
  s_add_u32 s17, s17, 917504
  v_pk_mul_f32 v[232:233], v[232:233], v[2:3]
  v_pk_mul_f32 v[234:235], v[234:235], v[4:5]
  buffer_load_dwordx4 a[124:127], v24, s[12:15], s17 offen offset:0 sc1
  v_cvt_pk_bf16_f32 v235, v234, v235
  v_cvt_pk_bf16_f32 v234, v232, v233
  buffer_load_dwordx4 a[128:131], v24, s[12:15], s17 offen offset:256 sc1
  s_add_u32 s17, s17, 917504
  v_pk_fma_f32 v[236:237], v[208:209], v[14:15], v[236:237] op_sel:[0,1,0] op_sel_hi:[1,1,1]
  v_pk_fma_f32 v[238:239], v[210:211], v[14:15], v[238:239] op_sel:[0,1,0] op_sel_hi:[1,1,1]
  buffer_load_dwordx4 a[132:135], v24, s[12:15], s17 offen offset:0 sc1
  v_pk_mul_f32 v[2:3], v[236:237], v[18:19] op_sel:[0,1] op_sel_hi:[1,1]
  v_pk_mul_f32 v[4:5], v[238:239], v[18:19] op_sel:[0,1] op_sel_hi:[1,1]
  buffer_load_dwordx4 a[136:139], v24, s[12:15], s17 offen offset:256 sc1
  s_add_u32 s17, s17, 917504
  v_exp_f32 v2, v2
  v_exp_f32 v3, v3
  buffer_load_dwordx4 a[140:143], v24, s[12:15], s17 offen offset:0 sc1
  v_exp_f32 v4, v4
  v_exp_f32 v5, v5
  buffer_load_dwordx4 a[144:147], v24, s[12:15], s17 offen offset:256 sc1
  s_add_u32 s17, s17, 917504
  v_pk_fma_f32 v[252:253], v[212:213], v[14:15], v[252:253] op_sel:[0,1,0] op_sel_hi:[1,1,1]
  v_pk_fma_f32 v[254:255], v[214:215], v[14:15], v[254:255] op_sel:[0,1,0] op_sel_hi:[1,1,1]
  buffer_load_dwordx4 a[148:151], v24, s[12:15], s17 offen offset:0 sc1
  v_pk_fma_f32 v[2:3], v[2:3], v[22:23], v[22:23] op_sel:[0,1,1] op_sel_hi:[1,1,1]
  v_pk_fma_f32 v[4:5], v[4:5], v[22:23], v[22:23] op_sel:[0,1,1] op_sel_hi:[1,1,1]
  buffer_load_dwordx4 a[152:155], v24, s[12:15], s17 offen offset:256 sc1
  s_add_u32 s17, s17, 917504
  v_rcp_f32 v2, v2
  v_rcp_f32 v3, v3
  v_rcp_f32 v4, v4
  v_rcp_f32 v5, v5
  v_pk_mul_f32 v[236:237], v[236:237], v[252:253]
  v_pk_mul_f32 v[238:239], v[238:239], v[254:255]
  v_pk_mul_f32 v[236:237], v[236:237], v[2:3]
  v_pk_mul_f32 v[238:239], v[238:239], v[4:5]
  v_cvt_pk_bf16_f32 v236, v236, v237
  v_cvt_pk_bf16_f32 v237, v238, v239
  s_nop 1
  v_permlane16_swap_b32 v234, v236
  v_permlane16_swap_b32 v235, v237
  buffer_store_dwordx4 v[234:237], v10, s[12:15], s73 offen offset:512 sc1
  s_barrier
  ds_read_b64_tr_b16 a[0:1], v36 offset:0
  ds_read_b64_tr_b16 a[2:3], v36 offset:1024
  ds_read_b64_tr_b16 a[4:5], v37 offset:0
  ds_read_b64_tr_b16 a[6:7], v37 offset:1024
  ds_read_b64_tr_b16 a[8:9], v38 offset:0
  ds_read_b64_tr_b16 a[10:11], v38 offset:1024
  s_mov_b32 s19, 0
  s_waitcnt vmcnt(13) lgkmcnt(4)
  v_mfma_f32_16x16x32_bf16 v[128:131], a[0:3], a[100:103], 0
  ds_read_b64_tr_b16 a[12:13], v39 offset:0
  ds_read_b64_tr_b16 a[14:15], v39 offset:1024
  v_mfma_f32_16x16x32_bf16 v[132:135], a[0:3], a[104:107], 0
  buffer_load_dwordx4 a[156:159], v24, s[12:15], s17 offen offset:0 sc1
  s_waitcnt lgkmcnt(4)
  v_mfma_f32_16x16x32_bf16 v[140:143], a[4:7], a[104:107], 0
  ds_read_b64_tr_b16 a[0:1], v32 offset:0
  ds_read_b64_tr_b16 a[2:3], v32 offset:1024
  v_mfma_f32_16x16x32_bf16 v[136:139], a[4:7], a[100:103], 0
  s_waitcnt lgkmcnt(4)
  v_mfma_f32_16x16x32_bf16 v[144:147], a[8:11], a[100:103], 0
  ds_read_b64_tr_b16 a[4:5], v33 offset:0
  ds_read_b64_tr_b16 a[6:7], v33 offset:1024
  v_mfma_f32_16x16x32_bf16 v[148:151], a[8:11], a[104:107], 0
  buffer_load_dwordx4 a[160:163], v24, s[12:15], s17 offen offset:256 sc1
  s_add_u32 s17, s17, -6356992
  s_waitcnt lgkmcnt(4)
  v_mfma_f32_16x16x32_bf16 v[156:159], a[12:15], a[104:107], 0
  ds_read_b64_tr_b16 a[8:9], v34 offset:0
  ds_read_b64_tr_b16 a[10:11], v34 offset:1024
  v_mfma_f32_16x16x32_bf16 v[152:155], a[12:15], a[100:103], 0
  s_waitcnt lgkmcnt(4)
  v_mfma_f32_16x16x32_bf16 v[96:99], a[0:3], a[100:103], 0
  ds_read_b64_tr_b16 a[12:13], v35 offset:0
  ds_read_b64_tr_b16 a[14:15], v35 offset:1024
  s_add_u32 m0, s18, 0
  v_mfma_f32_16x16x32_bf16 v[100:103], a[0:3], a[104:107], 0
  buffer_load_dwordx4 v6, s[4:7], s16 offen  lds
  s_waitcnt lgkmcnt(4)
  v_mfma_f32_16x16x32_bf16 v[108:111], a[4:7], a[104:107], 0
  ds_read_b64_tr_b16 a[0:1], v36 offset:8192
  ds_read_b64_tr_b16 a[2:3], v36 offset:9216
  v_mfma_f32_16x16x32_bf16 v[104:107], a[4:7], a[100:103], 0
  s_waitcnt lgkmcnt(4)
  v_mfma_f32_16x16x32_bf16 v[112:115], a[8:11], a[100:103], 0
  ds_read_b64_tr_b16 a[4:5], v37 offset:8192
  ds_read_b64_tr_b16 a[6:7], v37 offset:9216
  s_add_u32 m0, s18, 1024
  v_mfma_f32_16x16x32_bf16 v[116:119], a[8:11], a[104:107], 0
  buffer_load_dwordx4 v7, s[4:7], s16 offen  lds
  s_waitcnt lgkmcnt(4)
  v_mfma_f32_16x16x32_bf16 v[124:127], a[12:15], a[104:107], 0
  ds_read_b64_tr_b16 a[8:9], v38 offset:8192
  ds_read_b64_tr_b16 a[10:11], v38 offset:9216
  v_mfma_f32_16x16x32_bf16 v[120:123], a[12:15], a[100:103], 0
  s_branch L_b_kernel_cmid
  .p2align 6
L_b_kernel_cloop:
  s_branch L_b_kernel_hook
L_b_kernel_ret2:
  s_waitcnt vmcnt(13) lgkmcnt(4)
  v_mfma_f32_16x16x32_bf16 v[128:131], a[0:3], a[100:103], v[128:131]
  ds_read_b64_tr_b16 a[12:13], v39 offset:0
  ds_read_b64_tr_b16 a[14:15], v39 offset:1024
  v_mfma_f32_16x16x32_bf16 v[132:135], a[0:3], a[104:107], v[132:135]
  buffer_load_dwordx4 a[156:159], v24, s[12:15], s17 offen offset:0 sc1
  s_waitcnt lgkmcnt(4)
  v_mfma_f32_16x16x32_bf16 v[140:143], a[4:7], a[104:107], v[140:143]
  ds_read_b64_tr_b16 a[0:1], v32 offset:0
  ds_read_b64_tr_b16 a[2:3], v32 offset:1024
  v_mfma_f32_16x16x32_bf16 v[136:139], a[4:7], a[100:103], v[136:139]
  s_waitcnt lgkmcnt(4)
  v_mfma_f32_16x16x32_bf16 v[144:147], a[8:11], a[100:103], v[144:147]
  ds_read_b64_tr_b16 a[4:5], v33 offset:0
  ds_read_b64_tr_b16 a[6:7], v33 offset:1024
  v_mfma_f32_16x16x32_bf16 v[148:151], a[8:11], a[104:107], v[148:151]
  buffer_load_dwordx4 a[160:163], v24, s[12:15], s17 offen offset:256 sc1
  s_add_u32 s17, s17, -6356992
  s_waitcnt lgkmcnt(4)
  v_mfma_f32_16x16x32_bf16 v[156:159], a[12:15], a[104:107], v[156:159]
  ds_read_b64_tr_b16 a[8:9], v34 offset:0
  ds_read_b64_tr_b16 a[10:11], v34 offset:1024
  v_mfma_f32_16x16x32_bf16 v[152:155], a[12:15], a[100:103], v[152:155]
  s_waitcnt lgkmcnt(4)
  v_mfma_f32_16x16x32_bf16 v[96:99], a[0:3], a[100:103], v[96:99]
  ds_read_b64_tr_b16 a[12:13], v35 offset:0
  ds_read_b64_tr_b16 a[14:15], v35 offset:1024
  s_add_u32 m0, s18, 0
  v_mfma_f32_16x16x32_bf16 v[100:103], a[0:3], a[104:107], v[100:103]
  buffer_load_dwordx4 v6, s[4:7], s16 offen  lds
  s_waitcnt lgkmcnt(4)
  v_mfma_f32_16x16x32_bf16 v[108:111], a[4:7], a[104:107], v[108:111]
  ds_read_b64_tr_b16 a[0:1], v36 offset:8192
  ds_read_b64_tr_b16 a[2:3], v36 offset:9216
  v_mfma_f32_16x16x32_bf16 v[104:107], a[4:7], a[100:103], v[104:107]
  s_waitcnt lgkmcnt(4)
  v_mfma_f32_16x16x32_bf16 v[112:115], a[8:11], a[100:103], v[112:115]
  ds_read_b64_tr_b16 a[4:5], v37 offset:8192
  ds_read_b64_tr_b16 a[6:7], v37 offset:9216
  s_add_u32 m0, s18, 1024
  v_mfma_f32_16x16x32_bf16 v[116:119], a[8:11], a[104:107], v[116:119]
  buffer_load_dwordx4 v7, s[4:7], s16 offen  lds
  s_waitcnt lgkmcnt(4)
  v_mfma_f32_16x16x32_bf16 v[124:127], a[12:15], a[104:107], v[124:127]
  ds_read_b64_tr_b16 a[8:9], v38 offset:8192
  ds_read_b64_tr_b16 a[10:11], v38 offset:9216
  v_mfma_f32_16x16x32_bf16 v[120:123], a[12:15], a[100:103], v[120:123]
L_b_kernel_cmid:
  s_waitcnt vmcnt(15) lgkmcnt(4)
  v_mfma_f32_16x16x32_bf16 v[128:131], a[0:3], a[108:111], v[128:131]
  ds_read_b64_tr_b16 a[12:13], v39 offset:8192
  ds_read_b64_tr_b16 a[14:15], v39 offset:9216
  v_mfma_f32_16x16x32_bf16 v[132:135], a[0:3], a[112:115], v[132:135]
  buffer_load_dwordx4 a[100:103], v24, s[12:15], s17 offen offset:0 sc1
  s_waitcnt lgkmcnt(4)
  v_mfma_f32_16x16x32_bf16 v[140:143], a[4:7], a[112:115], v[140:143]
  ds_read_b64_tr_b16 a[0:1], v32 offset:8192
  ds_read_b64_tr_b16 a[2:3], v32 offset:9216
  v_mfma_f32_16x16x32_bf16 v[136:139], a[4:7], a[108:111], v[136:139]
  s_waitcnt lgkmcnt(4)
  v_mfma_f32_16x16x32_bf16 v[144:147], a[8:11], a[108:111], v[144:147]
  ds_read_b64_tr_b16 a[4:5], v33 offset:8192
  ds_read_b64_tr_b16 a[6:7], v33 offset:9216
  v_mfma_f32_16x16x32_bf16 v[148:151], a[8:11], a[112:115], v[148:151]
  buffer_load_dwordx4 a[104:107], v24, s[12:15], s17 offen offset:256 sc1
  s_add_u32 s17, s17, 917504
  s_waitcnt lgkmcnt(4)
  v_mfma_f32_16x16x32_bf16 v[156:159], a[12:15], a[112:115], v[156:159]
  ds_read_b64_tr_b16 a[8:9], v34 offset:8192
  ds_read_b64_tr_b16 a[10:11], v34 offset:9216
  v_mfma_f32_16x16x32_bf16 v[152:155], a[12:15], a[108:111], v[152:155]
  s_waitcnt lgkmcnt(4)
  v_mfma_f32_16x16x32_bf16 v[96:99], a[0:3], a[108:111], v[96:99]
  ds_read_b64_tr_b16 a[12:13], v35 offset:8192
  ds_read_b64_tr_b16 a[14:15], v35 offset:9216
  s_add_u32 m0, s18, 2048
  v_mfma_f32_16x16x32_bf16 v[100:103], a[0:3], a[112:115], v[100:103]
  buffer_load_dwordx4 v8, s[4:7], s16 offen  lds
  s_waitcnt vmcnt(23)
  s_barrier
  s_waitcnt lgkmcnt(4)
  v_mfma_f32_16x16x32_bf16 v[108:111], a[4:7], a[112:115], v[108:111]
  ds_read_b64_tr_b16 a[0:1], v36 offset:16384
  ds_read_b64_tr_b16 a[2:3], v36 offset:17408
  v_mfma_f32_16x16x32_bf16 v[104:107], a[4:7], a[108:111], v[104:107]
  s_waitcnt lgkmcnt(4)
  v_mfma_f32_16x16x32_bf16 v[112:115], a[8:11], a[108:111], v[112:115]
  ds_read_b64_tr_b16 a[4:5], v37 offset:16384
  ds_read_b64_tr_b16 a[6:7], v37 offset:17408
  s_add_u32 m0, s18, 3072
  v_mfma_f32_16x16x32_bf16 v[116:119], a[8:11], a[112:115], v[116:119]
  buffer_load_dwordx4 v9, s[4:7], s16 offen  lds
  s_add_u32 s16, s16, 917504
  s_waitcnt lgkmcnt(4)
  v_mfma_f32_16x16x32_bf16 v[124:127], a[12:15], a[112:115], v[124:127]
  ds_read_b64_tr_b16 a[8:9], v38 offset:16384
  ds_read_b64_tr_b16 a[10:11], v38 offset:17408
  v_mfma_f32_16x16x32_bf16 v[120:123], a[12:15], a[108:111], v[120:123]
  s_waitcnt vmcnt(17) lgkmcnt(4)
  v_mfma_f32_16x16x32_bf16 v[128:131], a[0:3], a[116:119], v[128:131]
  ds_read_b64_tr_b16 a[12:13], v39 offset:16384
  ds_read_b64_tr_b16 a[14:15], v39 offset:17408
  v_mfma_f32_16x16x32_bf16 v[132:135], a[0:3], a[120:123], v[132:135]
  buffer_load_dwordx4 a[108:111], v24, s[12:15], s17 offen offset:0 sc1
  s_waitcnt lgkmcnt(4)
  v_mfma_f32_16x16x32_bf16 v[140:143], a[4:7], a[120:123], v[140:143]
  ds_read_b64_tr_b16 a[0:1], v32 offset:16384
  ds_read_b64_tr_b16 a[2:3], v32 offset:17408
  v_mfma_f32_16x16x32_bf16 v[136:139], a[4:7], a[116:119], v[136:139]
  s_waitcnt lgkmcnt(4)
  v_mfma_f32_16x16x32_bf16 v[144:147], a[8:11], a[116:119], v[144:147]
  ds_read_b64_tr_b16 a[4:5], v33 offset:16384
  ds_read_b64_tr_b16 a[6:7], v33 offset:17408
  v_mfma_f32_16x16x32_bf16 v[148:151], a[8:11], a[120:123], v[148:151]
  buffer_load_dwordx4 a[112:115], v24, s[12:15], s17 offen offset:256 sc1
  s_add_u32 s17, s17, 917504
  s_waitcnt lgkmcnt(4)
  v_mfma_f32_16x16x32_bf16 v[156:159], a[12:15], a[120:123], v[156:159]
  ds_read_b64_tr_b16 a[8:9], v34 offset:16384
  ds_read_b64_tr_b16 a[10:11], v34 offset:17408
  v_mfma_f32_16x16x32_bf16 v[152:155], a[12:15], a[116:119], v[152:155]
  s_waitcnt lgkmcnt(4)
  v_mfma_f32_16x16x32_bf16 v[96:99], a[0:3], a[116:119], v[96:99]
  ds_read_b64_tr_b16 a[12:13], v35 offset:16384
  ds_read_b64_tr_b16 a[14:15], v35 offset:17408
  s_add_u32 m0, s18, 16384
  v_mfma_f32_16x16x32_bf16 v[100:103], a[0:3], a[120:123], v[100:103]
  buffer_load_dwordx4 v6, s[4:7], s16 offen  lds
  s_waitcnt lgkmcnt(4)
  v_mfma_f32_16x16x32_bf16 v[108:111], a[4:7], a[120:123], v[108:111]
  ds_read_b64_tr_b16 a[0:1], v36 offset:24576
  ds_read_b64_tr_b16 a[2:3], v36 offset:25600
  v_mfma_f32_16x16x32_bf16 v[104:107], a[4:7], a[116:119], v[104:107]
  s_waitcnt lgkmcnt(4)
  v_mfma_f32_16x16x32_bf16 v[112:115], a[8:11], a[116:119], v[112:115]
  ds_read_b64_tr_b16 a[4:5], v37 offset:24576
  ds_read_b64_tr_b16 a[6:7], v37 offset:25600
  s_add_u32 m0, s18, 17408
  v_mfma_f32_16x16x32_bf16 v[116:119], a[8:11], a[120:123], v[116:119]
  buffer_load_dwordx4 v7, s[4:7], s16 offen  lds
  s_waitcnt lgkmcnt(4)
  v_mfma_f32_16x16x32_bf16 v[124:127], a[12:15], a[120:123], v[124:127]
  ds_read_b64_tr_b16 a[8:9], v38 offset:24576
  ds_read_b64_tr_b16 a[10:11], v38 offset:25600
  v_mfma_f32_16x16x32_bf16 v[120:123], a[12:15], a[116:119], v[120:123]
  s_waitcnt vmcnt(19) lgkmcnt(4)
  v_mfma_f32_16x16x32_bf16 v[128:131], a[0:3], a[124:127], v[128:131]
  ds_read_b64_tr_b16 a[12:13], v39 offset:24576
  ds_read_b64_tr_b16 a[14:15], v39 offset:25600
  v_mfma_f32_16x16x32_bf16 v[132:135], a[0:3], a[128:131], v[132:135]
  buffer_load_dwordx4 a[116:119], v24, s[12:15], s17 offen offset:0 sc1
  s_waitcnt lgkmcnt(4)
  v_mfma_f32_16x16x32_bf16 v[140:143], a[4:7], a[128:131], v[140:143]
  ds_read_b64_tr_b16 a[0:1], v32 offset:24576
  ds_read_b64_tr_b16 a[2:3], v32 offset:25600
  v_mfma_f32_16x16x32_bf16 v[136:139], a[4:7], a[124:127], v[136:139]
  s_waitcnt lgkmcnt(4)
  v_mfma_f32_16x16x32_bf16 v[144:147], a[8:11], a[124:127], v[144:147]
  ds_read_b64_tr_b16 a[4:5], v33 offset:24576
  ds_read_b64_tr_b16 a[6:7], v33 offset:25600
  v_mfma_f32_16x16x32_bf16 v[148:151], a[8:11], a[128:131], v[148:151]
  buffer_load_dwordx4 a[120:123], v24, s[12:15], s17 offen offset:256 sc1
  s_add_u32 s17, s17, 917504
  s_waitcnt lgkmcnt(4)
  v_mfma_f32_16x16x32_bf16 v[156:159], a[12:15], a[128:131], v[156:159]
  ds_read_b64_tr_b16 a[8:9], v34 offset:24576
  ds_read_b64_tr_b16 a[10:11], v34 offset:25600
  v_mfma_f32_16x16x32_bf16 v[152:155], a[12:15], a[124:127], v[152:155]
  s_waitcnt lgkmcnt(4)
  v_mfma_f32_16x16x32_bf16 v[96:99], a[0:3], a[124:127], v[96:99]
  ds_read_b64_tr_b16 a[12:13], v35 offset:24576
  ds_read_b64_tr_b16 a[14:15], v35 offset:25600
  s_add_u32 m0, s18, 18432
  v_mfma_f32_16x16x32_bf16 v[100:103], a[0:3], a[128:131], v[100:103]
  buffer_load_dwordx4 v8, s[4:7], s16 offen  lds
  s_waitcnt vmcnt(23)
  s_barrier
  s_waitcnt lgkmcnt(4)
  v_mfma_f32_16x16x32_bf16 v[108:111], a[4:7], a[128:131], v[108:111]
  ds_read_b64_tr_b16 a[0:1], v36 offset:32768
  ds_read_b64_tr_b16 a[2:3], v36 offset:33792
  v_mfma_f32_16x16x32_bf16 v[104:107], a[4:7], a[124:127], v[104:107]
  s_waitcnt lgkmcnt(4)
  v_mfma_f32_16x16x32_bf16 v[112:115], a[8:11], a[124:127], v[112:115]
  ds_read_b64_tr_b16 a[4:5], v37 offset:32768
  ds_read_b64_tr_b16 a[6:7], v37 offset:33792
  s_add_u32 m0, s18, 19456
  v_mfma_f32_16x16x32_bf16 v[116:119], a[8:11], a[128:131], v[116:119]
  buffer_load_dwordx4 v9, s[4:7], s16 offen  lds
  s_add_u32 s16, s16, 917504
  s_waitcnt lgkmcnt(4)
  v_mfma_f32_16x16x32_bf16 v[124:127], a[12:15], a[128:131], v[124:127]
  ds_read_b64_tr_b16 a[8:9], v38 offset:32768
  ds_read_b64_tr_b16 a[10:11], v38 offset:33792
  v_mfma_f32_16x16x32_bf16 v[120:123], a[12:15], a[124:127], v[120:123]
  s_waitcnt vmcnt(21) lgkmcnt(4)
  v_mfma_f32_16x16x32_bf16 v[128:131], a[0:3], a[132:135], v[128:131]
  ds_read_b64_tr_b16 a[12:13], v39 offset:32768
  ds_read_b64_tr_b16 a[14:15], v39 offset:33792
  v_mfma_f32_16x16x32_bf16 v[132:135], a[0:3], a[136:139], v[132:135]
  buffer_load_dwordx4 a[124:127], v24, s[12:15], s17 offen offset:0 sc1
  s_waitcnt lgkmcnt(4)
  v_mfma_f32_16x16x32_bf16 v[140:143], a[4:7], a[136:139], v[140:143]
  ds_read_b64_tr_b16 a[0:1], v32 offset:32768
  ds_read_b64_tr_b16 a[2:3], v32 offset:33792
  v_mfma_f32_16x16x32_bf16 v[136:139], a[4:7], a[132:135], v[136:139]
  s_waitcnt lgkmcnt(4)
  v_mfma_f32_16x16x32_bf16 v[144:147], a[8:11], a[132:135], v[144:147]
  ds_read_b64_tr_b16 a[4:5], v33 offset:32768
  ds_read_b64_tr_b16 a[6:7], v33 offset:33792
  v_mfma_f32_16x16x32_bf16 v[148:151], a[8:11], a[136:139], v[148:151]
  buffer_load_dwordx4 a[128:131], v24, s[12:15], s17 offen offset:256 sc1
  s_add_u32 s17, s17, 917504
  s_waitcnt lgkmcnt(4)
  v_mfma_f32_16x16x32_bf16 v[156:159], a[12:15], a[136:139], v[156:159]
  ds_read_b64_tr_b16 a[8:9], v34 offset:32768
  ds_read_b64_tr_b16 a[10:11], v34 offset:33792
  v_mfma_f32_16x16x32_bf16 v[152:155], a[12:15], a[132:135], v[152:155]
  s_waitcnt lgkmcnt(4)
  v_mfma_f32_16x16x32_bf16 v[96:99], a[0:3], a[132:135], v[96:99]
  ds_read_b64_tr_b16 a[12:13], v35 offset:32768
  ds_read_b64_tr_b16 a[14:15], v35 offset:33792
  s_add_u32 m0, s18, 32768
  v_mfma_f32_16x16x32_bf16 v[100:103], a[0:3], a[136:139], v[100:103]
  buffer_load_dwordx4 v6, s[4:7], s16 offen  lds
  s_waitcnt lgkmcnt(4)
  v_mfma_f32_16x16x32_bf16 v[108:111], a[4:7], a[136:139], v[108:111]
  ds_read_b64_tr_b16 a[0:1], v36 offset:40960
  ds_read_b64_tr_b16 a[2:3], v36 offset:41984
  v_mfma_f32_16x16x32_bf16 v[104:107], a[4:7], a[132:135], v[104:107]
  s_waitcnt lgkmcnt(4)
  v_mfma_f32_16x16x32_bf16 v[112:115], a[8:11], a[132:135], v[112:115]
  ds_read_b64_tr_b16 a[4:5], v37 offset:40960
  ds_read_b64_tr_b16 a[6:7], v37 offset:41984
  s_add_u32 m0, s18, 33792
  v_mfma_f32_16x16x32_bf16 v[116:119], a[8:11], a[136:139], v[116:119]
  buffer_load_dwordx4 v7, s[4:7], s16 offen  lds
  s_waitcnt lgkmcnt(4)
  v_mfma_f32_16x16x32_bf16 v[124:127], a[12:15], a[136:139], v[124:127]
  ds_read_b64_tr_b16 a[8:9], v38 offset:40960
  ds_read_b64_tr_b16 a[10:11], v38 offset:41984
  v_mfma_f32_16x16x32_bf16 v[120:123], a[12:15], a[132:135], v[120:123]
  s_waitcnt vmcnt(23) lgkmcnt(4)
  v_mfma_f32_16x16x32_bf16 v[128:131], a[0:3], a[140:143], v[128:131]
  ds_read_b64_tr_b16 a[12:13], v39 offset:40960
  ds_read_b64_tr_b16 a[14:15], v39 offset:41984
  v_mfma_f32_16x16x32_bf16 v[132:135], a[0:3], a[144:147], v[132:135]
  buffer_load_dwordx4 a[132:135], v24, s[12:15], s17 offen offset:0 sc1
  s_waitcnt lgkmcnt(4)
  v_mfma_f32_16x16x32_bf16 v[140:143], a[4:7], a[144:147], v[140:143]
  ds_read_b64_tr_b16 a[0:1], v32 offset:40960
  ds_read_b64_tr_b16 a[2:3], v32 offset:41984
  v_mfma_f32_16x16x32_bf16 v[136:139], a[4:7], a[140:143], v[136:139]
  s_waitcnt lgkmcnt(4)
  v_mfma_f32_16x16x32_bf16 v[144:147], a[8:11], a[140:143], v[144:147]
  ds_read_b64_tr_b16 a[4:5], v33 offset:40960
  ds_read_b64_tr_b16 a[6:7], v33 offset:41984
  v_mfma_f32_16x16x32_bf16 v[148:151], a[8:11], a[144:147], v[148:151]
  buffer_load_dwordx4 a[136:139], v24, s[12:15], s17 offen offset:256 sc1
  s_add_u32 s17, s17, 917504
  s_waitcnt lgkmcnt(4)
  v_mfma_f32_16x16x32_bf16 v[156:159], a[12:15], a[144:147], v[156:159]
  ds_read_b64_tr_b16 a[8:9], v34 offset:40960
  ds_read_b64_tr_b16 a[10:11], v34 offset:41984
  v_mfma_f32_16x16x32_bf16 v[152:155], a[12:15], a[140:143], v[152:155]
  s_waitcnt lgkmcnt(4)
  v_mfma_f32_16x16x32_bf16 v[96:99], a[0:3], a[140:143], v[96:99]
  ds_read_b64_tr_b16 a[12:13], v35 offset:40960
  ds_read_b64_tr_b16 a[14:15], v35 offset:41984
  s_add_u32 m0, s18, 34816
  v_mfma_f32_16x16x32_bf16 v[100:103], a[0:3], a[144:147], v[100:103]
  buffer_load_dwordx4 v8, s[4:7], s16 offen  lds
  s_waitcnt vmcnt(23)
  s_barrier
  s_waitcnt lgkmcnt(4)
  v_mfma_f32_16x16x32_bf16 v[108:111], a[4:7], a[144:147], v[108:111]
  ds_read_b64_tr_b16 a[0:1], v36 offset:49152
  ds_read_b64_tr_b16 a[2:3], v36 offset:50176
  v_mfma_f32_16x16x32_bf16 v[104:107], a[4:7], a[140:143], v[104:107]
  s_waitcnt lgkmcnt(4)
  v_mfma_f32_16x16x32_bf16 v[112:115], a[8:11], a[140:143], v[112:115]
  ds_read_b64_tr_b16 a[4:5], v37 offset:49152
  ds_read_b64_tr_b16 a[6:7], v37 offset:50176
  s_add_u32 m0, s18, 35840
  v_mfma_f32_16x16x32_bf16 v[116:119], a[8:11], a[144:147], v[116:119]
  buffer_load_dwordx4 v9, s[4:7], s16 offen  lds
  s_add_u32 s16, s16, 917504
  s_waitcnt lgkmcnt(4)
  v_mfma_f32_16x16x32_bf16 v[124:127], a[12:15], a[144:147], v[124:127]
  ds_read_b64_tr_b16 a[8:9], v38 offset:49152
  ds_read_b64_tr_b16 a[10:11], v38 offset:50176
  v_mfma_f32_16x16x32_bf16 v[120:123], a[12:15], a[140:143], v[120:123]
  s_waitcnt vmcnt(25) lgkmcnt(4)
  v_mfma_f32_16x16x32_bf16 v[128:131], a[0:3], a[148:151], v[128:131]
  ds_read_b64_tr_b16 a[12:13], v39 offset:49152
  ds_read_b64_tr_b16 a[14:15], v39 offset:50176
  v_mfma_f32_16x16x32_bf16 v[132:135], a[0:3], a[152:155], v[132:135]
  buffer_load_dwordx4 a[140:143], v24, s[12:15], s17 offen offset:0 sc1
  s_waitcnt lgkmcnt(4)
  v_mfma_f32_16x16x32_bf16 v[140:143], a[4:7], a[152:155], v[140:143]
  ds_read_b64_tr_b16 a[0:1], v32 offset:49152
  ds_read_b64_tr_b16 a[2:3], v32 offset:50176
  v_mfma_f32_16x16x32_bf16 v[136:139], a[4:7], a[148:151], v[136:139]
  s_waitcnt lgkmcnt(4)
  v_mfma_f32_16x16x32_bf16 v[144:147], a[8:11], a[148:151], v[144:147]
  ds_read_b64_tr_b16 a[4:5], v33 offset:49152
  ds_read_b64_tr_b16 a[6:7], v33 offset:50176
  v_mfma_f32_16x16x32_bf16 v[148:151], a[8:11], a[152:155], v[148:151]
  buffer_load_dwordx4 a[144:147], v24, s[12:15], s17 offen offset:256 sc1
  s_add_u32 s17, s17, 917504
  s_waitcnt lgkmcnt(4)
  v_mfma_f32_16x16x32_bf16 v[156:159], a[12:15], a[152:155], v[156:159]
  ds_read_b64_tr_b16 a[8:9], v34 offset:49152
  ds_read_b64_tr_b16 a[10:11], v34 offset:50176
  v_mfma_f32_16x16x32_bf16 v[152:155], a[12:15], a[148:151], v[152:155]
  s_waitcnt lgkmcnt(4)
  v_mfma_f32_16x16x32_bf16 v[96:99], a[0:3], a[148:151], v[96:99]
  ds_read_b64_tr_b16 a[12:13], v35 offset:49152
  ds_read_b64_tr_b16 a[14:15], v35 offset:50176
  s_add_u32 m0, s18, 49152
  v_mfma_f32_16x16x32_bf16 v[100:103], a[0:3], a[152:155], v[100:103]
  buffer_load_dwordx4 v6, s[4:7], s16 offen  lds
  s_waitcnt lgkmcnt(4)
  v_mfma_f32_16x16x32_bf16 v[108:111], a[4:7], a[152:155], v[108:111]
  ds_read_b64_tr_b16 a[0:1], v36 offset:57344
  ds_read_b64_tr_b16 a[2:3], v36 offset:58368
  v_mfma_f32_16x16x32_bf16 v[104:107], a[4:7], a[148:151], v[104:107]
  s_waitcnt lgkmcnt(4)
  v_mfma_f32_16x16x32_bf16 v[112:115], a[8:11], a[148:151], v[112:115]
  ds_read_b64_tr_b16 a[4:5], v37 offset:57344
  ds_read_b64_tr_b16 a[6:7], v37 offset:58368
  s_add_u32 m0, s18, 50176
  v_mfma_f32_16x16x32_bf16 v[116:119], a[8:11], a[152:155], v[116:119]
  buffer_load_dwordx4 v7, s[4:7], s16 offen  lds
  s_waitcnt lgkmcnt(4)
  v_mfma_f32_16x16x32_bf16 v[124:127], a[12:15], a[152:155], v[124:127]
  ds_read_b64_tr_b16 a[8:9], v38 offset:57344
  ds_read_b64_tr_b16 a[10:11], v38 offset:58368
  v_mfma_f32_16x16x32_bf16 v[120:123], a[12:15], a[148:151], v[120:123]
  s_waitcnt vmcnt(26) lgkmcnt(4)
  v_mfma_f32_16x16x32_bf16 v[128:131], a[0:3], a[156:159], v[128:131]
  ds_read_b64_tr_b16 a[12:13], v39 offset:57344
  ds_read_b64_tr_b16 a[14:15], v39 offset:58368
  v_mfma_f32_16x16x32_bf16 v[132:135], a[0:3], a[160:163], v[132:135]
  buffer_load_dwordx4 a[148:151], v24, s[12:15], s17 offen offset:0 sc1
  s_waitcnt lgkmcnt(4)
  v_mfma_f32_16x16x32_bf16 v[140:143], a[4:7], a[160:163], v[140:143]
  ds_read_b64_tr_b16 a[0:1], v32 offset:57344
  ds_read_b64_tr_b16 a[2:3], v32 offset:58368
  v_mfma_f32_16x16x32_bf16 v[136:139], a[4:7], a[156:159], v[136:139]
  s_waitcnt lgkmcnt(4)
  v_mfma_f32_16x16x32_bf16 v[144:147], a[8:11], a[156:159], v[144:147]
  ds_read_b64_tr_b16 a[4:5], v33 offset:57344
  ds_read_b64_tr_b16 a[6:7], v33 offset:58368
  v_mfma_f32_16x16x32_bf16 v[148:151], a[8:11], a[160:163], v[148:151]
  buffer_load_dwordx4 a[152:155], v24, s[12:15], s17 offen offset:256 sc1
  s_add_u32 s17, s17, 917504
  s_waitcnt lgkmcnt(4)
  v_mfma_f32_16x16x32_bf16 v[156:159], a[12:15], a[160:163], v[156:159]
  ds_read_b64_tr_b16 a[8:9], v34 offset:57344
  ds_read_b64_tr_b16 a[10:11], v34 offset:58368
  v_mfma_f32_16x16x32_bf16 v[152:155], a[12:15], a[156:159], v[152:155]
  s_waitcnt lgkmcnt(4)
  v_mfma_f32_16x16x32_bf16 v[96:99], a[0:3], a[156:159], v[96:99]
  ds_read_b64_tr_b16 a[12:13], v35 offset:57344
  ds_read_b64_tr_b16 a[14:15], v35 offset:58368
  s_add_u32 m0, s18, 51200
  v_mfma_f32_16x16x32_bf16 v[100:103], a[0:3], a[160:163], v[100:103]
  buffer_load_dwordx4 v8, s[4:7], s16 offen  lds
  s_waitcnt vmcnt(23)
  s_barrier
  v_xor_b32 v32, 65536, v32
  v_xor_b32 v33, 65536, v33
  v_xor_b32 v34, 65536, v34
  v_xor_b32 v35, 65536, v35
  v_xor_b32 v36, 65536, v36
  v_xor_b32 v37, 65536, v37
  v_xor_b32 v38, 65536, v38
  v_xor_b32 v39, 65536, v39
  s_waitcnt lgkmcnt(4)
  v_mfma_f32_16x16x32_bf16 v[108:111], a[4:7], a[160:163], v[108:111]
  ds_read_b64_tr_b16 a[0:1], v36 offset:0
  ds_read_b64_tr_b16 a[2:3], v36 offset:1024
  v_mfma_f32_16x16x32_bf16 v[104:107], a[4:7], a[156:159], v[104:107]
  s_waitcnt lgkmcnt(4)
  v_mfma_f32_16x16x32_bf16 v[112:115], a[8:11], a[156:159], v[112:115]
  ds_read_b64_tr_b16 a[4:5], v37 offset:0
  ds_read_b64_tr_b16 a[6:7], v37 offset:1024
  s_add_u32 m0, s18, 52224
  v_mfma_f32_16x16x32_bf16 v[116:119], a[8:11], a[160:163], v[116:119]
  buffer_load_dwordx4 v9, s[4:7], s16 offen  lds
  s_add_u32 s16, s16, -2719744
  s_xor_b32 s18, s18, 65536
  s_waitcnt lgkmcnt(4)
  v_mfma_f32_16x16x32_bf16 v[124:127], a[12:15], a[160:163], v[124:127]
  ds_read_b64_tr_b16 a[8:9], v38 offset:0
  ds_read_b64_tr_b16 a[10:11], v38 offset:1024
  v_mfma_f32_16x16x32_bf16 v[120:123], a[12:15], a[156:159], v[120:123]
  s_add_u32 s19, s19, 1
  s_cmp_lt_u32 s19, 6
  s_cbranch_scc1 L_b_kernel_cloop
  s_waitcnt lgkmcnt(4)
  v_mfma_f32_16x16x32_bf16 v[128:131], a[0:3], a[100:103], v[128:131]
  ds_read_b64_tr_b16 a[12:13], v39 offset:0
  ds_read_b64_tr_b16 a[14:15], v39 offset:1024
  v_mfma_f32_16x16x32_bf16 v[132:135], a[0:3], a[104:107], v[132:135]
  buffer_load_dwordx4 a[156:159], v24, s[12:15], s17 offen offset:0 sc1
  buffer_load_dwordx4 a[160:163], v24, s[12:15], s17 offen offset:256 sc1
  s_add_u32 s17, s17, -6356992
  s_waitcnt lgkmcnt(4)
  v_mfma_f32_16x16x32_bf16 v[140:143], a[4:7], a[104:107], v[140:143]
  ds_read_b64_tr_b16 a[0:1], v32 offset:0
  ds_read_b64_tr_b16 a[2:3], v32 offset:1024
  v_mfma_f32_16x16x32_bf16 v[136:139], a[4:7], a[100:103], v[136:139]
  buffer_load_dwordx4 a[164:167], v25, s[8:11], s57 offen offset:0
  buffer_load_dwordx4 a[168:171], v25, s[8:11], s57 offen offset:256
  s_waitcnt lgkmcnt(4)
  v_mfma_f32_16x16x32_bf16 v[144:147], a[8:11], a[100:103], v[144:147]
  ds_read_b64_tr_b16 a[4:5], v33 offset:0
  ds_read_b64_tr_b16 a[6:7], v33 offset:1024
  v_mfma_f32_16x16x32_bf16 v[148:151], a[8:11], a[104:107], v[148:151]
  buffer_load_dwordx4 a[172:175], v25, s[8:11], s58 offen offset:0
  buffer_load_dwordx4 a[176:179], v25, s[8:11], s58 offen offset:256
  s_waitcnt lgkmcnt(4)
  v_mfma_f32_16x16x32_bf16 v[156:159], a[12:15], a[104:107], v[156:159]
  ds_read_b64_tr_b16 a[8:9], v34 offset:0
  ds_read_b64_tr_b16 a[10:11], v34 offset:1024
  v_mfma_f32_16x16x32_bf16 v[152:155], a[12:15], a[100:103], v[152:155]
  v_and_b32 v12, 15, v0
  v_bfe_u32 v13, v0, 4, 2
  s_waitcnt lgkmcnt(4)
  v_mfma_f32_16x16x32_bf16 v[96:99], a[0:3], a[100:103], v[96:99]
  ds_read_b64_tr_b16 a[12:13], v35 offset:0
  ds_read_b64_tr_b16 a[14:15], v35 offset:1024
  v_mfma_f32_16x16x32_bf16 v[100:103], a[0:3], a[104:107], v[100:103]
  v_and_b32 v14, 1, v0
  v_lshlrev_b32 v14, 4, v14
  s_waitcnt lgkmcnt(4)
  v_mfma_f32_16x16x32_bf16 v[108:111], a[4:7], a[104:107], v[108:111]
  ds_read_b64_tr_b16 a[0:1], v36 offset:8192
  ds_read_b64_tr_b16 a[2:3], v36 offset:9216
  v_mfma_f32_16x16x32_bf16 v[104:107], a[4:7], a[100:103], v[104:107]
  v_mov_b32 v15, 0x3f80
  v_lshlrev_b32 v14, v14, v15
  s_waitcnt lgkmcnt(4)
  v_mfma_f32_16x16x32_bf16 v[112:115], a[8:11], a[100:103], v[112:115]
  ds_read_b64_tr_b16 a[4:5], v37 offset:8192
  ds_read_b64_tr_b16 a[6:7], v37 offset:9216
  v_mfma_f32_16x16x32_bf16 v[116:119], a[8:11], a[104:107], v[116:119]
  v_lshrrev_b32 v15, 2, v12
  v_cmp_eq_u32 s[20:21], v13, v15
  s_waitcnt lgkmcnt(4)
  v_mfma_f32_16x16x32_bf16 v[124:127], a[12:15], a[104:107], v[124:127]
  ds_read_b64_tr_b16 a[8:9], v38 offset:8192
  ds_read_b64_tr_b16 a[10:11], v38 offset:9216
  v_mfma_f32_16x16x32_bf16 v[120:123], a[12:15], a[100:103], v[120:123]
  v_bfe_u32 v16, v12, 1, 1
  v_mov_b32 v40, 0
  s_waitcnt vmcnt(28) lgkmcnt(4)
  v_mfma_f32_16x16x32_bf16 v[128:131], a[0:3], a[108:111], v[128:131]
  ds_read_b64_tr_b16 a[12:13], v39 offset:8192
  ds_read_b64_tr_b16 a[14:15], v39 offset:9216
  v_mfma_f32_16x16x32_bf16 v[132:135], a[0:3], a[112:115], v[132:135]
  v_mov_b32 v41, 0
  v_cndmask_b32 v17, 0, v14, s[20:21]
  s_waitcnt lgkmcnt(4)
  v_mfma_f32_16x16x32_bf16 v[140:143], a[4:7], a[112:115], v[140:143]
  ds_read_b64_tr_b16 a[0:1], v32 offset:8192
  ds_read_b64_tr_b16 a[2:3], v32 offset:9216
  v_mfma_f32_16x16x32_bf16 v[136:139], a[4:7], a[108:111], v[136:139]
  v_cmp_eq_u32 s[20:21], 0, v16
  v_mov_b32 v44, 0
  s_waitcnt lgkmcnt(4)
  v_mfma_f32_16x16x32_bf16 v[144:147], a[8:11], a[108:111], v[144:147]
  ds_read_b64_tr_b16 a[4:5], v33 offset:8192
  ds_read_b64_tr_b16 a[6:7], v33 offset:9216
  v_mfma_f32_16x16x32_bf16 v[148:151], a[8:11], a[112:115], v[148:151]
  v_mov_b32 v45, 0
  v_cndmask_b32 v42, 0, v17, s[20:21]
  s_waitcnt lgkmcnt(4)
  v_mfma_f32_16x16x32_bf16 v[156:159], a[12:15], a[112:115], v[156:159]
  ds_read_b64_tr_b16 a[8:9], v34 offset:8192
  ds_read_b64_tr_b16 a[10:11], v34 offset:9216
  v_mfma_f32_16x16x32_bf16 v[152:155], a[12:15], a[108:111], v[152:155]
  v_cndmask_b32 v43, v17, 0, s[20:21]
  v_lshrrev_b32 v15, 3, v12
  s_waitcnt lgkmcnt(4)
  v_mfma_f32_16x16x32_bf16 v[96:99], a[0:3], a[108:111], v[96:99]
  ds_read_b64_tr_b16 a[12:13], v35 offset:8192
  ds_read_b64_tr_b16 a[14:15], v35 offset:9216
  v_mfma_f32_16x16x32_bf16 v[100:103], a[0:3], a[112:115], v[100:103]
  v_lshlrev_b32 v15, 1, v15
  v_cmp_eq_u32 s[20:21], v13, v15
  s_waitcnt vmcnt(22)
  s_barrier
  s_waitcnt lgkmcnt(4)
  v_mfma_f32_16x16x32_bf16 v[108:111], a[4:7], a[112:115], v[108:111]
  ds_read_b64_tr_b16 a[0:1], v36 offset:16384
  ds_read_b64_tr_b16 a[2:3], v36 offset:17408
  v_mfma_f32_16x16x32_bf16 v[104:107], a[4:7], a[108:111], v[104:107]
  v_add_u32 v15, 1, v15
  v_cmp_eq_u32 s[22:23], v13, v15
  s_waitcnt lgkmcnt(4)
  v_mfma_f32_16x16x32_bf16 v[112:115], a[8:11], a[108:111], v[112:115]
  ds_read_b64_tr_b16 a[4:5], v37 offset:16384
  ds_read_b64_tr_b16 a[6:7], v37 offset:17408
  v_mfma_f32_16x16x32_bf16 v[116:119], a[8:11], a[112:115], v[116:119]
  v_bfe_u32 v16, v12, 1, 2
  v_cndmask_b32 v17, 0, v14, s[20:21]
  s_waitcnt lgkmcnt(4)
  v_mfma_f32_16x16x32_bf16 v[124:127], a[12:15], a[112:115], v[124:127]
  ds_read_b64_tr_b16 a[8:9], v38 offset:16384
  ds_read_b64_tr_b16 a[10:11], v38 offset:17408
  v_mfma_f32_16x16x32_bf16 v[120:123], a[12:15], a[108:111], v[120:123]
  v_cndmask_b32 v18, 0, v14, s[22:23]
  v_cmp_eq_u32 s[20:21], 0, v16
  s_waitcnt lgkmcnt(4)
  v_mfma_f32_16x16x32_bf16 v[128:131], a[0:3], a[116:119], v[128:131]
  ds_read_b64_tr_b16 a[12:13], v39 offset:16384
  ds_read_b64_tr_b16 a[14:15], v39 offset:17408
  v_mfma_f32_16x16x32_bf16 v[132:135], a[0:3], a[120:123], v[132:135]
  s_nop 1
  v_cndmask_b32 v46, 0, v17, s[20:21]
  s_waitcnt lgkmcnt(4)
  v_mfma_f32_16x16x32_bf16 v[140:143], a[4:7], a[120:123], v[140:143]
  ds_read_b64_tr_b16 a[0:1], v36 offset:24576
  ds_read_b64_tr_b16 a[2:3], v36 offset:25600
  v_mfma_f32_16x16x32_bf16 v[136:139], a[4:7], a[116:119], v[136:139]
  v_cndmask_b32 v50, 0, v18, s[20:21]
  v_cmp_eq_u32 s[20:21], 1, v16
  s_waitcnt lgkmcnt(4)
  v_mfma_f32_16x16x32_bf16 v[144:147], a[8:11], a[116:119], v[144:147]
  ds_read_b64_tr_b16 a[4:5], v37 offset:24576
  ds_read_b64_tr_b16 a[6:7], v37 offset:25600
  v_mfma_f32_16x16x32_bf16 v[148:151], a[8:11], a[120:123], v[148:151]
  s_nop 1
  v_cndmask_b32 v47, 0, v17, s[20:21]
  s_waitcnt lgkmcnt(4)
  v_mfma_f32_16x16x32_bf16 v[156:159], a[12:15], a[120:123], v[156:159]
  ds_read_b64_tr_b16 a[8:9], v38 offset:24576
  ds_read_b64_tr_b16 a[10:11], v38 offset:25600
  v_mfma_f32_16x16x32_bf16 v[152:155], a[12:15], a[116:119], v[152:155]
  v_cndmask_b32 v51, 0, v18, s[20:21]
  v_cmp_eq_u32 s[20:21], 2, v16
  s_waitcnt vmcnt(20) lgkmcnt(4)
  v_mfma_f32_16x16x32_bf16 v[128:131], a[0:3], a[124:127], v[128:131]
  ds_read_b64_tr_b16 a[12:13], v39 offset:24576
  ds_read_b64_tr_b16 a[14:15], v39 offset:25600
  v_mfma_f32_16x16x32_bf16 v[132:135], a[0:3], a[128:131], v[132:135]
  s_nop 1
  v_cndmask_b32 v48, 0, v17, s[20:21]
  s_waitcnt vmcnt(14)
  s_barrier
  s_waitcnt lgkmcnt(4)
  v_mfma_f32_16x16x32_bf16 v[140:143], a[4:7], a[128:131], v[140:143]
  ds_read_b64_tr_b16 a[0:1], v36 offset:32768
  ds_read_b64_tr_b16 a[2:3], v36 offset:33792
  v_mfma_f32_16x16x32_bf16 v[136:139], a[4:7], a[124:127], v[136:139]
  v_cndmask_b32 v52, 0, v18, s[20:21]
  v_cmp_eq_u32 s[20:21], 3, v16
  s_waitcnt lgkmcnt(4)
  v_mfma_f32_16x16x32_bf16 v[144:147], a[8:11], a[124:127], v[144:147]
  ds_read_b64_tr_b16 a[4:5], v37 offset:32768
  ds_read_b64_tr_b16 a[6:7], v37 offset:33792
  v_mfma_f32_16x16x32_bf16 v[148:151], a[8:11], a[128:131], v[148:151]
  s_nop 1
  v_cndmask_b32 v49, 0, v17, s[20:21]
  s_waitcnt lgkmcnt(4)
  v_mfma_f32_16x16x32_bf16 v[156:159], a[12:15], a[128:131], v[156:159]
  ds_read_b64_tr_b16 a[8:9], v38 offset:32768
  ds_read_b64_tr_b16 a[10:11], v38 offset:33792
  v_mfma_f32_16x16x32_bf16 v[152:155], a[12:15], a[124:127], v[152:155]
  v_cndmask_b32 v53, 0, v18, s[20:21]
  s_waitcnt lgkmcnt(4)
  v_mfma_f32_16x16x32_bf16 v[128:131], a[0:3], a[132:135], v[128:131]
  ds_read_b64_tr_b16 a[12:13], v39 offset:32768
  ds_read_b64_tr_b16 a[14:15], v39 offset:33792
  v_mfma_f32_16x16x32_bf16 v[132:135], a[0:3], a[136:139], v[132:135]
  s_waitcnt lgkmcnt(4)
  v_mfma_f32_16x16x32_bf16 v[140:143], a[4:7], a[136:139], v[140:143]
  ds_read_b64_tr_b16 a[0:1], v36 offset:40960
  ds_read_b64_tr_b16 a[2:3], v36 offset:41984
  v_mfma_f32_16x16x32_bf16 v[136:139], a[4:7], a[132:135], v[136:139]
  s_waitcnt lgkmcnt(4)
  v_mfma_f32_16x16x32_bf16 v[144:147], a[8:11], a[132:135], v[144:147]
  ds_read_b64_tr_b16 a[4:5], v37 offset:40960
  ds_read_b64_tr_b16 a[6:7], v37 offset:41984
  v_mfma_f32_16x16x32_bf16 v[148:151], a[8:11], a[136:139], v[148:151]
  s_waitcnt lgkmcnt(4)
  v_mfma_f32_16x16x32_bf16 v[156:159], a[12:15], a[136:139], v[156:159]
  ds_read_b64_tr_b16 a[8:9], v38 offset:40960
  ds_read_b64_tr_b16 a[10:11], v38 offset:41984
  v_mfma_f32_16x16x32_bf16 v[152:155], a[12:15], a[132:135], v[152:155]
  s_waitcnt vmcnt(12) lgkmcnt(4)
  v_mfma_f32_16x16x32_bf16 v[128:131], a[0:3], a[140:143], v[128:131]
  ds_read_b64_tr_b16 a[12:13], v39 offset:40960
  ds_read_b64_tr_b16 a[14:15], v39 offset:41984
  v_mfma_f32_16x16x32_bf16 v[132:135], a[0:3], a[144:147], v[132:135]
  s_waitcnt vmcnt(6)
  s_barrier
  s_waitcnt lgkmcnt(4)
  v_mfma_f32_16x16x32_bf16 v[140:143], a[4:7], a[144:147], v[140:143]
  ds_read_b64_tr_b16 a[0:1], v36 offset:49152
  ds_read_b64_tr_b16 a[2:3], v36 offset:50176
  v_mfma_f32_16x16x32_bf16 v[136:139], a[4:7], a[140:143], v[136:139]
  s_waitcnt lgkmcnt(4)
  v_mfma_f32_16x16x32_bf16 v[144:147], a[8:11], a[140:143], v[144:147]
  ds_read_b64_tr_b16 a[4:5], v37 offset:49152
  ds_read_b64_tr_b16 a[6:7], v37 offset:50176
  v_mfma_f32_16x16x32_bf16 v[148:151], a[8:11], a[144:147], v[148:151]
  s_waitcnt lgkmcnt(4)
  v_mfma_f32_16x16x32_bf16 v[156:159], a[12:15], a[144:147], v[156:159]
  ds_read_b64_tr_b16 a[8:9], v38 offset:49152
  ds_read_b64_tr_b16 a[10:11], v38 offset:50176
  v_mfma_f32_16x16x32_bf16 v[152:155], a[12:15], a[140:143], v[152:155]
  s_waitcnt lgkmcnt(4)
  v_mfma_f32_16x16x32_bf16 v[128:131], a[0:3], a[148:151], v[128:131]
  ds_read_b64_tr_b16 a[12:13], v39 offset:49152
  ds_read_b64_tr_b16 a[14:15], v39 offset:50176
  v_mfma_f32_16x16x32_bf16 v[132:135], a[0:3], a[152:155], v[132:135]
  s_waitcnt lgkmcnt(4)
  v_mfma_f32_16x16x32_bf16 v[140:143], a[4:7], a[152:155], v[140:143]
  ds_read_b64_tr_b16 a[0:1], v36 offset:57344
  ds_read_b64_tr_b16 a[2:3], v36 offset:58368
  v_mfma_f32_16x16x32_bf16 v[136:139], a[4:7], a[148:151], v[136:139]
  s_waitcnt lgkmcnt(4)
  v_mfma_f32_16x16x32_bf16 v[144:147], a[8:11], a[148:151], v[144:147]
  ds_read_b64_tr_b16 a[4:5], v37 offset:57344
  ds_read_b64_tr_b16 a[6:7], v37 offset:58368
  v_mfma_f32_16x16x32_bf16 v[148:151], a[8:11], a[152:155], v[148:151]
  s_waitcnt lgkmcnt(4)
  v_mfma_f32_16x16x32_bf16 v[156:159], a[12:15], a[152:155], v[156:159]
  ds_read_b64_tr_b16 a[8:9], v38 offset:57344
  ds_read_b64_tr_b16 a[10:11], v38 offset:58368
  v_mfma_f32_16x16x32_bf16 v[152:155], a[12:15], a[148:151], v[152:155]
  s_waitcnt vmcnt(4) lgkmcnt(4)
  v_mfma_f32_16x16x32_bf16 v[128:131], a[0:3], a[156:159], v[128:131]
  ds_read_b64_tr_b16 a[12:13], v39 offset:57344
  ds_read_b64_tr_b16 a[14:15], v39 offset:58368
  v_mfma_f32_16x16x32_bf16 v[132:135], a[0:3], a[160:163], v[132:135]
  s_waitcnt lgkmcnt(4)
  v_mfma_f32_16x16x32_bf16 v[140:143], a[4:7], a[160:163], v[140:143]
  ds_read_b64_tr_b16 a[0:1], v32 offset:16384
  ds_read_b64_tr_b16 a[2:3], v32 offset:17408
  v_mfma_f32_16x16x32_bf16 v[136:139], a[4:7], a[156:159], v[136:139]
  s_waitcnt lgkmcnt(4)
  v_mfma_f32_16x16x32_bf16 v[144:147], a[8:11], a[156:159], v[144:147]
  ds_read_b64_tr_b16 a[4:5], v33 offset:16384
  ds_read_b64_tr_b16 a[6:7], v33 offset:17408
  v_mfma_f32_16x16x32_bf16 v[148:151], a[8:11], a[160:163], v[148:151]
  s_waitcnt lgkmcnt(4)
  v_mfma_f32_16x16x32_bf16 v[156:159], a[12:15], a[160:163], v[156:159]
  ds_read_b64_tr_b16 a[8:9], v34 offset:16384
  ds_read_b64_tr_b16 a[10:11], v34 offset:17408
  v_mfma_f32_16x16x32_bf16 v[152:155], a[12:15], a[156:159], v[152:155]
  s_waitcnt lgkmcnt(4)
  v_mfma_f32_16x16x32_bf16 v[96:99], a[0:3], a[116:119], v[96:99]
  ds_read_b64_tr_b16 a[12:13], v35 offset:16384
  ds_read_b64_tr_b16 a[14:15], v35 offset:17408
  v_mfma_f32_16x16x32_bf16 v[100:103], a[0:3], a[120:123], v[100:103]
  s_waitcnt lgkmcnt(4)
  v_mfma_f32_16x16x32_bf16 v[108:111], a[4:7], a[120:123], v[108:111]
  ds_read_b64_tr_b16 a[0:1], v32 offset:24576
  ds_read_b64_tr_b16 a[2:3], v32 offset:25600
  v_mfma_f32_16x16x32_bf16 v[104:107], a[4:7], a[116:119], v[104:107]
  s_nop 3
  v_cvt_pk_bf16_f32 v128, v128, v129
  s_waitcnt lgkmcnt(4)
  v_mfma_f32_16x16x32_bf16 v[112:115], a[8:11], a[116:119], v[112:115]
  ds_read_b64_tr_b16 a[4:5], v33 offset:24576
  ds_read_b64_tr_b16 a[6:7], v33 offset:25600
  v_mfma_f32_16x16x32_bf16 v[116:119], a[8:11], a[120:123], v[116:119]
  v_cvt_pk_bf16_f32 v129, v130, v131
  v_cvt_pk_bf16_f32 v130, v136, v137
  s_waitcnt lgkmcnt(4)
  v_mfma_f32_16x16x32_bf16 v[124:127], a[12:15], a[120:123], v[124:127]
  ds_read_b64_tr_b16 a[8:9], v34 offset:24576
  ds_read_b64_tr_b16 a[10:11], v34 offset:25600
  v_mfma_f32_16x16x32_bf16 v[120:123], a[12:15], a[116:119], v[120:123]
  v_cvt_pk_bf16_f32 v131, v138, v139
  buffer_store_dwordx4 v[128:131], v27, s[76:79], s80 offen offset:0 sc1
  s_waitcnt lgkmcnt(4)
  v_mfma_f32_16x16x32_bf16 v[96:99], a[0:3], a[124:127], v[96:99]
  ds_read_b64_tr_b16 a[12:13], v35 offset:24576
  ds_read_b64_tr_b16 a[14:15], v35 offset:25600
  v_mfma_f32_16x16x32_bf16 v[100:103], a[0:3], a[128:131], v[100:103]
  v_cvt_pk_bf16_f32 v132, v132, v133
  v_cvt_pk_bf16_f32 v133, v134, v135
  s_waitcnt lgkmcnt(4)
  v_mfma_f32_16x16x32_bf16 v[108:111], a[4:7], a[128:131], v[108:111]
  ds_read_b64_tr_b16 a[0:1], v32 offset:32768
  ds_read_b64_tr_b16 a[2:3], v32 offset:33792
  v_mfma_f32_16x16x32_bf16 v[104:107], a[4:7], a[124:127], v[104:107]
  v_cvt_pk_bf16_f32 v134, v140, v141
  v_cvt_pk_bf16_f32 v135, v142, v143
  s_waitcnt lgkmcnt(4)
  v_mfma_f32_16x16x32_bf16 v[112:115], a[8:11], a[124:127], v[112:115]
  ds_read_b64_tr_b16 a[4:5], v33 offset:32768
  ds_read_b64_tr_b16 a[6:7], v33 offset:33792
  v_mfma_f32_16x16x32_bf16 v[116:119], a[8:11], a[128:131], v[116:119]
  buffer_store_dwordx4 v[132:135], v27, s[76:79], s80 offen offset:1024 sc1
  v_cvt_pk_bf16_f32 v144, v144, v145
  s_waitcnt lgkmcnt(4)
  v_mfma_f32_16x16x32_bf16 v[124:127], a[12:15], a[128:131], v[124:127]
  ds_read_b64_tr_b16 a[8:9], v34 offset:32768
  ds_read_b64_tr_b16 a[10:11], v34 offset:33792
  v_mfma_f32_16x16x32_bf16 v[120:123], a[12:15], a[124:127], v[120:123]
  v_cvt_pk_bf16_f32 v145, v146, v147
  v_cvt_pk_bf16_f32 v146, v152, v153
  s_waitcnt lgkmcnt(4)
  v_mfma_f32_16x16x32_bf16 v[96:99], a[0:3], a[132:135], v[96:99]
  ds_read_b64_tr_b16 a[12:13], v35 offset:32768
  ds_read_b64_tr_b16 a[14:15], v35 offset:33792
  v_mfma_f32_16x16x32_bf16 v[100:103], a[0:3], a[136:139], v[100:103]
  v_cvt_pk_bf16_f32 v147, v154, v155
  buffer_store_dwordx4 v[144:147], v27, s[76:79], s80 offen offset:2048 sc1
  s_waitcnt lgkmcnt(4)
  v_mfma_f32_16x16x32_bf16 v[108:111], a[4:7], a[136:139], v[108:111]
  ds_read_b64_tr_b16 a[0:1], v32 offset:40960
  ds_read_b64_tr_b16 a[2:3], v32 offset:41984
  v_mfma_f32_16x16x32_bf16 v[104:107], a[4:7], a[132:135], v[104:107]
  v_cvt_pk_bf16_f32 v148, v148, v149
  v_cvt_pk_bf16_f32 v149, v150, v151
  s_waitcnt lgkmcnt(4)
  v_mfma_f32_16x16x32_bf16 v[112:115], a[8:11], a[132:135], v[112:115]
  ds_read_b64_tr_b16 a[4:5], v33 offset:40960
  ds_read_b64_tr_b16 a[6:7], v33 offset:41984
  v_mfma_f32_16x16x32_bf16 v[116:119], a[8:11], a[136:139], v[116:119]
  v_cvt_pk_bf16_f32 v150, v156, v157
  v_cvt_pk_bf16_f32 v151, v158, v159
  s_waitcnt lgkmcnt(4)
  v_mfma_f32_16x16x32_bf16 v[124:127], a[12:15], a[136:139], v[124:127]
  ds_read_b64_tr_b16 a[8:9], v34 offset:40960
  ds_read_b64_tr_b16 a[10:11], v34 offset:41984
  v_mfma_f32_16x16x32_bf16 v[120:123], a[12:15], a[132:135], v[120:123]
  buffer_store_dwordx4 v[148:151], v27, s[76:79], s80 offen offset:3072 sc1
  s_waitcnt lgkmcnt(4)
  v_mfma_f32_16x16x32_bf16 v[96:99], a[0:3], a[140:143], v[96:99]
  ds_read_b64_tr_b16 a[12:13], v35 offset:40960
  ds_read_b64_tr_b16 a[14:15], v35 offset:41984
  v_mfma_f32_16x16x32_bf16 v[100:103], a[0:3], a[144:147], v[100:103]
  s_waitcnt lgkmcnt(4)
  v_mfma_f32_16x16x32_bf16 v[108:111], a[4:7], a[144:147], v[108:111]
  ds_read_b64_tr_b16 a[0:1], v32 offset:49152
  ds_read_b64_tr_b16 a[2:3], v32 offset:50176
  v_mfma_f32_16x16x32_bf16 v[104:107], a[4:7], a[140:143], v[104:107]
  s_waitcnt lgkmcnt(4)
  v_mfma_f32_16x16x32_bf16 v[112:115], a[8:11], a[140:143], v[112:115]
  ds_read_b64_tr_b16 a[4:5], v33 offset:49152
  ds_read_b64_tr_b16 a[6:7], v33 offset:50176
  v_mfma_f32_16x16x32_bf16 v[116:119], a[8:11], a[144:147], v[116:119]
  s_waitcnt lgkmcnt(4)
  v_mfma_f32_16x16x32_bf16 v[124:127], a[12:15], a[144:147], v[124:127]
  ds_read_b64_tr_b16 a[8:9], v34 offset:49152
  ds_read_b64_tr_b16 a[10:11], v34 offset:50176
  v_mfma_f32_16x16x32_bf16 v[120:123], a[12:15], a[140:143], v[120:123]
  s_waitcnt lgkmcnt(4)
  v_mfma_f32_16x16x32_bf16 v[96:99], a[0:3], a[148:151], v[96:99]
  ds_read_b64_tr_b16 a[12:13], v35 offset:49152
  ds_read_b64_tr_b16 a[14:15], v35 offset:50176
  v_mfma_f32_16x16x32_bf16 v[100:103], a[0:3], a[152:155], v[100:103]
  s_waitcnt lgkmcnt(4)
  v_mfma_f32_16x16x32_bf16 v[108:111], a[4:7], a[152:155], v[108:111]
  ds_read_b64_tr_b16 a[0:1], v32 offset:57344
  ds_read_b64_tr_b16 a[2:3], v32 offset:58368
  v_mfma_f32_16x16x32_bf16 v[104:107], a[4:7], a[148:151], v[104:107]
  s_waitcnt lgkmcnt(4)
  v_mfma_f32_16x16x32_bf16 v[112:115], a[8:11], a[148:151], v[112:115]
  ds_read_b64_tr_b16 a[4:5], v33 offset:57344
  ds_read_b64_tr_b16 a[6:7], v33 offset:58368
  v_mfma_f32_16x16x32_bf16 v[116:119], a[8:11], a[152:155], v[116:119]
  s_waitcnt lgkmcnt(4)
  v_mfma_f32_16x16x32_bf16 v[124:127], a[12:15], a[152:155], v[124:127]
  ds_read_b64_tr_b16 a[8:9], v34 offset:57344
  ds_read_b64_tr_b16 a[10:11], v34 offset:58368
  v_mfma_f32_16x16x32_bf16 v[120:123], a[12:15], a[148:151], v[120:123]
  s_waitcnt vmcnt(4)
  v_mfma_f32_16x16x32_bf16 v[96:99], v[46:49], a[164:167], v[96:99]
  v_mfma_f32_16x16x32_bf16 v[104:107], v[50:53], a[164:167], v[104:107]
  v_mfma_f32_16x16x32_bf16 v[100:103], v[46:49], a[168:171], v[100:103]
  v_mfma_f32_16x16x32_bf16 v[108:111], v[50:53], a[168:171], v[108:111]
  v_mfma_f32_16x16x32_bf16 v[112:115], v[46:49], a[172:175], v[112:115]
  v_mfma_f32_16x16x32_bf16 v[120:123], v[50:53], a[172:175], v[120:123]
  v_mfma_f32_16x16x32_bf16 v[116:119], v[46:49], a[176:179], v[116:119]
  v_mfma_f32_16x16x32_bf16 v[124:127], v[50:53], a[176:179], v[124:127]
  s_waitcnt lgkmcnt(4)
  v_mfma_f32_16x16x32_bf16 v[96:99], a[0:3], a[156:159], v[96:99]
  ds_read_b64_tr_b16 a[12:13], v35 offset:57344
  ds_read_b64_tr_b16 a[14:15], v35 offset:58368
  v_mfma_f32_16x16x32_bf16 v[100:103], a[0:3], a[160:163], v[100:103]
  s_waitcnt lgkmcnt(4)
  v_mfma_f32_16x16x32_bf16 v[108:111], a[4:7], a[160:163], v[108:111]
  v_mfma_f32_16x16x32_bf16 v[104:107], a[4:7], a[156:159], v[104:107]
  s_waitcnt lgkmcnt(2)
  v_mfma_f32_16x16x32_bf16 v[112:115], a[8:11], a[156:159], v[112:115]
  v_mfma_f32_16x16x32_bf16 v[116:119], a[8:11], a[160:163], v[116:119]
  s_waitcnt lgkmcnt(0)
  v_mfma_f32_16x16x32_bf16 v[124:127], a[12:15], a[160:163], v[124:127]
  v_mfma_f32_16x16x32_bf16 v[120:123], a[12:15], a[156:159], v[120:123]
  s_waitcnt vmcnt(0)
  s_mov_b64 exec, 1
  buffer_store_dword v61, v60, s[64:67], s82 offen sc1
  s_mov_b32 s20, 0
L_b_kernel_poll3:
  buffer_load_dword v12, v60, s[64:67], s83 offen sc1
  s_waitcnt vmcnt(0)
  v_cmp_eq_u32 vcc, 0, v12
  s_cbranch_vccz L_b_kernel_go3
  s_add_u32 s20, s20, 1
  s_cmp_gt_u32 s20, 0x100000
  s_cbranch_scc1 L_b_kernel_go3
  s_sleep 1
  s_branch L_b_kernel_poll3
L_b_kernel_go3:
  s_mov_b64 exec, -1
  buffer_load_dwordx4 a[180:183], v27, s[76:79], s81 offen offset:0 sc1
  buffer_load_dwordx4 a[184:187], v27, s[76:79], s81 offen offset:1024 sc1
  buffer_load_dwordx4 a[188:191], v27, s[76:79], s81 offen offset:2048 sc1
  buffer_load_dwordx4 a[192:195], v27, s[76:79], s81 offen offset:3072 sc1
  s_waitcnt vmcnt(3)
  v_mfma_f32_16x16x32_bf16 v[96:99], v[42:45], a[180:183], v[96:99]
  v_mfma_f32_16x16x32_bf16 v[104:107], v[40:43], a[180:183], v[104:107]
  s_waitcnt vmcnt(2)
  v_mfma_f32_16x16x32_bf16 v[100:103], v[42:45], a[184:187], v[100:103]
  v_mfma_f32_16x16x32_bf16 v[108:111], v[40:43], a[184:187], v[108:111]
  s_nop 5
  v_cvt_pk_bf16_f32 v12, v96, v97
  v_cvt_pk_bf16_f32 v13, v98, v99
  v_cvt_pk_bf16_f32 v14, v104, v105
  v_cvt_pk_bf16_f32 v15, v106, v107
  s_mov_b32 s16, 0
  s_nop 0
  v_permlane16_swap_b32 v12, v14
  v_permlane16_swap_b32 v13, v15
  buffer_store_dwordx4 v[12:15], v26, s[84:87], s16 offen offset:0
  s_waitcnt vmcnt(2)
  v_mfma_f32_16x16x32_bf16 v[112:115], v[42:45], a[188:191], v[112:115]
  v_mfma_f32_16x16x32_bf16 v[120:123], v[40:43], a[188:191], v[120:123]
  s_nop 5
  v_cvt_pk_bf16_f32 v16, v100, v101
  v_cvt_pk_bf16_f32 v17, v102, v103
  v_cvt_pk_bf16_f32 v18, v108, v109
  v_cvt_pk_bf16_f32 v19, v110, v111
  s_mov_b32 s16, 262144
  s_nop 0
  v_permlane16_swap_b32 v16, v18
  v_permlane16_swap_b32 v17, v19
  buffer_store_dwordx4 v[16:19], v26, s[84:87], s16 offen offset:0
  s_waitcnt vmcnt(2)
  v_mfma_f32_16x16x32_bf16 v[116:119], v[42:45], a[192:195], v[116:119]
  v_mfma_f32_16x16x32_bf16 v[124:127], v[40:43], a[192:195], v[124:127]
  s_nop 5
  v_cvt_pk_bf16_f32 v12, v112, v113
  v_cvt_pk_bf16_f32 v13, v114, v115
  v_cvt_pk_bf16_f32 v14, v120, v121
  v_cvt_pk_bf16_f32 v15, v122, v123
  s_mov_b32 s16, 0
  s_nop 0
  v_permlane16_swap_b32 v12, v14
  v_permlane16_swap_b32 v13, v15
  buffer_store_dwordx4 v[12:15], v26, s[84:87], s16 offen offset:64
  s_nop 3
  v_cvt_pk_bf16_f32 v16, v116, v117
  v_cvt_pk_bf16_f32 v17, v118, v119
  v_cvt_pk_bf16_f32 v18, v124, v125
  v_cvt_pk_bf16_f32 v19, v126, v127
  s_mov_b32 s16, 262144
  s_nop 0
  v_permlane16_swap_b32 v16, v18
  v_permlane16_swap_b32 v17, v19
  buffer_store_dwordx4 v[16:19], v26, s[84:87], s16 offen offset:64
L_b_kernel_end:
  s_endpgm
L_b_kernel_fin:
  ds_read_b64 v[12:13], v17 offset:0
  ds_read_b64 v[18:19], v17 offset:64
  ds_read_b64 v[22:23], v17 offset:128
  ds_read_b64 v[24:25], v17 offset:192
  s_cmp_eq_u32 s28, 0
  s_cselect_b32 s66, 8192, 0
  s_waitcnt lgkmcnt(0)
  v_add_f32 v12, v12, v18
  v_add_f32 v13, v13, v19
  v_add_f32 v22, v22, v24
  v_add_f32 v23, v23, v25
  v_add_f32 v12, v12, v22
  v_add_f32 v13, v13, v23
  v_mul_f32 v12, 0x3a800000, v12
  v_mul_f32 v13, 0x3a800000, v13
  v_fma_f32 v13, -v12, v12, v13
  v_max_f32 v13, 0, v13
  v_cvt_pk_bf16_f32 v15, v13, v13
  v_lshlrev_b32 v15, 16, v15
  v_add_f32 v15, 0x3727c5ac, v15
  v_cvt_pk_bf16_f32 v15, v15, v15
  v_lshlrev_b32 v15, 16, v15
  v_sqrt_f32 v15, v15
  s_nop 0
  v_cvt_pk_bf16_f32 v18, v12, v15
  s_mov_b64 exec, 0xff
  buffer_store_dword v18, v21, s[64:67], 0 offen sc1
  s_mov_b64 exec, -1
  s_mov_b32 s66, 81920
  s_branch L_b_kernel_finret
L_b_kernel_spin0:
  s_mov_b32 s20, 0
L_b_kernel_spin0l:
  s_sleep 2
  buffer_load_dword v28, v26, s[64:67], 0 offen offset:0 sc1
  buffer_load_dword v29, v26, s[64:67], 0 offen offset:64 sc1
  buffer_load_dword v30, v26, s[64:67], 0 offen offset:128 sc1
  buffer_load_dword v31, v26, s[64:67], 0 offen offset:192 sc1
  s_waitcnt vmcnt(0)
  v_min_u32 v2, v28, v29
  v_min3_u32 v2, v2, v30, v31
  v_cmp_eq_u32 vcc, 0, v2
  s_cbranch_vccz L_b_kernel_ret0
  s_add_u32 s20, s20, 1
  s_cmp_gt_u32 s20, 0x100000
  s_cbranch_scc0 L_b_kernel_spin0l
  s_branch L_b_kernel_ret0
L_b_kernel_spin1:
  s_mov_b32 s20, 0
  s_mov_b64 exec, 1
L_b_kernel_spin1l:
  buffer_load_dword v62, v60, s[64:67], s56 offen offset:0 sc1
  s_waitcnt vmcnt(0)
  v_readfirstlane_b32 s29, v62
  s_cmp_ge_u32 s29, 16
  s_cbranch_scc1 L_b_kernel_spin1x
  s_sleep 1
  s_add_u32 s20, s20, 1
  s_cmp_gt_u32 s20, 0x100000
  s_cbranch_scc0 L_b_kernel_spin1l
L_b_kernel_spin1x:
  s_mov_b64 exec, -1
  s_branch L_b_kernel_ret1
L_b_kernel_spin2:
  s_mov_b32 s20, 0
  s_mov_b64 exec, 1
L_b_kernel_spin2l:
  buffer_load_dword v62, v60, s[64:67], s56 offen offset:2048 sc1
  s_waitcnt vmcnt(0)
  v_readfirstlane_b32 s29, v62
  s_cmp_ge_u32 s29, 16
  s_cbranch_scc1 L_b_kernel_spin2x
  s_sleep 1
  s_add_u32 s20, s20, 1
  s_cmp_gt_u32 s20, 0x100000
  s_cbranch_scc0 L_b_kernel_spin2l
L_b_kernel_spin2x:
  s_mov_b64 exec, -1
  s_branch L_b_kernel_ret2
L_b_kernel_spin3:
  s_mov_b32 s20, 0
  s_mov_b64 exec, 1
L_b_kernel_spin3l:
  buffer_load_dword v62, v60, s[64:67], s55 offen offset:0 sc1
  s_waitcnt vmcnt(0)
  v_readfirstlane_b32 s29, v62
  s_cmp_ge_u32 s29, 16
  s_cbranch_scc1 L_b_kernel_spin3x
  s_sleep 1
  s_add_u32 s20, s20, 1
  s_cmp_gt_u32 s20, 0x100000
  s_cbranch_scc0 L_b_kernel_spin3l
L_b_kernel_spin3x:
  s_mov_b64 exec, -1
  s_branch L_b_kernel_ret2
L_b_kernel_hook:
  s_cmp_lg_u32 s19, 1
  s_cbranch_scc1 L_b_kernel_h1
  s_add_u32 s54, s52, 4096
  s_add_u32 s55, s56, 4096
  s_mov_b64 exec, 1
  buffer_atomic_add v61, v60, s[60:63], s54 offen sc1
  s_mov_b64 exec, -1
L_b_kernel_h1:
  s_cmp_lg_u32 s19, 1
  s_cbranch_scc1 L_b_kernel_h2
  s_mov_b64 exec, 1
  buffer_load_dword v62, v60, s[64:67], s56 offen offset:2048 sc1
  s_mov_b64 exec, -1
L_b_kernel_h2:
  s_cmp_lg_u32 s19, 2
  s_cbranch_scc1 L_b_kernel_h3
  s_waitcnt vmcnt(31)
  v_readfirstlane_b32 s29, v62
  s_cmp_lt_u32 s29, 16
  s_cbranch_scc1 L_b_kernel_spin2
L_b_kernel_h3:
  s_cmp_lg_u32 s19, 3
  s_cbranch_scc1 L_b_kernel_h4
  s_mov_b64 exec, 1
  buffer_load_dword v62, v60, s[64:67], s55 offen sc1
  s_mov_b64 exec, -1
L_b_kernel_h4:
  s_cmp_lg_u32 s19, 4
  s_cbranch_scc1 L_b_kernel_ret2
  s_waitcnt vmcnt(31)
  v_readfirstlane_b32 s29, v62
  s_cmp_lt_u32 s29, 16
  s_cbranch_scc1 L_b_kernel_spin3
  s_branch L_b_kernel_ret2

  .fill 6144, 4, 0xbf800000
.section .rodata,"a"
.p2align 6
.amdhsa_kernel a_kernel
  .amdhsa_next_free_vgpr 256
  .amdhsa_next_free_sgpr 96
  .amdhsa_accum_offset 128
  .amdhsa_group_segment_fixed_size 0
  .amdhsa_kernarg_size 128
  .amdhsa_user_sgpr_count 2
  .amdhsa_user_sgpr_kernarg_segment_ptr 1
  .amdhsa_system_sgpr_workgroup_id_x 1
  .amdhsa_float_denorm_mode_32 3
  .amdhsa_float_denorm_mode_16_64 3
.end_amdhsa_kernel
.section .rodata,"a"
.p2align 6
.amdhsa_kernel b_kernel
  .amdhsa_next_free_vgpr 452
  .amdhsa_next_free_sgpr 102
  .amdhsa_accum_offset 256
  .amdhsa_group_segment_fixed_size 0
  .amdhsa_kernarg_size 128
  .amdhsa_user_sgpr_count 2
  .amdhsa_user_sgpr_kernarg_segment_ptr 1
  .amdhsa_system_sgpr_workgroup_id_x 1
  .amdhsa_float_denorm_mode_32 3
  .amdhsa_float_denorm_mode_16_64 3
.end_amdhsa_kernel
```
